```python
import torch

def _softmax(x, axis=-1):
    return torch.softmax(x, dim=axis)

def _gelu(x):
    return torch.nn.functional.gelu(x, approximate='tanh')

def _silu(x):
    return torch.nn.functional.silu(x)

def _sigmoid(x):
    return torch.sigmoid(x)

def _layernorm(x, axis=-1, eps=1e-05):
    m = x.mean(dim=axis, keepdim=True)
    v = x.var(dim=axis, keepdim=True, unbiased=False)
    return (x - m) / torch.sqrt(v + eps)

def _scatter_add(tgt, idx, src, axis=0):
    return tgt.clone().index_add_(axis, idx, src)

def _segment_sum(src, seg, n):
    out = torch.zeros((n,) + src.shape[1:], dtype=src.dtype)
    return out.index_add_(0, seg, src)

def _pad(x, pw):
    flat = tuple((v for pair in reversed(pw) for v in pair))
    return torch.nn.functional.pad(x, flat)
kernel_name = 'recurrent_scan__memory_aug_recurrent_mem_tr__glu_gated_reglu__prompt'

def setup_inputs():

    _w = lambda a: (lambda t: t.to(torch.bfloat16) if t.is_floating_point() else t)(torch.as_tensor(a))

    def _A_setup():
        B, S, Dm = (1, 2048, 512)
        H, Dh = (32, 128)
        M, seg = (8, 32)
        seg = min(seg, S)
        S = S // seg * seg
        return {'x': _w((lambda *s: torch.randn(*s, dtype=torch.bfloat16) * 0.1)(B, S, Dm)), 'mem0': _w((lambda *s: torch.randn(*s, dtype=torch.bfloat16) * 1.6)(B, M, Dm)), 'Wq': _w((lambda *s: torch.randn(*s, dtype=torch.bfloat16) * 0.8)(Dm, H, Dh) * Dm ** (-0.5)), 'Wk': _w((lambda *s: torch.randn(*s, dtype=torch.bfloat16) * 0.8)(Dm, H, Dh) * Dm ** (-0.5)), 'Wv': _w((lambda *s: torch.randn(*s, dtype=torch.bfloat16) * 1.6)(Dm, H, Dh) * Dm ** (-0.5)), 'Wo': _w((lambda *s: torch.randn(*s, dtype=torch.bfloat16) * 1.6)(H, Dh, Dm) * (H * Dh) ** (-0.5)), 'seg_len': seg}
    _A_in = _A_setup()

    def _B_setup():
        B, S, D, F = (1, 2048, 512, 1376)
        return {'x': _w((lambda *s: torch.randn(*s, dtype=torch.bfloat16) * 0.1)(B, S, D)), 'W_gate': _w((lambda *s: torch.randn(*s, dtype=torch.bfloat16) * 0.4)(D, F) * (2.0 / D) ** 0.5), 'W_up': _w((lambda *s: torch.randn(*s, dtype=torch.bfloat16) * 0.4)(D, F) * (2.0 / D) ** 0.5), 'W_down': _w((lambda *s: torch.randn(*s, dtype=torch.bfloat16) * 0.4)(F, D) * (1.0 / F) ** 0.5)}
    _B_in = _B_setup()
    return {'A_x': _A_in['x'], 'A_mem0': _A_in['mem0'], 'A_Wq': _A_in['Wq'], 'A_Wk': _A_in['Wk'], 'A_Wv': _A_in['Wv'], 'A_Wo': _A_in['Wo'], 'A_seg_len': _A_in['seg_len'], 'B_x': _B_in['x'], 'B_W_gate': _B_in['W_gate'], 'B_W_up': _B_in['W_up'], 'B_W_down': _B_in['W_down']}

def reference(A_x, A_mem0, A_Wq, A_Wk, A_Wv, A_Wo, A_seg_len, B_x, B_W_gate, B_W_up, B_W_down):

    def _A_ref(x, mem0, Wq, Wk, Wv, Wo, seg_len):
        B, S, Dm = x.shape
        H, Dh = (Wq.shape[1], Wq.shape[2])
        M = mem0.shape[1]
        scale = Dh ** (-0.5)
        n_seg = S // seg_len
        L = M + seg_len
        idx = torch.arange(L)
        mask = (idx[:, None] < M) | (idx[:, None] >= idx[None, :])
        mem = mem0
        outs = []
        for s in range(n_seg):
            xs = x[:, s * seg_len:(s + 1) * seg_len, :].clone()
            h = torch.concatenate([mem, xs], axis=1)
            q = torch.einsum('btd,dhe->bhte', h, Wq)
            k = torch.einsum('btd,dhe->bhte', h, Wk)
            v = torch.einsum('btd,dhe->bhte', h, Wv)
            scores = torch.einsum('bhqe,bhke->bhqk', q, k) * scale
            scores = torch.where(mask[None, None], scores, -1000000000.0)
            p = _softmax(scores, axis=-1)
            o = torch.einsum('bhqk,bhke->bhqe', p, v)
            o = torch.einsum('bhte,hed->btd', o, Wo)
            mem = o[:, :M, :].clone()
            outs.append(o[:, M:, :])
        return torch.concatenate(outs, axis=1)

    def _B_ref(x, W_gate, W_up, W_down):
        gate = torch.einsum('bsd,df->bsf', x, W_gate)
        up = torch.einsum('bsd,df->bsf', x, W_up)
        gate = gate * (lambda x, dt: x.to(dt))(gate > 0, gate.dtype)
        h = gate * up
        return torch.einsum('bsf,fd->bsd', h, W_down)
    x = A_x
    xn = _layernorm(x, axis=-1)
    s = _A_ref(xn, A_mem0, A_Wq, A_Wk, A_Wv, A_Wo, A_seg_len)
    g = _silu(_B_ref(xn, B_W_gate, B_W_up, B_W_down))
    return x + s * g
```

```asm
; @launch grid=(256,1,1) block=(256,1,1) lds=163840
.amdgcn_target "amdgcn-amd-amdhsa--gfx950"
.text
.globl recurrent_scan__memory_aug_recurrent_mem_tr__glu_gated_reglu__prompt_kernel
.p2align 8
.type recurrent_scan__memory_aug_recurrent_mem_tr__glu_gated_reglu__prompt_kernel,@function
recurrent_scan__memory_aug_recurrent_mem_tr__glu_gated_reglu__prompt_kernel:
s_cmp_ge_u32 s2, 256
s_cbranch_scc1 L_END
s_load_dwordx16 s[4:19], s[0:1], 0
s_load_dwordx8 s[20:27], s[0:1], 64
s_load_dwordx4 s[28:31], s[0:1], 96
s_getreg_b32 s33, hwreg(HW_REG_XCC_ID)
s_and_b32 s33, s33, 7
s_xor_b32 s33, s33, 3
v_lshrrev_b32 v1, 6, v0
s_nop 0
v_readfirstlane_b32 s32, v1
v_and_b32 v0, 63, v0
s_mov_b32 s35, 0
s_mov_b32 s52, 0x05040100
s_mov_b32 s53, 0x07060302
s_waitcnt lgkmcnt(0)
s_mov_b32 s36, s30
s_and_b32 s37, s31, 0xffff
s_mov_b32 s38, 0x10000000
s_mov_b32 s39, 0x20000
s_cmp_lg_u32 s32, 0
s_cbranch_scc1 L_notick
s_lshl_b32 s54, s33, 2
s_add_u32 s54, s54, 128
s_cmp_eq_u32 s33, 0
s_cselect_b32 s54, 0, s54
v_mov_b32 v2, s54
v_mov_b32 v3, 1
s_mov_b64 exec, 1
global_atomic_add v4, v2, v3, s[28:29] sc0
s_mov_b64 exec, -1
L_notick:
s_getpc_b64 s[56:57]
L_pc:
s_lshr_b32 s54, s2, 3
s_lshl_b32 s54, s54, 2
s_add_u32 s54, s54, s32
s_and_b32 s54, s54, 7
s_lshl_b32 s54, s54, 13
v_lshlrev_b32 v6, 7, v0
v_add_u32 v6, s54, v6
v_min_u32 v6, L_END-L_pc, v6
global_load_dword v127, v6, s[56:57]
s_cmp_lg_u32 s32, 0
s_cbranch_scc1 L_notick2
s_waitcnt vmcnt(1)
v_mov_b32 v5, 0
s_mov_b64 exec, 1
ds_write_b32 v5, v4
s_waitcnt lgkmcnt(0)
s_mov_b64 exec, -1
L_notick2:
s_barrier
v_mov_b32 v5, 0
ds_read_b32 v4, v5
s_waitcnt lgkmcnt(0)
v_readfirstlane_b32 s34, v4
s_barrier
s_cmp_ge_u32 s34, 32
s_cbranch_scc1 L_END
s_cmp_eq_u32 s33, 0
s_cbranch_scc1 L_CHAIN
s_sub_u32 s54, s33, 1
s_lshl_b32 s54, s54, 5
s_add_u32 s34, s34, s54
s_sub_u32 s55, s34, 32
s_mul_i32 s62, s55, 10923
s_lshr_b32 s62, s62, 16
s_mul_i32 s54, s62, 6
s_sub_u32 s63, s55, s54
s_cmp_lt_u32 s34, 32
s_cselect_b32 s62, s34, s62
s_cselect_b32 s63, 6, s63
s_cmp_lt_u32 s63, 3
s_cbranch_scc1 L_skipln
s_lshl_b32 s61, s62, 2
s_add_u32 s61, s61, s63
s_sub_u32 s61, s61, 3
s_mov_b32 s48, s4
s_and_b32 s49, s5, 0xffff
s_mov_b32 s50, 0x200000
s_mov_b32 s51, 0x20000
v_lshlrev_b32 v1, 4, v0
s_lshl_b32 s54, s61, 14
s_lshl_b32 s55, s32, 12
s_add_u32 s54, s54, s55
buffer_load_dwordx4 v[16:19], v1, s[48:51], s54 offen offset:0
buffer_load_dwordx4 v[20:23], v1, s[48:51], s54 offen offset:1024
buffer_load_dwordx4 v[24:27], v1, s[48:51], s54 offen offset:2048
buffer_load_dwordx4 v[28:31], v1, s[48:51], s54 offen offset:3072
v_lshrrev_b32 v120, 1, v0
v_lshlrev_b32 v120, 13, v120
v_and_b32 v121, 1, v0
v_lshlrev_b32 v121, 7, v121
s_lshl_b32 s55, s62, 8
s_sub_u32 s56, s63, 3
s_lshl_b32 s56, s56, 2
s_add_u32 s56, s56, s32
s_lshl_b32 s56, s56, 18
s_add_u32 s55, s55, s56
v_add3_u32 v120, v120, v121, s55
s_mov_b32 s40, s10
s_and_b32 s41, s11, 0xffff
s_mov_b32 s42, 0x400000
s_mov_b32 s43, 0x20000
buffer_load_dword v121, v120, s[40:43], 0 offen
s_mov_b32 s40, s12
s_and_b32 s41, s13, 0xffff
s_mov_b32 s42, 0x400000
s_mov_b32 s43, 0x20000
buffer_load_dword v121, v120, s[40:43], 0 offen
s_mov_b32 s40, s8
s_and_b32 s41, s9, 0xffff
s_mov_b32 s42, 0x400000
s_mov_b32 s43, 0x20000
buffer_load_dword v121, v120, s[40:43], 0 offen
v_lshlrev_b32 v2, 2, v0
v_mov_b32 v3, 0
s_lshl_b32 s55, s61, 10
s_lshl_b32 s56, s32, 8
s_add_u32 s55, s55, s56
s_add_u32 s55, s55, 2097152
buffer_store_dword v3, v2, s[36:39], s55 offen sc1
v_lshlrev_b32 v2, 7, v0
s_lshl_b32 s55, s61, 11
s_lshl_b32 s56, s32, 9
s_add_u32 s55, s55, s56
s_add_u32 s55, s55, 2359296
s_mov_b64 exec, 15
buffer_store_dword v3, v2, s[36:39], s55 offen sc1
s_mov_b64 exec, -1
s_mov_b32 s56, 0xffff0000
s_mov_b32 s57, 0x3b000000
s_mov_b32 s58, 0x3727c5ac
s_waitcnt vmcnt(8)
v_lshlrev_b32 v32, 16, v16
v_and_b32 v33, s56, v16
v_lshlrev_b32 v34, 16, v17
v_and_b32 v35, s56, v17
v_lshlrev_b32 v36, 16, v18
v_and_b32 v37, s56, v18
v_lshlrev_b32 v38, 16, v19
v_and_b32 v39, s56, v19
s_waitcnt vmcnt(7)
v_lshlrev_b32 v40, 16, v20
v_and_b32 v41, s56, v20
v_lshlrev_b32 v42, 16, v21
v_and_b32 v43, s56, v21
v_lshlrev_b32 v44, 16, v22
v_and_b32 v45, s56, v22
v_lshlrev_b32 v46, 16, v23
v_and_b32 v47, s56, v23
s_waitcnt vmcnt(6)
v_lshlrev_b32 v48, 16, v24
v_and_b32 v49, s56, v24
v_lshlrev_b32 v50, 16, v25
v_and_b32 v51, s56, v25
v_lshlrev_b32 v52, 16, v26
v_and_b32 v53, s56, v26
v_lshlrev_b32 v54, 16, v27
v_and_b32 v55, s56, v27
s_waitcnt vmcnt(5)
v_lshlrev_b32 v56, 16, v28
v_and_b32 v57, s56, v28
v_lshlrev_b32 v58, 16, v29
v_and_b32 v59, s56, v29
v_lshlrev_b32 v60, 16, v30
v_and_b32 v61, s56, v30
v_lshlrev_b32 v62, 16, v31
v_and_b32 v63, s56, v31
v_add_f32 v96, v32, v33
v_add_f32 v97, v40, v41
v_add_f32 v98, v48, v49
v_add_f32 v99, v56, v57
v_add_f32 v96, v96, v34
v_add_f32 v97, v97, v42
v_add_f32 v98, v98, v50
v_add_f32 v99, v99, v58
v_add_f32 v96, v96, v35
v_add_f32 v97, v97, v43
v_add_f32 v98, v98, v51
v_add_f32 v99, v99, v59
v_add_f32 v96, v96, v36
v_add_f32 v97, v97, v44
v_add_f32 v98, v98, v52
v_add_f32 v99, v99, v60
v_add_f32 v96, v96, v37
v_add_f32 v97, v97, v45
v_add_f32 v98, v98, v53
v_add_f32 v99, v99, v61
v_add_f32 v96, v96, v38
v_add_f32 v97, v97, v46
v_add_f32 v98, v98, v54
v_add_f32 v99, v99, v62
v_add_f32 v96, v96, v39
v_add_f32 v97, v97, v47
v_add_f32 v98, v98, v55
v_add_f32 v99, v99, v63
v_add_f32_dpp v96, v96, v96 row_ror:1 row_mask:0xf bank_mask:0xf
v_add_f32_dpp v97, v97, v97 row_ror:1 row_mask:0xf bank_mask:0xf
v_add_f32_dpp v98, v98, v98 row_ror:1 row_mask:0xf bank_mask:0xf
v_add_f32_dpp v99, v99, v99 row_ror:1 row_mask:0xf bank_mask:0xf
v_add_f32_dpp v96, v96, v96 row_ror:2 row_mask:0xf bank_mask:0xf
v_add_f32_dpp v97, v97, v97 row_ror:2 row_mask:0xf bank_mask:0xf
v_add_f32_dpp v98, v98, v98 row_ror:2 row_mask:0xf bank_mask:0xf
v_add_f32_dpp v99, v99, v99 row_ror:2 row_mask:0xf bank_mask:0xf
v_add_f32_dpp v96, v96, v96 row_ror:4 row_mask:0xf bank_mask:0xf
v_add_f32_dpp v97, v97, v97 row_ror:4 row_mask:0xf bank_mask:0xf
v_add_f32_dpp v98, v98, v98 row_ror:4 row_mask:0xf bank_mask:0xf
v_add_f32_dpp v99, v99, v99 row_ror:4 row_mask:0xf bank_mask:0xf
v_add_f32_dpp v96, v96, v96 row_ror:8 row_mask:0xf bank_mask:0xf
v_add_f32_dpp v97, v97, v97 row_ror:8 row_mask:0xf bank_mask:0xf
v_add_f32_dpp v98, v98, v98 row_ror:8 row_mask:0xf bank_mask:0xf
v_add_f32_dpp v99, v99, v99 row_ror:8 row_mask:0xf bank_mask:0xf
v_mov_b32 v104, v96
v_mov_b32 v105, v97
v_mov_b32 v106, v98
v_mov_b32 v107, v99
v_permlane16_swap_b32 v96, v104
v_permlane16_swap_b32 v97, v105
v_permlane16_swap_b32 v98, v106
v_permlane16_swap_b32 v99, v107
v_add_f32 v96, v96, v104
v_add_f32 v97, v97, v105
v_add_f32 v98, v98, v106
v_add_f32 v99, v99, v107
v_mov_b32 v104, v96
v_mov_b32 v105, v97
v_mov_b32 v106, v98
v_mov_b32 v107, v99
v_permlane32_swap_b32 v96, v104
v_permlane32_swap_b32 v97, v105
v_permlane32_swap_b32 v98, v106
v_permlane32_swap_b32 v99, v107
v_add_f32 v96, v96, v104
v_add_f32 v97, v97, v105
v_add_f32 v98, v98, v106
v_add_f32 v99, v99, v107
v_mul_f32 v96, s57, v96
v_mul_f32 v97, s57, v97
v_mul_f32 v98, s57, v98
v_mul_f32 v99, s57, v99
v_sub_f32 v64, v32, v96
v_sub_f32 v65, v33, v96
v_sub_f32 v66, v34, v96
v_sub_f32 v67, v35, v96
v_sub_f32 v68, v36, v96
v_sub_f32 v69, v37, v96
v_sub_f32 v70, v38, v96
v_sub_f32 v71, v39, v96
v_sub_f32 v72, v40, v97
v_sub_f32 v73, v41, v97
v_sub_f32 v74, v42, v97
v_sub_f32 v75, v43, v97
v_sub_f32 v76, v44, v97
v_sub_f32 v77, v45, v97
v_sub_f32 v78, v46, v97
v_sub_f32 v79, v47, v97
v_sub_f32 v80, v48, v98
v_sub_f32 v81, v49, v98
v_sub_f32 v82, v50, v98
v_sub_f32 v83, v51, v98
v_sub_f32 v84, v52, v98
v_sub_f32 v85, v53, v98
v_sub_f32 v86, v54, v98
v_sub_f32 v87, v55, v98
v_sub_f32 v88, v56, v99
v_sub_f32 v89, v57, v99
v_sub_f32 v90, v58, v99
v_sub_f32 v91, v59, v99
v_sub_f32 v92, v60, v99
v_sub_f32 v93, v61, v99
v_sub_f32 v94, v62, v99
v_sub_f32 v95, v63, v99
v_mul_f32 v100, v64, v64
v_mul_f32 v101, v72, v72
v_mul_f32 v102, v80, v80
v_mul_f32 v103, v88, v88
v_fmac_f32 v100, v65, v65
v_fmac_f32 v101, v73, v73
v_fmac_f32 v102, v81, v81
v_fmac_f32 v103, v89, v89
v_fmac_f32 v100, v66, v66
v_fmac_f32 v101, v74, v74
v_fmac_f32 v102, v82, v82
v_fmac_f32 v103, v90, v90
v_fmac_f32 v100, v67, v67
v_fmac_f32 v101, v75, v75
v_fmac_f32 v102, v83, v83
v_fmac_f32 v103, v91, v91
v_fmac_f32 v100, v68, v68
v_fmac_f32 v101, v76, v76
v_fmac_f32 v102, v84, v84
v_fmac_f32 v103, v92, v92
v_fmac_f32 v100, v69, v69
v_fmac_f32 v101, v77, v77
v_fmac_f32 v102, v85, v85
v_fmac_f32 v103, v93, v93
v_fmac_f32 v100, v70, v70
v_fmac_f32 v101, v78, v78
v_fmac_f32 v102, v86, v86
v_fmac_f32 v103, v94, v94
v_fmac_f32 v100, v71, v71
v_fmac_f32 v101, v79, v79
v_fmac_f32 v102, v87, v87
v_fmac_f32 v103, v95, v95
v_add_f32_dpp v100, v100, v100 row_ror:1 row_mask:0xf bank_mask:0xf
v_add_f32_dpp v101, v101, v101 row_ror:1 row_mask:0xf bank_mask:0xf
v_add_f32_dpp v102, v102, v102 row_ror:1 row_mask:0xf bank_mask:0xf
v_add_f32_dpp v103, v103, v103 row_ror:1 row_mask:0xf bank_mask:0xf
v_add_f32_dpp v100, v100, v100 row_ror:2 row_mask:0xf bank_mask:0xf
v_add_f32_dpp v101, v101, v101 row_ror:2 row_mask:0xf bank_mask:0xf
v_add_f32_dpp v102, v102, v102 row_ror:2 row_mask:0xf bank_mask:0xf
v_add_f32_dpp v103, v103, v103 row_ror:2 row_mask:0xf bank_mask:0xf
v_add_f32_dpp v100, v100, v100 row_ror:4 row_mask:0xf bank_mask:0xf
v_add_f32_dpp v101, v101, v101 row_ror:4 row_mask:0xf bank_mask:0xf
v_add_f32_dpp v102, v102, v102 row_ror:4 row_mask:0xf bank_mask:0xf
v_add_f32_dpp v103, v103, v103 row_ror:4 row_mask:0xf bank_mask:0xf
v_add_f32_dpp v100, v100, v100 row_ror:8 row_mask:0xf bank_mask:0xf
v_add_f32_dpp v101, v101, v101 row_ror:8 row_mask:0xf bank_mask:0xf
v_add_f32_dpp v102, v102, v102 row_ror:8 row_mask:0xf bank_mask:0xf
v_add_f32_dpp v103, v103, v103 row_ror:8 row_mask:0xf bank_mask:0xf
v_mov_b32 v104, v100
v_mov_b32 v105, v101
v_mov_b32 v106, v102
v_mov_b32 v107, v103
v_permlane16_swap_b32 v100, v104
v_permlane16_swap_b32 v101, v105
v_permlane16_swap_b32 v102, v106
v_permlane16_swap_b32 v103, v107
v_add_f32 v100, v100, v104
v_add_f32 v101, v101, v105
v_add_f32 v102, v102, v106
v_add_f32 v103, v103, v107
v_mov_b32 v104, v100
v_mov_b32 v105, v101
v_mov_b32 v106, v102
v_mov_b32 v107, v103
v_permlane32_swap_b32 v100, v104
v_permlane32_swap_b32 v101, v105
v_permlane32_swap_b32 v102, v106
v_permlane32_swap_b32 v103, v107
v_add_f32 v100, v100, v104
v_add_f32 v101, v101, v105
v_add_f32 v102, v102, v106
v_add_f32 v103, v103, v107
v_mul_f32 v100, s57, v100
v_cvt_pk_bf16_f32 v100, v100, v100
v_lshlrev_b32 v100, 16, v100
v_cvt_pk_bf16_f32 v96, v96, v96
v_lshlrev_b32 v96, 16, v96
v_add_f32 v100, s58, v100
v_cvt_pk_bf16_f32 v100, v100, v100
v_lshlrev_b32 v100, 16, v100
v_sqrt_f32 v100, v100
s_nop 0
v_cvt_pk_bf16_f32 v100, v100, v100
v_lshlrev_b32 v100, 16, v100
v_rcp_f32 v104, v100
v_mul_f32 v101, s57, v101
v_cvt_pk_bf16_f32 v101, v101, v101
v_lshlrev_b32 v101, 16, v101
v_cvt_pk_bf16_f32 v97, v97, v97
v_lshlrev_b32 v97, 16, v97
v_add_f32 v101, s58, v101
v_cvt_pk_bf16_f32 v101, v101, v101
v_lshlrev_b32 v101, 16, v101
v_sqrt_f32 v101, v101
s_nop 0
v_cvt_pk_bf16_f32 v101, v101, v101
v_lshlrev_b32 v101, 16, v101
v_rcp_f32 v105, v101
v_mul_f32 v102, s57, v102
v_cvt_pk_bf16_f32 v102, v102, v102
v_lshlrev_b32 v102, 16, v102
v_cvt_pk_bf16_f32 v98, v98, v98
v_lshlrev_b32 v98, 16, v98
v_add_f32 v102, s58, v102
v_cvt_pk_bf16_f32 v102, v102, v102
v_lshlrev_b32 v102, 16, v102
v_sqrt_f32 v102, v102
s_nop 0
v_cvt_pk_bf16_f32 v102, v102, v102
v_lshlrev_b32 v102, 16, v102
v_rcp_f32 v106, v102
v_mul_f32 v103, s57, v103
v_cvt_pk_bf16_f32 v103, v103, v103
v_lshlrev_b32 v103, 16, v103
v_cvt_pk_bf16_f32 v99, v99, v99
v_lshlrev_b32 v99, 16, v99
v_add_f32 v103, s58, v103
v_cvt_pk_bf16_f32 v103, v103, v103
v_lshlrev_b32 v103, 16, v103
v_sqrt_f32 v103, v103
s_nop 0
v_cvt_pk_bf16_f32 v103, v103, v103
v_lshlrev_b32 v103, 16, v103
v_rcp_f32 v107, v103
v_sub_f32 v32, v32, v96
v_sub_f32 v33, v33, v96
v_sub_f32 v34, v34, v96
v_sub_f32 v35, v35, v96
v_sub_f32 v36, v36, v96
v_sub_f32 v37, v37, v96
v_sub_f32 v38, v38, v96
v_sub_f32 v39, v39, v96
v_cvt_pk_bf16_f32 v108, v32, v33
v_lshlrev_b32 v32, 16, v108
v_and_b32 v33, s56, v108
v_cvt_pk_bf16_f32 v108, v34, v35
v_lshlrev_b32 v34, 16, v108
v_and_b32 v35, s56, v108
v_cvt_pk_bf16_f32 v108, v36, v37
v_lshlrev_b32 v36, 16, v108
v_and_b32 v37, s56, v108
v_cvt_pk_bf16_f32 v108, v38, v39
v_lshlrev_b32 v38, 16, v108
v_and_b32 v39, s56, v108
v_mul_f32 v64, v32, v104
v_mul_f32 v65, v33, v104
v_mul_f32 v66, v34, v104
v_mul_f32 v67, v35, v104
v_mul_f32 v68, v36, v104
v_mul_f32 v69, v37, v104
v_mul_f32 v70, v38, v104
v_mul_f32 v71, v39, v104
v_fma_f32 v32, -v64, v100, v32
v_fma_f32 v33, -v65, v100, v33
v_fma_f32 v34, -v66, v100, v34
v_fma_f32 v35, -v67, v100, v35
v_fma_f32 v36, -v68, v100, v36
v_fma_f32 v37, -v69, v100, v37
v_fma_f32 v38, -v70, v100, v38
v_fma_f32 v39, -v71, v100, v39
v_fmac_f32 v64, v32, v104
v_fmac_f32 v65, v33, v104
v_fmac_f32 v66, v34, v104
v_fmac_f32 v67, v35, v104
v_fmac_f32 v68, v36, v104
v_fmac_f32 v69, v37, v104
v_fmac_f32 v70, v38, v104
v_fmac_f32 v71, v39, v104
v_cvt_pk_bf16_f32 v16, v64, v65
v_cvt_pk_bf16_f32 v17, v66, v67
v_cvt_pk_bf16_f32 v18, v68, v69
v_cvt_pk_bf16_f32 v19, v70, v71
v_sub_f32 v40, v40, v97
v_sub_f32 v41, v41, v97
v_sub_f32 v42, v42, v97
v_sub_f32 v43, v43, v97
v_sub_f32 v44, v44, v97
v_sub_f32 v45, v45, v97
v_sub_f32 v46, v46, v97
v_sub_f32 v47, v47, v97
v_cvt_pk_bf16_f32 v108, v40, v41
v_lshlrev_b32 v40, 16, v108
v_and_b32 v41, s56, v108
v_cvt_pk_bf16_f32 v108, v42, v43
v_lshlrev_b32 v42, 16, v108
v_and_b32 v43, s56, v108
v_cvt_pk_bf16_f32 v108, v44, v45
v_lshlrev_b32 v44, 16, v108
v_and_b32 v45, s56, v108
v_cvt_pk_bf16_f32 v108, v46, v47
v_lshlrev_b32 v46, 16, v108
v_and_b32 v47, s56, v108
v_mul_f32 v72, v40, v105
v_mul_f32 v73, v41, v105
v_mul_f32 v74, v42, v105
v_mul_f32 v75, v43, v105
v_mul_f32 v76, v44, v105
v_mul_f32 v77, v45, v105
v_mul_f32 v78, v46, v105
v_mul_f32 v79, v47, v105
v_fma_f32 v40, -v72, v101, v40
v_fma_f32 v41, -v73, v101, v41
v_fma_f32 v42, -v74, v101, v42
v_fma_f32 v43, -v75, v101, v43
v_fma_f32 v44, -v76, v101, v44
v_fma_f32 v45, -v77, v101, v45
v_fma_f32 v46, -v78, v101, v46
v_fma_f32 v47, -v79, v101, v47
v_fmac_f32 v72, v40, v105
v_fmac_f32 v73, v41, v105
v_fmac_f32 v74, v42, v105
v_fmac_f32 v75, v43, v105
v_fmac_f32 v76, v44, v105
v_fmac_f32 v77, v45, v105
v_fmac_f32 v78, v46, v105
v_fmac_f32 v79, v47, v105
v_cvt_pk_bf16_f32 v20, v72, v73
v_cvt_pk_bf16_f32 v21, v74, v75
v_cvt_pk_bf16_f32 v22, v76, v77
v_cvt_pk_bf16_f32 v23, v78, v79
v_sub_f32 v48, v48, v98
v_sub_f32 v49, v49, v98
v_sub_f32 v50, v50, v98
v_sub_f32 v51, v51, v98
v_sub_f32 v52, v52, v98
v_sub_f32 v53, v53, v98
v_sub_f32 v54, v54, v98
v_sub_f32 v55, v55, v98
v_cvt_pk_bf16_f32 v108, v48, v49
v_lshlrev_b32 v48, 16, v108
v_and_b32 v49, s56, v108
v_cvt_pk_bf16_f32 v108, v50, v51
v_lshlrev_b32 v50, 16, v108
v_and_b32 v51, s56, v108
v_cvt_pk_bf16_f32 v108, v52, v53
v_lshlrev_b32 v52, 16, v108
v_and_b32 v53, s56, v108
v_cvt_pk_bf16_f32 v108, v54, v55
v_lshlrev_b32 v54, 16, v108
v_and_b32 v55, s56, v108
v_mul_f32 v80, v48, v106
v_mul_f32 v81, v49, v106
v_mul_f32 v82, v50, v106
v_mul_f32 v83, v51, v106
v_mul_f32 v84, v52, v106
v_mul_f32 v85, v53, v106
v_mul_f32 v86, v54, v106
v_mul_f32 v87, v55, v106
v_fma_f32 v48, -v80, v102, v48
v_fma_f32 v49, -v81, v102, v49
v_fma_f32 v50, -v82, v102, v50
v_fma_f32 v51, -v83, v102, v51
v_fma_f32 v52, -v84, v102, v52
v_fma_f32 v53, -v85, v102, v53
v_fma_f32 v54, -v86, v102, v54
v_fma_f32 v55, -v87, v102, v55
v_fmac_f32 v80, v48, v106
v_fmac_f32 v81, v49, v106
v_fmac_f32 v82, v50, v106
v_fmac_f32 v83, v51, v106
v_fmac_f32 v84, v52, v106
v_fmac_f32 v85, v53, v106
v_fmac_f32 v86, v54, v106
v_fmac_f32 v87, v55, v106
v_cvt_pk_bf16_f32 v24, v80, v81
v_cvt_pk_bf16_f32 v25, v82, v83
v_cvt_pk_bf16_f32 v26, v84, v85
v_cvt_pk_bf16_f32 v27, v86, v87
v_sub_f32 v56, v56, v99
v_sub_f32 v57, v57, v99
v_sub_f32 v58, v58, v99
v_sub_f32 v59, v59, v99
v_sub_f32 v60, v60, v99
v_sub_f32 v61, v61, v99
v_sub_f32 v62, v62, v99
v_sub_f32 v63, v63, v99
v_cvt_pk_bf16_f32 v108, v56, v57
v_lshlrev_b32 v56, 16, v108
v_and_b32 v57, s56, v108
v_cvt_pk_bf16_f32 v108, v58, v59
v_lshlrev_b32 v58, 16, v108
v_and_b32 v59, s56, v108
v_cvt_pk_bf16_f32 v108, v60, v61
v_lshlrev_b32 v60, 16, v108
v_and_b32 v61, s56, v108
v_cvt_pk_bf16_f32 v108, v62, v63
v_lshlrev_b32 v62, 16, v108
v_and_b32 v63, s56, v108
v_mul_f32 v88, v56, v107
v_mul_f32 v89, v57, v107
v_mul_f32 v90, v58, v107
v_mul_f32 v91, v59, v107
v_mul_f32 v92, v60, v107
v_mul_f32 v93, v61, v107
v_mul_f32 v94, v62, v107
v_mul_f32 v95, v63, v107
v_fma_f32 v56, -v88, v103, v56
v_fma_f32 v57, -v89, v103, v57
v_fma_f32 v58, -v90, v103, v58
v_fma_f32 v59, -v91, v103, v59
v_fma_f32 v60, -v92, v103, v60
v_fma_f32 v61, -v93, v103, v61
v_fma_f32 v62, -v94, v103, v62
v_fma_f32 v63, -v95, v103, v63
v_fmac_f32 v88, v56, v107
v_fmac_f32 v89, v57, v107
v_fmac_f32 v90, v58, v107
v_fmac_f32 v91, v59, v107
v_fmac_f32 v92, v60, v107
v_fmac_f32 v93, v61, v107
v_fmac_f32 v94, v62, v107
v_fmac_f32 v95, v63, v107
v_cvt_pk_bf16_f32 v28, v88, v89
v_cvt_pk_bf16_f32 v29, v90, v91
v_cvt_pk_bf16_f32 v30, v92, v93
v_cvt_pk_bf16_f32 v31, v94, v95
v_lshlrev_b32 v2, 8, v0
s_lshl_b32 s55, s32, 6
v_add_u32 v2, s55, v2
ds_write_b128 v2, v[16:19] offset:0
ds_write_b128 v2, v[20:23] offset:16
ds_write_b128 v2, v[24:27] offset:32
ds_write_b128 v2, v[28:31] offset:48
s_waitcnt lgkmcnt(0)
s_barrier
s_lshl_b32 s55, s32, 12
v_add_u32 v2, s55, v1
ds_read_b128 v[16:19], v2 offset:0
ds_read_b128 v[20:23], v2 offset:1024
ds_read_b128 v[24:27], v2 offset:2048
ds_read_b128 v[28:31], v2 offset:3072
s_waitcnt lgkmcnt(3)
buffer_store_dwordx4 v[16:19], v1, s[36:39], s54 offen offset:0 sc1
s_waitcnt lgkmcnt(2)
buffer_store_dwordx4 v[20:23], v1, s[36:39], s54 offen offset:1024 sc1
s_waitcnt lgkmcnt(1)
buffer_store_dwordx4 v[24:27], v1, s[36:39], s54 offen offset:2048 sc1
s_waitcnt lgkmcnt(0)
buffer_store_dwordx4 v[28:31], v1, s[36:39], s54 offen offset:3072 sc1
s_waitcnt vmcnt(0)
s_barrier
s_cmp_lg_u32 s32, 0
s_cbranch_scc1 L_noln
v_mov_b32 v2, 192
v_mov_b32 v3, 1
s_mov_b64 exec, 1
global_atomic_add v2, v3, s[28:29]
s_mov_b64 exec, -1
s_branch L_noln
L_skipln:
L_noln:
s_waitcnt vmcnt(0)
s_mov_b32 s40, s10
s_and_b32 s41, s11, 0xffff
s_mov_b32 s42, 0x400000
s_mov_b32 s43, 0x20000
s_mov_b32 s44, s12
s_and_b32 s45, s13, 0xffff
s_mov_b32 s46, 0x400000
s_mov_b32 s47, 0x20000
s_mov_b32 s48, s8
s_and_b32 s49, s9, 0xffff
s_mov_b32 s50, 0x400000
s_mov_b32 s51, 0x20000
s_cmp_lt_u32 s63, 3
s_cbranch_scc1 L_two_1
s_mov_b32 s84, s14
s_and_b32 s85, s15, 0xffff
s_mov_b32 s86, 0x400000
s_mov_b32 s87, 0x20000
s_lshl_b32 s54, s61, 2
s_add_u32 s54, s54, s32
s_lshl_b32 s54, s54, 13
v_lshlrev_b32 v120, 7, v0
buffer_load_dword v121, v120, s[84:87], s54 offen
L_two_1:
s_cmp_eq_u32 s63, 6
s_cbranch_scc1 L_side
s_lshl_b32 s54, s62, 8
v_lshrrev_b32 v3, 4, v0
v_and_b32 v4, 15, v0
v_mul_u32_u24 v5, 8192, v3
v_lshlrev_b32 v2, 4, v4
s_mul_i32 s55, s32, 131072
s_add_u32 s54, s54, s55
v_add3_u32 v1, v5, v2, s54
v_xor_b32 v2, 64, v2
v_add3_u32 v2, v5, v2, s54
v_lshlrev_b32 v4, 2, v4
s_lshl_b32 s54, s32, 6
v_add_u32 v4, s54, v4
v_and_b32 v5, 1, v3
v_lshlrev_b32 v5, 6, v5
v_xor_b32 v4, v4, v5
v_lshlrev_b32 v3, 11, v3
v_add_u32 v3, v3, v4
v_add_u32 v4, 0x10000, v3
s_lshl_b32 s56, s32, 12
s_barrier
s_add_u32 m0, s56, 0
s_mov_b32 s54, 0
buffer_load_dwordx4 v1, s[40:43], s54 offen offset:0 lds
s_mov_b32 s54, 31744
buffer_load_dwordx4 v1, s[40:43], s54 offen offset:1024 lds
s_mov_b32 s54, 63488
buffer_load_dwordx4 v2, s[40:43], s54 offen offset:2048 lds
s_mov_b32 s54, 95232
buffer_load_dwordx4 v2, s[40:43], s54 offen offset:3072 lds
s_add_u32 m0, s56, 16384
s_mov_b32 s54, 524288
buffer_load_dwordx4 v1, s[40:43], s54 offen offset:0 lds
s_mov_b32 s54, 556032
buffer_load_dwordx4 v1, s[40:43], s54 offen offset:1024 lds
s_mov_b32 s54, 587776
buffer_load_dwordx4 v2, s[40:43], s54 offen offset:2048 lds
s_mov_b32 s54, 619520
buffer_load_dwordx4 v2, s[40:43], s54 offen offset:3072 lds
s_add_u32 m0, s56, 32768
s_mov_b32 s54, 1048576
buffer_load_dwordx4 v1, s[40:43], s54 offen offset:0 lds
s_mov_b32 s54, 1080320
buffer_load_dwordx4 v1, s[40:43], s54 offen offset:1024 lds
s_mov_b32 s54, 1112064
buffer_load_dwordx4 v2, s[40:43], s54 offen offset:2048 lds
s_mov_b32 s54, 1143808
buffer_load_dwordx4 v2, s[40:43], s54 offen offset:3072 lds
s_add_u32 m0, s56, 49152
s_mov_b32 s54, 1572864
buffer_load_dwordx4 v1, s[40:43], s54 offen offset:0 lds
s_mov_b32 s54, 1604608
buffer_load_dwordx4 v1, s[40:43], s54 offen offset:1024 lds
s_mov_b32 s54, 1636352
buffer_load_dwordx4 v2, s[40:43], s54 offen offset:2048 lds
s_mov_b32 s54, 1668096
buffer_load_dwordx4 v2, s[40:43], s54 offen offset:3072 lds
s_add_u32 m0, s56, 65536
s_mov_b32 s54, 2097152
buffer_load_dwordx4 v1, s[40:43], s54 offen offset:0 lds
s_mov_b32 s54, 2128896
buffer_load_dwordx4 v1, s[40:43], s54 offen offset:1024 lds
s_mov_b32 s54, 2160640
buffer_load_dwordx4 v2, s[40:43], s54 offen offset:2048 lds
s_mov_b32 s54, 2192384
buffer_load_dwordx4 v2, s[40:43], s54 offen offset:3072 lds
s_waitcnt vmcnt(16)
s_barrier
s_add_u32 m0, s56, 81920
s_mov_b32 s54, 2621440
buffer_load_dwordx4 v1, s[40:43], s54 offen offset:0 lds
s_mov_b32 s54, 2653184
buffer_load_dwordx4 v1, s[40:43], s54 offen offset:1024 lds
s_mov_b32 s54, 2684928
buffer_load_dwordx4 v2, s[40:43], s54 offen offset:2048 lds
s_mov_b32 s54, 2716672
buffer_load_dwordx4 v2, s[40:43], s54 offen offset:3072 lds
ds_read2st64_b32 v[16:17], v3 offset0:0 offset1:1
ds_read2st64_b32 v[18:19], v3 offset0:2 offset1:3
ds_read2st64_b32 v[20:21], v3 offset0:4 offset1:5
ds_read2st64_b32 v[22:23], v3 offset0:6 offset1:7
ds_read2st64_b32 v[24:25], v3 offset0:32 offset1:33
ds_read2st64_b32 v[26:27], v3 offset0:34 offset1:35
ds_read2st64_b32 v[28:29], v3 offset0:36 offset1:37
ds_read2st64_b32 v[30:31], v3 offset0:38 offset1:39
s_waitcnt lgkmcnt(7)
v_perm_b32 v48, v17, v16, s52
v_accvgpr_write_b32 a0, v48
v_perm_b32 v49, v17, v16, s53
v_accvgpr_write_b32 a4, v49
s_waitcnt lgkmcnt(6)
v_perm_b32 v48, v19, v18, s52
v_accvgpr_write_b32 a1, v48
v_perm_b32 v49, v19, v18, s53
v_accvgpr_write_b32 a5, v49
s_waitcnt lgkmcnt(5)
v_perm_b32 v48, v21, v20, s52
v_accvgpr_write_b32 a2, v48
v_perm_b32 v49, v21, v20, s53
v_accvgpr_write_b32 a6, v49
s_waitcnt lgkmcnt(4)
v_perm_b32 v48, v23, v22, s52
v_accvgpr_write_b32 a3, v48
v_perm_b32 v49, v23, v22, s53
v_accvgpr_write_b32 a7, v49
s_waitcnt lgkmcnt(3)
v_perm_b32 v48, v25, v24, s52
v_accvgpr_write_b32 a8, v48
v_perm_b32 v49, v25, v24, s53
v_accvgpr_write_b32 a12, v49
s_waitcnt lgkmcnt(2)
v_perm_b32 v48, v27, v26, s52
v_accvgpr_write_b32 a9, v48
v_perm_b32 v49, v27, v26, s53
v_accvgpr_write_b32 a13, v49
s_waitcnt lgkmcnt(1)
v_perm_b32 v48, v29, v28, s52
v_accvgpr_write_b32 a10, v48
v_perm_b32 v49, v29, v28, s53
v_accvgpr_write_b32 a14, v49
s_waitcnt lgkmcnt(0)
v_perm_b32 v48, v31, v30, s52
v_accvgpr_write_b32 a11, v48
v_perm_b32 v49, v31, v30, s53
v_accvgpr_write_b32 a15, v49
s_waitcnt vmcnt(16)
s_barrier
s_add_u32 m0, s56, 98304
s_mov_b32 s54, 3145728
buffer_load_dwordx4 v1, s[40:43], s54 offen offset:0 lds
s_mov_b32 s54, 3177472
buffer_load_dwordx4 v1, s[40:43], s54 offen offset:1024 lds
s_mov_b32 s54, 3209216
buffer_load_dwordx4 v2, s[40:43], s54 offen offset:2048 lds
s_mov_b32 s54, 3240960
buffer_load_dwordx4 v2, s[40:43], s54 offen offset:3072 lds
ds_read2st64_b32 v[32:33], v3 offset0:64 offset1:65
ds_read2st64_b32 v[34:35], v3 offset0:66 offset1:67
ds_read2st64_b32 v[36:37], v3 offset0:68 offset1:69
ds_read2st64_b32 v[38:39], v3 offset0:70 offset1:71
ds_read2st64_b32 v[40:41], v3 offset0:96 offset1:97
ds_read2st64_b32 v[42:43], v3 offset0:98 offset1:99
ds_read2st64_b32 v[44:45], v3 offset0:100 offset1:101
ds_read2st64_b32 v[46:47], v3 offset0:102 offset1:103
s_waitcnt lgkmcnt(7)
v_perm_b32 v48, v33, v32, s52
v_accvgpr_write_b32 a16, v48
v_perm_b32 v49, v33, v32, s53
v_accvgpr_write_b32 a20, v49
s_waitcnt lgkmcnt(6)
v_perm_b32 v48, v35, v34, s52
v_accvgpr_write_b32 a17, v48
v_perm_b32 v49, v35, v34, s53
v_accvgpr_write_b32 a21, v49
s_waitcnt lgkmcnt(5)
v_perm_b32 v48, v37, v36, s52
v_accvgpr_write_b32 a18, v48
v_perm_b32 v49, v37, v36, s53
v_accvgpr_write_b32 a22, v49
s_waitcnt lgkmcnt(4)
v_perm_b32 v48, v39, v38, s52
v_accvgpr_write_b32 a19, v48
v_perm_b32 v49, v39, v38, s53
v_accvgpr_write_b32 a23, v49
s_waitcnt lgkmcnt(3)
v_perm_b32 v48, v41, v40, s52
v_accvgpr_write_b32 a24, v48
v_perm_b32 v49, v41, v40, s53
v_accvgpr_write_b32 a28, v49
s_waitcnt lgkmcnt(2)
v_perm_b32 v48, v43, v42, s52
v_accvgpr_write_b32 a25, v48
v_perm_b32 v49, v43, v42, s53
v_accvgpr_write_b32 a29, v49
s_waitcnt lgkmcnt(1)
v_perm_b32 v48, v45, v44, s52
v_accvgpr_write_b32 a26, v48
v_perm_b32 v49, v45, v44, s53
v_accvgpr_write_b32 a30, v49
s_waitcnt lgkmcnt(0)
v_perm_b32 v48, v47, v46, s52
v_accvgpr_write_b32 a27, v48
v_perm_b32 v49, v47, v46, s53
v_accvgpr_write_b32 a31, v49
s_waitcnt vmcnt(16)
s_barrier
s_add_u32 m0, s56, 114688
s_mov_b32 s54, 3670016
buffer_load_dwordx4 v1, s[40:43], s54 offen offset:0 lds
s_mov_b32 s54, 3701760
buffer_load_dwordx4 v1, s[40:43], s54 offen offset:1024 lds
s_mov_b32 s54, 3733504
buffer_load_dwordx4 v2, s[40:43], s54 offen offset:2048 lds
s_mov_b32 s54, 3765248
buffer_load_dwordx4 v2, s[40:43], s54 offen offset:3072 lds
ds_read2st64_b32 v[16:17], v3 offset0:128 offset1:129
ds_read2st64_b32 v[18:19], v3 offset0:130 offset1:131
ds_read2st64_b32 v[20:21], v3 offset0:132 offset1:133
ds_read2st64_b32 v[22:23], v3 offset0:134 offset1:135
ds_read2st64_b32 v[24:25], v3 offset0:160 offset1:161
ds_read2st64_b32 v[26:27], v3 offset0:162 offset1:163
ds_read2st64_b32 v[28:29], v3 offset0:164 offset1:165
ds_read2st64_b32 v[30:31], v3 offset0:166 offset1:167
s_waitcnt lgkmcnt(7)
v_perm_b32 v48, v17, v16, s52
v_accvgpr_write_b32 a32, v48
v_perm_b32 v49, v17, v16, s53
v_accvgpr_write_b32 a36, v49
s_waitcnt lgkmcnt(6)
v_perm_b32 v48, v19, v18, s52
v_accvgpr_write_b32 a33, v48
v_perm_b32 v49, v19, v18, s53
v_accvgpr_write_b32 a37, v49
s_waitcnt lgkmcnt(5)
v_perm_b32 v48, v21, v20, s52
v_accvgpr_write_b32 a34, v48
v_perm_b32 v49, v21, v20, s53
v_accvgpr_write_b32 a38, v49
s_waitcnt lgkmcnt(4)
v_perm_b32 v48, v23, v22, s52
v_accvgpr_write_b32 a35, v48
v_perm_b32 v49, v23, v22, s53
v_accvgpr_write_b32 a39, v49
s_waitcnt lgkmcnt(3)
v_perm_b32 v48, v25, v24, s52
v_accvgpr_write_b32 a40, v48
v_perm_b32 v49, v25, v24, s53
v_accvgpr_write_b32 a44, v49
s_waitcnt lgkmcnt(2)
v_perm_b32 v48, v27, v26, s52
v_accvgpr_write_b32 a41, v48
v_perm_b32 v49, v27, v26, s53
v_accvgpr_write_b32 a45, v49
s_waitcnt lgkmcnt(1)
v_perm_b32 v48, v29, v28, s52
v_accvgpr_write_b32 a42, v48
v_perm_b32 v49, v29, v28, s53
v_accvgpr_write_b32 a46, v49
s_waitcnt lgkmcnt(0)
v_perm_b32 v48, v31, v30, s52
v_accvgpr_write_b32 a43, v48
v_perm_b32 v49, v31, v30, s53
v_accvgpr_write_b32 a47, v49
s_waitcnt vmcnt(16)
s_barrier
s_add_u32 m0, s56, 0
s_mov_b32 s54, 0
buffer_load_dwordx4 v1, s[44:47], s54 offen offset:0 lds
s_mov_b32 s54, 31744
buffer_load_dwordx4 v1, s[44:47], s54 offen offset:1024 lds
s_mov_b32 s54, 63488
buffer_load_dwordx4 v2, s[44:47], s54 offen offset:2048 lds
s_mov_b32 s54, 95232
buffer_load_dwordx4 v2, s[44:47], s54 offen offset:3072 lds
ds_read2st64_b32 v[32:33], v3 offset0:192 offset1:193
ds_read2st64_b32 v[34:35], v3 offset0:194 offset1:195
ds_read2st64_b32 v[36:37], v3 offset0:196 offset1:197
ds_read2st64_b32 v[38:39], v3 offset0:198 offset1:199
ds_read2st64_b32 v[40:41], v3 offset0:224 offset1:225
ds_read2st64_b32 v[42:43], v3 offset0:226 offset1:227
ds_read2st64_b32 v[44:45], v3 offset0:228 offset1:229
ds_read2st64_b32 v[46:47], v3 offset0:230 offset1:231
s_waitcnt lgkmcnt(7)
v_perm_b32 v48, v33, v32, s52
v_accvgpr_write_b32 a48, v48
v_perm_b32 v49, v33, v32, s53
v_accvgpr_write_b32 a52, v49
s_waitcnt lgkmcnt(6)
v_perm_b32 v48, v35, v34, s52
v_accvgpr_write_b32 a49, v48
v_perm_b32 v49, v35, v34, s53
v_accvgpr_write_b32 a53, v49
s_waitcnt lgkmcnt(5)
v_perm_b32 v48, v37, v36, s52
v_accvgpr_write_b32 a50, v48
v_perm_b32 v49, v37, v36, s53
v_accvgpr_write_b32 a54, v49
s_waitcnt lgkmcnt(4)
v_perm_b32 v48, v39, v38, s52
v_accvgpr_write_b32 a51, v48
v_perm_b32 v49, v39, v38, s53
v_accvgpr_write_b32 a55, v49
s_waitcnt lgkmcnt(3)
v_perm_b32 v48, v41, v40, s52
v_accvgpr_write_b32 a56, v48
v_perm_b32 v49, v41, v40, s53
v_accvgpr_write_b32 a60, v49
s_waitcnt lgkmcnt(2)
v_perm_b32 v48, v43, v42, s52
v_accvgpr_write_b32 a57, v48
v_perm_b32 v49, v43, v42, s53
v_accvgpr_write_b32 a61, v49
s_waitcnt lgkmcnt(1)
v_perm_b32 v48, v45, v44, s52
v_accvgpr_write_b32 a58, v48
v_perm_b32 v49, v45, v44, s53
v_accvgpr_write_b32 a62, v49
s_waitcnt lgkmcnt(0)
v_perm_b32 v48, v47, v46, s52
v_accvgpr_write_b32 a59, v48
v_perm_b32 v49, v47, v46, s53
v_accvgpr_write_b32 a63, v49
s_waitcnt vmcnt(16)
s_barrier
s_add_u32 m0, s56, 16384
s_mov_b32 s54, 524288
buffer_load_dwordx4 v1, s[44:47], s54 offen offset:0 lds
s_mov_b32 s54, 556032
buffer_load_dwordx4 v1, s[44:47], s54 offen offset:1024 lds
s_mov_b32 s54, 587776
buffer_load_dwordx4 v2, s[44:47], s54 offen offset:2048 lds
s_mov_b32 s54, 619520
buffer_load_dwordx4 v2, s[44:47], s54 offen offset:3072 lds
ds_read2st64_b32 v[16:17], v4 offset0:0 offset1:1
ds_read2st64_b32 v[18:19], v4 offset0:2 offset1:3
ds_read2st64_b32 v[20:21], v4 offset0:4 offset1:5
ds_read2st64_b32 v[22:23], v4 offset0:6 offset1:7
ds_read2st64_b32 v[24:25], v4 offset0:32 offset1:33
ds_read2st64_b32 v[26:27], v4 offset0:34 offset1:35
ds_read2st64_b32 v[28:29], v4 offset0:36 offset1:37
ds_read2st64_b32 v[30:31], v4 offset0:38 offset1:39
s_waitcnt lgkmcnt(7)
v_perm_b32 v48, v17, v16, s52
v_accvgpr_write_b32 a64, v48
v_perm_b32 v49, v17, v16, s53
v_accvgpr_write_b32 a68, v49
s_waitcnt lgkmcnt(6)
v_perm_b32 v48, v19, v18, s52
v_accvgpr_write_b32 a65, v48
v_perm_b32 v49, v19, v18, s53
v_accvgpr_write_b32 a69, v49
s_waitcnt lgkmcnt(5)
v_perm_b32 v48, v21, v20, s52
v_accvgpr_write_b32 a66, v48
v_perm_b32 v49, v21, v20, s53
v_accvgpr_write_b32 a70, v49
s_waitcnt lgkmcnt(4)
v_perm_b32 v48, v23, v22, s52
v_accvgpr_write_b32 a67, v48
v_perm_b32 v49, v23, v22, s53
v_accvgpr_write_b32 a71, v49
s_waitcnt lgkmcnt(3)
v_perm_b32 v48, v25, v24, s52
v_accvgpr_write_b32 a72, v48
v_perm_b32 v49, v25, v24, s53
v_accvgpr_write_b32 a76, v49
s_waitcnt lgkmcnt(2)
v_perm_b32 v48, v27, v26, s52
v_accvgpr_write_b32 a73, v48
v_perm_b32 v49, v27, v26, s53
v_accvgpr_write_b32 a77, v49
s_waitcnt lgkmcnt(1)
v_perm_b32 v48, v29, v28, s52
v_accvgpr_write_b32 a74, v48
v_perm_b32 v49, v29, v28, s53
v_accvgpr_write_b32 a78, v49
s_waitcnt lgkmcnt(0)
v_perm_b32 v48, v31, v30, s52
v_accvgpr_write_b32 a75, v48
v_perm_b32 v49, v31, v30, s53
v_accvgpr_write_b32 a79, v49
s_waitcnt vmcnt(16)
s_barrier
s_add_u32 m0, s56, 32768
s_mov_b32 s54, 1048576
buffer_load_dwordx4 v1, s[44:47], s54 offen offset:0 lds
s_mov_b32 s54, 1080320
buffer_load_dwordx4 v1, s[44:47], s54 offen offset:1024 lds
s_mov_b32 s54, 1112064
buffer_load_dwordx4 v2, s[44:47], s54 offen offset:2048 lds
s_mov_b32 s54, 1143808
buffer_load_dwordx4 v2, s[44:47], s54 offen offset:3072 lds
ds_read2st64_b32 v[32:33], v4 offset0:64 offset1:65
ds_read2st64_b32 v[34:35], v4 offset0:66 offset1:67
ds_read2st64_b32 v[36:37], v4 offset0:68 offset1:69
ds_read2st64_b32 v[38:39], v4 offset0:70 offset1:71
ds_read2st64_b32 v[40:41], v4 offset0:96 offset1:97
ds_read2st64_b32 v[42:43], v4 offset0:98 offset1:99
ds_read2st64_b32 v[44:45], v4 offset0:100 offset1:101
ds_read2st64_b32 v[46:47], v4 offset0:102 offset1:103
s_waitcnt lgkmcnt(7)
v_perm_b32 v48, v33, v32, s52
v_accvgpr_write_b32 a80, v48
v_perm_b32 v49, v33, v32, s53
v_accvgpr_write_b32 a84, v49
s_waitcnt lgkmcnt(6)
v_perm_b32 v48, v35, v34, s52
v_accvgpr_write_b32 a81, v48
v_perm_b32 v49, v35, v34, s53
v_accvgpr_write_b32 a85, v49
s_waitcnt lgkmcnt(5)
v_perm_b32 v48, v37, v36, s52
v_accvgpr_write_b32 a82, v48
v_perm_b32 v49, v37, v36, s53
v_accvgpr_write_b32 a86, v49
s_waitcnt lgkmcnt(4)
v_perm_b32 v48, v39, v38, s52
v_accvgpr_write_b32 a83, v48
v_perm_b32 v49, v39, v38, s53
v_accvgpr_write_b32 a87, v49
s_waitcnt lgkmcnt(3)
v_perm_b32 v48, v41, v40, s52
v_accvgpr_write_b32 a88, v48
v_perm_b32 v49, v41, v40, s53
v_accvgpr_write_b32 a92, v49
s_waitcnt lgkmcnt(2)
v_perm_b32 v48, v43, v42, s52
v_accvgpr_write_b32 a89, v48
v_perm_b32 v49, v43, v42, s53
v_accvgpr_write_b32 a93, v49
s_waitcnt lgkmcnt(1)
v_perm_b32 v48, v45, v44, s52
v_accvgpr_write_b32 a90, v48
v_perm_b32 v49, v45, v44, s53
v_accvgpr_write_b32 a94, v49
s_waitcnt lgkmcnt(0)
v_perm_b32 v48, v47, v46, s52
v_accvgpr_write_b32 a91, v48
v_perm_b32 v49, v47, v46, s53
v_accvgpr_write_b32 a95, v49
s_waitcnt vmcnt(16)
s_barrier
s_add_u32 m0, s56, 49152
s_mov_b32 s54, 1572864
buffer_load_dwordx4 v1, s[44:47], s54 offen offset:0 lds
s_mov_b32 s54, 1604608
buffer_load_dwordx4 v1, s[44:47], s54 offen offset:1024 lds
s_mov_b32 s54, 1636352
buffer_load_dwordx4 v2, s[44:47], s54 offen offset:2048 lds
s_mov_b32 s54, 1668096
buffer_load_dwordx4 v2, s[44:47], s54 offen offset:3072 lds
ds_read2st64_b32 v[16:17], v4 offset0:128 offset1:129
ds_read2st64_b32 v[18:19], v4 offset0:130 offset1:131
ds_read2st64_b32 v[20:21], v4 offset0:132 offset1:133
ds_read2st64_b32 v[22:23], v4 offset0:134 offset1:135
ds_read2st64_b32 v[24:25], v4 offset0:160 offset1:161
ds_read2st64_b32 v[26:27], v4 offset0:162 offset1:163
ds_read2st64_b32 v[28:29], v4 offset0:164 offset1:165
ds_read2st64_b32 v[30:31], v4 offset0:166 offset1:167
s_waitcnt lgkmcnt(7)
v_perm_b32 v48, v17, v16, s52
v_accvgpr_write_b32 a96, v48
v_perm_b32 v49, v17, v16, s53
v_accvgpr_write_b32 a100, v49
s_waitcnt lgkmcnt(6)
v_perm_b32 v48, v19, v18, s52
v_accvgpr_write_b32 a97, v48
v_perm_b32 v49, v19, v18, s53
v_accvgpr_write_b32 a101, v49
s_waitcnt lgkmcnt(5)
v_perm_b32 v48, v21, v20, s52
v_accvgpr_write_b32 a98, v48
v_perm_b32 v49, v21, v20, s53
v_accvgpr_write_b32 a102, v49
s_waitcnt lgkmcnt(4)
v_perm_b32 v48, v23, v22, s52
v_accvgpr_write_b32 a99, v48
v_perm_b32 v49, v23, v22, s53
v_accvgpr_write_b32 a103, v49
s_waitcnt lgkmcnt(3)
v_perm_b32 v48, v25, v24, s52
v_accvgpr_write_b32 a104, v48
v_perm_b32 v49, v25, v24, s53
v_accvgpr_write_b32 a108, v49
s_waitcnt lgkmcnt(2)
v_perm_b32 v48, v27, v26, s52
v_accvgpr_write_b32 a105, v48
v_perm_b32 v49, v27, v26, s53
v_accvgpr_write_b32 a109, v49
s_waitcnt lgkmcnt(1)
v_perm_b32 v48, v29, v28, s52
v_accvgpr_write_b32 a106, v48
v_perm_b32 v49, v29, v28, s53
v_accvgpr_write_b32 a110, v49
s_waitcnt lgkmcnt(0)
v_perm_b32 v48, v31, v30, s52
v_accvgpr_write_b32 a107, v48
v_perm_b32 v49, v31, v30, s53
v_accvgpr_write_b32 a111, v49
s_waitcnt vmcnt(16)
s_barrier
s_add_u32 m0, s56, 65536
s_mov_b32 s54, 2097152
buffer_load_dwordx4 v1, s[44:47], s54 offen offset:0 lds
s_mov_b32 s54, 2128896
buffer_load_dwordx4 v1, s[44:47], s54 offen offset:1024 lds
s_mov_b32 s54, 2160640
buffer_load_dwordx4 v2, s[44:47], s54 offen offset:2048 lds
s_mov_b32 s54, 2192384
buffer_load_dwordx4 v2, s[44:47], s54 offen offset:3072 lds
ds_read2st64_b32 v[32:33], v4 offset0:192 offset1:193
ds_read2st64_b32 v[34:35], v4 offset0:194 offset1:195
ds_read2st64_b32 v[36:37], v4 offset0:196 offset1:197
ds_read2st64_b32 v[38:39], v4 offset0:198 offset1:199
ds_read2st64_b32 v[40:41], v4 offset0:224 offset1:225
ds_read2st64_b32 v[42:43], v4 offset0:226 offset1:227
ds_read2st64_b32 v[44:45], v4 offset0:228 offset1:229
ds_read2st64_b32 v[46:47], v4 offset0:230 offset1:231
s_waitcnt lgkmcnt(7)
v_perm_b32 v48, v33, v32, s52
v_accvgpr_write_b32 a112, v48
v_perm_b32 v49, v33, v32, s53
v_accvgpr_write_b32 a116, v49
s_waitcnt lgkmcnt(6)
v_perm_b32 v48, v35, v34, s52
v_accvgpr_write_b32 a113, v48
v_perm_b32 v49, v35, v34, s53
v_accvgpr_write_b32 a117, v49
s_waitcnt lgkmcnt(5)
v_perm_b32 v48, v37, v36, s52
v_accvgpr_write_b32 a114, v48
v_perm_b32 v49, v37, v36, s53
v_accvgpr_write_b32 a118, v49
s_waitcnt lgkmcnt(4)
v_perm_b32 v48, v39, v38, s52
v_accvgpr_write_b32 a115, v48
v_perm_b32 v49, v39, v38, s53
v_accvgpr_write_b32 a119, v49
s_waitcnt lgkmcnt(3)
v_perm_b32 v48, v41, v40, s52
v_accvgpr_write_b32 a120, v48
v_perm_b32 v49, v41, v40, s53
v_accvgpr_write_b32 a124, v49
s_waitcnt lgkmcnt(2)
v_perm_b32 v48, v43, v42, s52
v_accvgpr_write_b32 a121, v48
v_perm_b32 v49, v43, v42, s53
v_accvgpr_write_b32 a125, v49
s_waitcnt lgkmcnt(1)
v_perm_b32 v48, v45, v44, s52
v_accvgpr_write_b32 a122, v48
v_perm_b32 v49, v45, v44, s53
v_accvgpr_write_b32 a126, v49
s_waitcnt lgkmcnt(0)
v_perm_b32 v48, v47, v46, s52
v_accvgpr_write_b32 a123, v48
v_perm_b32 v49, v47, v46, s53
v_accvgpr_write_b32 a127, v49
s_waitcnt vmcnt(16)
s_barrier
s_add_u32 m0, s56, 81920
s_mov_b32 s54, 2621440
buffer_load_dwordx4 v1, s[44:47], s54 offen offset:0 lds
s_mov_b32 s54, 2653184
buffer_load_dwordx4 v1, s[44:47], s54 offen offset:1024 lds
s_mov_b32 s54, 2684928
buffer_load_dwordx4 v2, s[44:47], s54 offen offset:2048 lds
s_mov_b32 s54, 2716672
buffer_load_dwordx4 v2, s[44:47], s54 offen offset:3072 lds
ds_read2st64_b32 v[16:17], v3 offset0:0 offset1:1
ds_read2st64_b32 v[18:19], v3 offset0:2 offset1:3
ds_read2st64_b32 v[20:21], v3 offset0:4 offset1:5
ds_read2st64_b32 v[22:23], v3 offset0:6 offset1:7
ds_read2st64_b32 v[24:25], v3 offset0:32 offset1:33
ds_read2st64_b32 v[26:27], v3 offset0:34 offset1:35
ds_read2st64_b32 v[28:29], v3 offset0:36 offset1:37
ds_read2st64_b32 v[30:31], v3 offset0:38 offset1:39
s_waitcnt lgkmcnt(7)
v_perm_b32 v48, v17, v16, s52
v_accvgpr_write_b32 a128, v48
v_perm_b32 v49, v17, v16, s53
v_accvgpr_write_b32 a132, v49
s_waitcnt lgkmcnt(6)
v_perm_b32 v48, v19, v18, s52
v_accvgpr_write_b32 a129, v48
v_perm_b32 v49, v19, v18, s53
v_accvgpr_write_b32 a133, v49
s_waitcnt lgkmcnt(5)
v_perm_b32 v48, v21, v20, s52
v_accvgpr_write_b32 a130, v48
v_perm_b32 v49, v21, v20, s53
v_accvgpr_write_b32 a134, v49
s_waitcnt lgkmcnt(4)
v_perm_b32 v48, v23, v22, s52
v_accvgpr_write_b32 a131, v48
v_perm_b32 v49, v23, v22, s53
v_accvgpr_write_b32 a135, v49
s_waitcnt lgkmcnt(3)
v_perm_b32 v48, v25, v24, s52
v_accvgpr_write_b32 a136, v48
v_perm_b32 v49, v25, v24, s53
v_accvgpr_write_b32 a140, v49
s_waitcnt lgkmcnt(2)
v_perm_b32 v48, v27, v26, s52
v_accvgpr_write_b32 a137, v48
v_perm_b32 v49, v27, v26, s53
v_accvgpr_write_b32 a141, v49
s_waitcnt lgkmcnt(1)
v_perm_b32 v48, v29, v28, s52
v_accvgpr_write_b32 a138, v48
v_perm_b32 v49, v29, v28, s53
v_accvgpr_write_b32 a142, v49
s_waitcnt lgkmcnt(0)
v_perm_b32 v48, v31, v30, s52
v_accvgpr_write_b32 a139, v48
v_perm_b32 v49, v31, v30, s53
v_accvgpr_write_b32 a143, v49
s_waitcnt vmcnt(16)
s_barrier
s_add_u32 m0, s56, 98304
s_mov_b32 s54, 3145728
buffer_load_dwordx4 v1, s[44:47], s54 offen offset:0 lds
s_mov_b32 s54, 3177472
buffer_load_dwordx4 v1, s[44:47], s54 offen offset:1024 lds
s_mov_b32 s54, 3209216
buffer_load_dwordx4 v2, s[44:47], s54 offen offset:2048 lds
s_mov_b32 s54, 3240960
buffer_load_dwordx4 v2, s[44:47], s54 offen offset:3072 lds
ds_read2st64_b32 v[32:33], v3 offset0:64 offset1:65
ds_read2st64_b32 v[34:35], v3 offset0:66 offset1:67
ds_read2st64_b32 v[36:37], v3 offset0:68 offset1:69
ds_read2st64_b32 v[38:39], v3 offset0:70 offset1:71
ds_read2st64_b32 v[40:41], v3 offset0:96 offset1:97
ds_read2st64_b32 v[42:43], v3 offset0:98 offset1:99
ds_read2st64_b32 v[44:45], v3 offset0:100 offset1:101
ds_read2st64_b32 v[46:47], v3 offset0:102 offset1:103
s_waitcnt lgkmcnt(7)
v_perm_b32 v48, v33, v32, s52
v_accvgpr_write_b32 a144, v48
v_perm_b32 v49, v33, v32, s53
v_accvgpr_write_b32 a148, v49
s_waitcnt lgkmcnt(6)
v_perm_b32 v48, v35, v34, s52
v_accvgpr_write_b32 a145, v48
v_perm_b32 v49, v35, v34, s53
v_accvgpr_write_b32 a149, v49
s_waitcnt lgkmcnt(5)
v_perm_b32 v48, v37, v36, s52
v_accvgpr_write_b32 a146, v48
v_perm_b32 v49, v37, v36, s53
v_accvgpr_write_b32 a150, v49
s_waitcnt lgkmcnt(4)
v_perm_b32 v48, v39, v38, s52
v_accvgpr_write_b32 a147, v48
v_perm_b32 v49, v39, v38, s53
v_accvgpr_write_b32 a151, v49
s_waitcnt lgkmcnt(3)
v_perm_b32 v48, v41, v40, s52
v_accvgpr_write_b32 a152, v48
v_perm_b32 v49, v41, v40, s53
v_accvgpr_write_b32 a156, v49
s_waitcnt lgkmcnt(2)
v_perm_b32 v48, v43, v42, s52
v_accvgpr_write_b32 a153, v48
v_perm_b32 v49, v43, v42, s53
v_accvgpr_write_b32 a157, v49
s_waitcnt lgkmcnt(1)
v_perm_b32 v48, v45, v44, s52
v_accvgpr_write_b32 a154, v48
v_perm_b32 v49, v45, v44, s53
v_accvgpr_write_b32 a158, v49
s_waitcnt lgkmcnt(0)
v_perm_b32 v48, v47, v46, s52
v_accvgpr_write_b32 a155, v48
v_perm_b32 v49, v47, v46, s53
v_accvgpr_write_b32 a159, v49
s_waitcnt vmcnt(16)
s_barrier
s_add_u32 m0, s56, 114688
s_mov_b32 s54, 3670016
buffer_load_dwordx4 v1, s[44:47], s54 offen offset:0 lds
s_mov_b32 s54, 3701760
buffer_load_dwordx4 v1, s[44:47], s54 offen offset:1024 lds
s_mov_b32 s54, 3733504
buffer_load_dwordx4 v2, s[44:47], s54 offen offset:2048 lds
s_mov_b32 s54, 3765248
buffer_load_dwordx4 v2, s[44:47], s54 offen offset:3072 lds
ds_read2st64_b32 v[16:17], v3 offset0:128 offset1:129
ds_read2st64_b32 v[18:19], v3 offset0:130 offset1:131
ds_read2st64_b32 v[20:21], v3 offset0:132 offset1:133
ds_read2st64_b32 v[22:23], v3 offset0:134 offset1:135
ds_read2st64_b32 v[24:25], v3 offset0:160 offset1:161
ds_read2st64_b32 v[26:27], v3 offset0:162 offset1:163
ds_read2st64_b32 v[28:29], v3 offset0:164 offset1:165
ds_read2st64_b32 v[30:31], v3 offset0:166 offset1:167
s_waitcnt lgkmcnt(7)
v_perm_b32 v48, v17, v16, s52
v_accvgpr_write_b32 a160, v48
v_perm_b32 v49, v17, v16, s53
v_accvgpr_write_b32 a164, v49
s_waitcnt lgkmcnt(6)
v_perm_b32 v48, v19, v18, s52
v_accvgpr_write_b32 a161, v48
v_perm_b32 v49, v19, v18, s53
v_accvgpr_write_b32 a165, v49
s_waitcnt lgkmcnt(5)
v_perm_b32 v48, v21, v20, s52
v_accvgpr_write_b32 a162, v48
v_perm_b32 v49, v21, v20, s53
v_accvgpr_write_b32 a166, v49
s_waitcnt lgkmcnt(4)
v_perm_b32 v48, v23, v22, s52
v_accvgpr_write_b32 a163, v48
v_perm_b32 v49, v23, v22, s53
v_accvgpr_write_b32 a167, v49
s_waitcnt lgkmcnt(3)
v_perm_b32 v48, v25, v24, s52
v_accvgpr_write_b32 a168, v48
v_perm_b32 v49, v25, v24, s53
v_accvgpr_write_b32 a172, v49
s_waitcnt lgkmcnt(2)
v_perm_b32 v48, v27, v26, s52
v_accvgpr_write_b32 a169, v48
v_perm_b32 v49, v27, v26, s53
v_accvgpr_write_b32 a173, v49
s_waitcnt lgkmcnt(1)
v_perm_b32 v48, v29, v28, s52
v_accvgpr_write_b32 a170, v48
v_perm_b32 v49, v29, v28, s53
v_accvgpr_write_b32 a174, v49
s_waitcnt lgkmcnt(0)
v_perm_b32 v48, v31, v30, s52
v_accvgpr_write_b32 a171, v48
v_perm_b32 v49, v31, v30, s53
v_accvgpr_write_b32 a175, v49
s_waitcnt vmcnt(16)
s_barrier
s_add_u32 m0, s56, 0
s_mov_b32 s54, 0
buffer_load_dwordx4 v1, s[48:51], s54 offen offset:0 lds
s_mov_b32 s54, 31744
buffer_load_dwordx4 v1, s[48:51], s54 offen offset:1024 lds
s_mov_b32 s54, 63488
buffer_load_dwordx4 v2, s[48:51], s54 offen offset:2048 lds
s_mov_b32 s54, 95232
buffer_load_dwordx4 v2, s[48:51], s54 offen offset:3072 lds
ds_read2st64_b32 v[32:33], v3 offset0:192 offset1:193
ds_read2st64_b32 v[34:35], v3 offset0:194 offset1:195
ds_read2st64_b32 v[36:37], v3 offset0:196 offset1:197
ds_read2st64_b32 v[38:39], v3 offset0:198 offset1:199
ds_read2st64_b32 v[40:41], v3 offset0:224 offset1:225
ds_read2st64_b32 v[42:43], v3 offset0:226 offset1:227
ds_read2st64_b32 v[44:45], v3 offset0:228 offset1:229
ds_read2st64_b32 v[46:47], v3 offset0:230 offset1:231
s_waitcnt lgkmcnt(7)
v_perm_b32 v48, v33, v32, s52
v_accvgpr_write_b32 a176, v48
v_perm_b32 v49, v33, v32, s53
v_accvgpr_write_b32 a180, v49
s_waitcnt lgkmcnt(6)
v_perm_b32 v48, v35, v34, s52
v_accvgpr_write_b32 a177, v48
v_perm_b32 v49, v35, v34, s53
v_accvgpr_write_b32 a181, v49
s_waitcnt lgkmcnt(5)
v_perm_b32 v48, v37, v36, s52
v_accvgpr_write_b32 a178, v48
v_perm_b32 v49, v37, v36, s53
v_accvgpr_write_b32 a182, v49
s_waitcnt lgkmcnt(4)
v_perm_b32 v48, v39, v38, s52
v_accvgpr_write_b32 a179, v48
v_perm_b32 v49, v39, v38, s53
v_accvgpr_write_b32 a183, v49
s_waitcnt lgkmcnt(3)
v_perm_b32 v48, v41, v40, s52
v_accvgpr_write_b32 a184, v48
v_perm_b32 v49, v41, v40, s53
v_accvgpr_write_b32 a188, v49
s_waitcnt lgkmcnt(2)
v_perm_b32 v48, v43, v42, s52
v_accvgpr_write_b32 a185, v48
v_perm_b32 v49, v43, v42, s53
v_accvgpr_write_b32 a189, v49
s_waitcnt lgkmcnt(1)
v_perm_b32 v48, v45, v44, s52
v_accvgpr_write_b32 a186, v48
v_perm_b32 v49, v45, v44, s53
v_accvgpr_write_b32 a190, v49
s_waitcnt lgkmcnt(0)
v_perm_b32 v48, v47, v46, s52
v_accvgpr_write_b32 a187, v48
v_perm_b32 v49, v47, v46, s53
v_accvgpr_write_b32 a191, v49
s_waitcnt vmcnt(16)
s_barrier
s_add_u32 m0, s56, 16384
s_mov_b32 s54, 524288
buffer_load_dwordx4 v1, s[48:51], s54 offen offset:0 lds
s_mov_b32 s54, 556032
buffer_load_dwordx4 v1, s[48:51], s54 offen offset:1024 lds
s_mov_b32 s54, 587776
buffer_load_dwordx4 v2, s[48:51], s54 offen offset:2048 lds
s_mov_b32 s54, 619520
buffer_load_dwordx4 v2, s[48:51], s54 offen offset:3072 lds
ds_read2st64_b32 v[16:17], v4 offset0:0 offset1:1
ds_read2st64_b32 v[18:19], v4 offset0:2 offset1:3
ds_read2st64_b32 v[20:21], v4 offset0:4 offset1:5
ds_read2st64_b32 v[22:23], v4 offset0:6 offset1:7
ds_read2st64_b32 v[24:25], v4 offset0:32 offset1:33
ds_read2st64_b32 v[26:27], v4 offset0:34 offset1:35
ds_read2st64_b32 v[28:29], v4 offset0:36 offset1:37
ds_read2st64_b32 v[30:31], v4 offset0:38 offset1:39
s_waitcnt lgkmcnt(7)
v_perm_b32 v48, v17, v16, s52
v_accvgpr_write_b32 a192, v48
v_perm_b32 v49, v17, v16, s53
v_accvgpr_write_b32 a196, v49
s_waitcnt lgkmcnt(6)
v_perm_b32 v48, v19, v18, s52
v_accvgpr_write_b32 a193, v48
v_perm_b32 v49, v19, v18, s53
v_accvgpr_write_b32 a197, v49
s_waitcnt lgkmcnt(5)
v_perm_b32 v48, v21, v20, s52
v_accvgpr_write_b32 a194, v48
v_perm_b32 v49, v21, v20, s53
v_accvgpr_write_b32 a198, v49
s_waitcnt lgkmcnt(4)
v_perm_b32 v48, v23, v22, s52
v_accvgpr_write_b32 a195, v48
v_perm_b32 v49, v23, v22, s53
v_accvgpr_write_b32 a199, v49
s_waitcnt lgkmcnt(3)
v_perm_b32 v48, v25, v24, s52
v_accvgpr_write_b32 a200, v48
v_perm_b32 v49, v25, v24, s53
v_accvgpr_write_b32 a204, v49
s_waitcnt lgkmcnt(2)
v_perm_b32 v48, v27, v26, s52
v_accvgpr_write_b32 a201, v48
v_perm_b32 v49, v27, v26, s53
v_accvgpr_write_b32 a205, v49
s_waitcnt lgkmcnt(1)
v_perm_b32 v48, v29, v28, s52
v_accvgpr_write_b32 a202, v48
v_perm_b32 v49, v29, v28, s53
v_accvgpr_write_b32 a206, v49
s_waitcnt lgkmcnt(0)
v_perm_b32 v48, v31, v30, s52
v_accvgpr_write_b32 a203, v48
v_perm_b32 v49, v31, v30, s53
v_accvgpr_write_b32 a207, v49
s_waitcnt vmcnt(16)
s_barrier
s_add_u32 m0, s56, 32768
s_mov_b32 s54, 1048576
buffer_load_dwordx4 v1, s[48:51], s54 offen offset:0 lds
s_mov_b32 s54, 1080320
buffer_load_dwordx4 v1, s[48:51], s54 offen offset:1024 lds
s_mov_b32 s54, 1112064
buffer_load_dwordx4 v2, s[48:51], s54 offen offset:2048 lds
s_mov_b32 s54, 1143808
buffer_load_dwordx4 v2, s[48:51], s54 offen offset:3072 lds
ds_read2st64_b32 v[32:33], v4 offset0:64 offset1:65
ds_read2st64_b32 v[34:35], v4 offset0:66 offset1:67
ds_read2st64_b32 v[36:37], v4 offset0:68 offset1:69
ds_read2st64_b32 v[38:39], v4 offset0:70 offset1:71
ds_read2st64_b32 v[40:41], v4 offset0:96 offset1:97
ds_read2st64_b32 v[42:43], v4 offset0:98 offset1:99
ds_read2st64_b32 v[44:45], v4 offset0:100 offset1:101
ds_read2st64_b32 v[46:47], v4 offset0:102 offset1:103
s_waitcnt lgkmcnt(7)
v_perm_b32 v48, v33, v32, s52
v_accvgpr_write_b32 a208, v48
v_perm_b32 v49, v33, v32, s53
v_accvgpr_write_b32 a212, v49
s_waitcnt lgkmcnt(6)
v_perm_b32 v48, v35, v34, s52
v_accvgpr_write_b32 a209, v48
v_perm_b32 v49, v35, v34, s53
v_accvgpr_write_b32 a213, v49
s_waitcnt lgkmcnt(5)
v_perm_b32 v48, v37, v36, s52
v_accvgpr_write_b32 a210, v48
v_perm_b32 v49, v37, v36, s53
v_accvgpr_write_b32 a214, v49
s_waitcnt lgkmcnt(4)
v_perm_b32 v48, v39, v38, s52
v_accvgpr_write_b32 a211, v48
v_perm_b32 v49, v39, v38, s53
v_accvgpr_write_b32 a215, v49
s_waitcnt lgkmcnt(3)
v_perm_b32 v48, v41, v40, s52
v_accvgpr_write_b32 a216, v48
v_perm_b32 v49, v41, v40, s53
v_accvgpr_write_b32 a220, v49
s_waitcnt lgkmcnt(2)
v_perm_b32 v48, v43, v42, s52
v_accvgpr_write_b32 a217, v48
v_perm_b32 v49, v43, v42, s53
v_accvgpr_write_b32 a221, v49
s_waitcnt lgkmcnt(1)
v_perm_b32 v48, v45, v44, s52
v_accvgpr_write_b32 a218, v48
v_perm_b32 v49, v45, v44, s53
v_accvgpr_write_b32 a222, v49
s_waitcnt lgkmcnt(0)
v_perm_b32 v48, v47, v46, s52
v_accvgpr_write_b32 a219, v48
v_perm_b32 v49, v47, v46, s53
v_accvgpr_write_b32 a223, v49
s_waitcnt vmcnt(16)
s_barrier
s_add_u32 m0, s56, 49152
s_mov_b32 s54, 1572864
buffer_load_dwordx4 v1, s[48:51], s54 offen offset:0 lds
s_mov_b32 s54, 1604608
buffer_load_dwordx4 v1, s[48:51], s54 offen offset:1024 lds
s_mov_b32 s54, 1636352
buffer_load_dwordx4 v2, s[48:51], s54 offen offset:2048 lds
s_mov_b32 s54, 1668096
buffer_load_dwordx4 v2, s[48:51], s54 offen offset:3072 lds
ds_read2st64_b32 v[16:17], v4 offset0:128 offset1:129
ds_read2st64_b32 v[18:19], v4 offset0:130 offset1:131
ds_read2st64_b32 v[20:21], v4 offset0:132 offset1:133
ds_read2st64_b32 v[22:23], v4 offset0:134 offset1:135
ds_read2st64_b32 v[24:25], v4 offset0:160 offset1:161
ds_read2st64_b32 v[26:27], v4 offset0:162 offset1:163
ds_read2st64_b32 v[28:29], v4 offset0:164 offset1:165
ds_read2st64_b32 v[30:31], v4 offset0:166 offset1:167
s_waitcnt lgkmcnt(7)
v_perm_b32 v48, v17, v16, s52
v_accvgpr_write_b32 a224, v48
v_perm_b32 v49, v17, v16, s53
v_accvgpr_write_b32 a228, v49
s_waitcnt lgkmcnt(6)
v_perm_b32 v48, v19, v18, s52
v_accvgpr_write_b32 a225, v48
v_perm_b32 v49, v19, v18, s53
v_accvgpr_write_b32 a229, v49
s_waitcnt lgkmcnt(5)
v_perm_b32 v48, v21, v20, s52
v_accvgpr_write_b32 a226, v48
v_perm_b32 v49, v21, v20, s53
v_accvgpr_write_b32 a230, v49
s_waitcnt lgkmcnt(4)
v_perm_b32 v48, v23, v22, s52
v_accvgpr_write_b32 a227, v48
v_perm_b32 v49, v23, v22, s53
v_accvgpr_write_b32 a231, v49
s_waitcnt lgkmcnt(3)
v_perm_b32 v48, v25, v24, s52
v_accvgpr_write_b32 a232, v48
v_perm_b32 v49, v25, v24, s53
v_accvgpr_write_b32 a236, v49
s_waitcnt lgkmcnt(2)
v_perm_b32 v48, v27, v26, s52
v_accvgpr_write_b32 a233, v48
v_perm_b32 v49, v27, v26, s53
v_accvgpr_write_b32 a237, v49
s_waitcnt lgkmcnt(1)
v_perm_b32 v48, v29, v28, s52
v_accvgpr_write_b32 a234, v48
v_perm_b32 v49, v29, v28, s53
v_accvgpr_write_b32 a238, v49
s_waitcnt lgkmcnt(0)
v_perm_b32 v48, v31, v30, s52
v_accvgpr_write_b32 a235, v48
v_perm_b32 v49, v31, v30, s53
v_accvgpr_write_b32 a239, v49
s_waitcnt vmcnt(16)
s_barrier
s_add_u32 m0, s56, 65536
s_mov_b32 s54, 2097152
buffer_load_dwordx4 v1, s[48:51], s54 offen offset:0 lds
s_mov_b32 s54, 2128896
buffer_load_dwordx4 v1, s[48:51], s54 offen offset:1024 lds
s_mov_b32 s54, 2160640
buffer_load_dwordx4 v2, s[48:51], s54 offen offset:2048 lds
s_mov_b32 s54, 2192384
buffer_load_dwordx4 v2, s[48:51], s54 offen offset:3072 lds
ds_read2st64_b32 v[32:33], v4 offset0:192 offset1:193
ds_read2st64_b32 v[34:35], v4 offset0:194 offset1:195
ds_read2st64_b32 v[36:37], v4 offset0:196 offset1:197
ds_read2st64_b32 v[38:39], v4 offset0:198 offset1:199
ds_read2st64_b32 v[40:41], v4 offset0:224 offset1:225
ds_read2st64_b32 v[42:43], v4 offset0:226 offset1:227
ds_read2st64_b32 v[44:45], v4 offset0:228 offset1:229
ds_read2st64_b32 v[46:47], v4 offset0:230 offset1:231
s_waitcnt lgkmcnt(7)
v_perm_b32 v48, v33, v32, s52
v_accvgpr_write_b32 a240, v48
v_perm_b32 v49, v33, v32, s53
v_accvgpr_write_b32 a244, v49
s_waitcnt lgkmcnt(6)
v_perm_b32 v48, v35, v34, s52
v_accvgpr_write_b32 a241, v48
v_perm_b32 v49, v35, v34, s53
v_accvgpr_write_b32 a245, v49
s_waitcnt lgkmcnt(5)
v_perm_b32 v48, v37, v36, s52
v_accvgpr_write_b32 a242, v48
v_perm_b32 v49, v37, v36, s53
v_accvgpr_write_b32 a246, v49
s_waitcnt lgkmcnt(4)
v_perm_b32 v48, v39, v38, s52
v_accvgpr_write_b32 a243, v48
v_perm_b32 v49, v39, v38, s53
v_accvgpr_write_b32 a247, v49
s_waitcnt lgkmcnt(3)
v_perm_b32 v48, v41, v40, s52
v_accvgpr_write_b32 a248, v48
v_perm_b32 v49, v41, v40, s53
v_accvgpr_write_b32 a252, v49
s_waitcnt lgkmcnt(2)
v_perm_b32 v48, v43, v42, s52
v_accvgpr_write_b32 a249, v48
v_perm_b32 v49, v43, v42, s53
v_accvgpr_write_b32 a253, v49
s_waitcnt lgkmcnt(1)
v_perm_b32 v48, v45, v44, s52
v_accvgpr_write_b32 a250, v48
v_perm_b32 v49, v45, v44, s53
v_accvgpr_write_b32 a254, v49
s_waitcnt lgkmcnt(0)
v_perm_b32 v48, v47, v46, s52
v_accvgpr_write_b32 a251, v48
v_perm_b32 v49, v47, v46, s53
v_accvgpr_write_b32 a255, v49
s_waitcnt vmcnt(16)
s_barrier
s_add_u32 m0, s56, 81920
s_mov_b32 s54, 2621440
buffer_load_dwordx4 v1, s[48:51], s54 offen offset:0 lds
s_mov_b32 s54, 2653184
buffer_load_dwordx4 v1, s[48:51], s54 offen offset:1024 lds
s_mov_b32 s54, 2684928
buffer_load_dwordx4 v2, s[48:51], s54 offen offset:2048 lds
s_mov_b32 s54, 2716672
buffer_load_dwordx4 v2, s[48:51], s54 offen offset:3072 lds
ds_read2st64_b32 v[16:17], v3 offset0:0 offset1:1
ds_read2st64_b32 v[18:19], v3 offset0:2 offset1:3
ds_read2st64_b32 v[20:21], v3 offset0:4 offset1:5
ds_read2st64_b32 v[22:23], v3 offset0:6 offset1:7
ds_read2st64_b32 v[24:25], v3 offset0:32 offset1:33
ds_read2st64_b32 v[26:27], v3 offset0:34 offset1:35
ds_read2st64_b32 v[28:29], v3 offset0:36 offset1:37
ds_read2st64_b32 v[30:31], v3 offset0:38 offset1:39
s_waitcnt lgkmcnt(7)
v_perm_b32 v128, v17, v16, s52
v_perm_b32 v132, v17, v16, s53
s_waitcnt lgkmcnt(6)
v_perm_b32 v129, v19, v18, s52
v_perm_b32 v133, v19, v18, s53
s_waitcnt lgkmcnt(5)
v_perm_b32 v130, v21, v20, s52
v_perm_b32 v134, v21, v20, s53
s_waitcnt lgkmcnt(4)
v_perm_b32 v131, v23, v22, s52
v_perm_b32 v135, v23, v22, s53
s_waitcnt lgkmcnt(3)
v_perm_b32 v136, v25, v24, s52
v_perm_b32 v140, v25, v24, s53
s_waitcnt lgkmcnt(2)
v_perm_b32 v137, v27, v26, s52
v_perm_b32 v141, v27, v26, s53
s_waitcnt lgkmcnt(1)
v_perm_b32 v138, v29, v28, s52
v_perm_b32 v142, v29, v28, s53
s_waitcnt lgkmcnt(0)
v_perm_b32 v139, v31, v30, s52
v_perm_b32 v143, v31, v30, s53
s_waitcnt vmcnt(16)
s_barrier
s_add_u32 m0, s56, 98304
s_mov_b32 s54, 3145728
buffer_load_dwordx4 v1, s[48:51], s54 offen offset:0 lds
s_mov_b32 s54, 3177472
buffer_load_dwordx4 v1, s[48:51], s54 offen offset:1024 lds
s_mov_b32 s54, 3209216
buffer_load_dwordx4 v2, s[48:51], s54 offen offset:2048 lds
s_mov_b32 s54, 3240960
buffer_load_dwordx4 v2, s[48:51], s54 offen offset:3072 lds
ds_read2st64_b32 v[32:33], v3 offset0:64 offset1:65
ds_read2st64_b32 v[34:35], v3 offset0:66 offset1:67
ds_read2st64_b32 v[36:37], v3 offset0:68 offset1:69
ds_read2st64_b32 v[38:39], v3 offset0:70 offset1:71
ds_read2st64_b32 v[40:41], v3 offset0:96 offset1:97
ds_read2st64_b32 v[42:43], v3 offset0:98 offset1:99
ds_read2st64_b32 v[44:45], v3 offset0:100 offset1:101
ds_read2st64_b32 v[46:47], v3 offset0:102 offset1:103
s_waitcnt lgkmcnt(7)
v_perm_b32 v144, v33, v32, s52
v_perm_b32 v148, v33, v32, s53
s_waitcnt lgkmcnt(6)
v_perm_b32 v145, v35, v34, s52
v_perm_b32 v149, v35, v34, s53
s_waitcnt lgkmcnt(5)
v_perm_b32 v146, v37, v36, s52
v_perm_b32 v150, v37, v36, s53
s_waitcnt lgkmcnt(4)
v_perm_b32 v147, v39, v38, s52
v_perm_b32 v151, v39, v38, s53
s_waitcnt lgkmcnt(3)
v_perm_b32 v152, v41, v40, s52
v_perm_b32 v156, v41, v40, s53
s_waitcnt lgkmcnt(2)
v_perm_b32 v153, v43, v42, s52
v_perm_b32 v157, v43, v42, s53
s_waitcnt lgkmcnt(1)
v_perm_b32 v154, v45, v44, s52
v_perm_b32 v158, v45, v44, s53
s_waitcnt lgkmcnt(0)
v_perm_b32 v155, v47, v46, s52
v_perm_b32 v159, v47, v46, s53
s_waitcnt vmcnt(16)
s_barrier
s_add_u32 m0, s56, 114688
s_mov_b32 s54, 3670016
buffer_load_dwordx4 v1, s[48:51], s54 offen offset:0 lds
s_mov_b32 s54, 3701760
buffer_load_dwordx4 v1, s[48:51], s54 offen offset:1024 lds
s_mov_b32 s54, 3733504
buffer_load_dwordx4 v2, s[48:51], s54 offen offset:2048 lds
s_mov_b32 s54, 3765248
buffer_load_dwordx4 v2, s[48:51], s54 offen offset:3072 lds
ds_read2st64_b32 v[16:17], v3 offset0:128 offset1:129
ds_read2st64_b32 v[18:19], v3 offset0:130 offset1:131
ds_read2st64_b32 v[20:21], v3 offset0:132 offset1:133
ds_read2st64_b32 v[22:23], v3 offset0:134 offset1:135
ds_read2st64_b32 v[24:25], v3 offset0:160 offset1:161
ds_read2st64_b32 v[26:27], v3 offset0:162 offset1:163
ds_read2st64_b32 v[28:29], v3 offset0:164 offset1:165
ds_read2st64_b32 v[30:31], v3 offset0:166 offset1:167
s_waitcnt lgkmcnt(7)
v_perm_b32 v160, v17, v16, s52
v_perm_b32 v164, v17, v16, s53
s_waitcnt lgkmcnt(6)
v_perm_b32 v161, v19, v18, s52
v_perm_b32 v165, v19, v18, s53
s_waitcnt lgkmcnt(5)
v_perm_b32 v162, v21, v20, s52
v_perm_b32 v166, v21, v20, s53
s_waitcnt lgkmcnt(4)
v_perm_b32 v163, v23, v22, s52
v_perm_b32 v167, v23, v22, s53
s_waitcnt lgkmcnt(3)
v_perm_b32 v168, v25, v24, s52
v_perm_b32 v172, v25, v24, s53
s_waitcnt lgkmcnt(2)
v_perm_b32 v169, v27, v26, s52
v_perm_b32 v173, v27, v26, s53
s_waitcnt lgkmcnt(1)
v_perm_b32 v170, v29, v28, s52
v_perm_b32 v174, v29, v28, s53
s_waitcnt lgkmcnt(0)
v_perm_b32 v171, v31, v30, s52
v_perm_b32 v175, v31, v30, s53
s_waitcnt vmcnt(16)
s_barrier
ds_read2st64_b32 v[32:33], v3 offset0:192 offset1:193
ds_read2st64_b32 v[34:35], v3 offset0:194 offset1:195
ds_read2st64_b32 v[36:37], v3 offset0:196 offset1:197
ds_read2st64_b32 v[38:39], v3 offset0:198 offset1:199
ds_read2st64_b32 v[40:41], v3 offset0:224 offset1:225
ds_read2st64_b32 v[42:43], v3 offset0:226 offset1:227
ds_read2st64_b32 v[44:45], v3 offset0:228 offset1:229
ds_read2st64_b32 v[46:47], v3 offset0:230 offset1:231
s_waitcnt lgkmcnt(7)
v_perm_b32 v176, v33, v32, s52
v_perm_b32 v180, v33, v32, s53
s_waitcnt lgkmcnt(6)
v_perm_b32 v177, v35, v34, s52
v_perm_b32 v181, v35, v34, s53
s_waitcnt lgkmcnt(5)
v_perm_b32 v178, v37, v36, s52
v_perm_b32 v182, v37, v36, s53
s_waitcnt lgkmcnt(4)
v_perm_b32 v179, v39, v38, s52
v_perm_b32 v183, v39, v38, s53
s_waitcnt lgkmcnt(3)
v_perm_b32 v184, v41, v40, s52
v_perm_b32 v188, v41, v40, s53
s_waitcnt lgkmcnt(2)
v_perm_b32 v185, v43, v42, s52
v_perm_b32 v189, v43, v42, s53
s_waitcnt lgkmcnt(1)
v_perm_b32 v186, v45, v44, s52
v_perm_b32 v190, v45, v44, s53
s_waitcnt lgkmcnt(0)
v_perm_b32 v187, v47, v46, s52
v_perm_b32 v191, v47, v46, s53
s_waitcnt vmcnt(12)
s_barrier
ds_read2st64_b32 v[16:17], v4 offset0:0 offset1:1
ds_read2st64_b32 v[18:19], v4 offset0:2 offset1:3
ds_read2st64_b32 v[20:21], v4 offset0:4 offset1:5
ds_read2st64_b32 v[22:23], v4 offset0:6 offset1:7
ds_read2st64_b32 v[24:25], v4 offset0:32 offset1:33
ds_read2st64_b32 v[26:27], v4 offset0:34 offset1:35
ds_read2st64_b32 v[28:29], v4 offset0:36 offset1:37
ds_read2st64_b32 v[30:31], v4 offset0:38 offset1:39
s_waitcnt lgkmcnt(7)
v_perm_b32 v192, v17, v16, s52
v_perm_b32 v196, v17, v16, s53
s_waitcnt lgkmcnt(6)
v_perm_b32 v193, v19, v18, s52
v_perm_b32 v197, v19, v18, s53
s_waitcnt lgkmcnt(5)
v_perm_b32 v194, v21, v20, s52
v_perm_b32 v198, v21, v20, s53
s_waitcnt lgkmcnt(4)
v_perm_b32 v195, v23, v22, s52
v_perm_b32 v199, v23, v22, s53
s_waitcnt lgkmcnt(3)
v_perm_b32 v200, v25, v24, s52
v_perm_b32 v204, v25, v24, s53
s_waitcnt lgkmcnt(2)
v_perm_b32 v201, v27, v26, s52
v_perm_b32 v205, v27, v26, s53
s_waitcnt lgkmcnt(1)
v_perm_b32 v202, v29, v28, s52
v_perm_b32 v206, v29, v28, s53
s_waitcnt lgkmcnt(0)
v_perm_b32 v203, v31, v30, s52
v_perm_b32 v207, v31, v30, s53
s_waitcnt vmcnt(8)
s_barrier
ds_read2st64_b32 v[32:33], v4 offset0:64 offset1:65
ds_read2st64_b32 v[34:35], v4 offset0:66 offset1:67
ds_read2st64_b32 v[36:37], v4 offset0:68 offset1:69
ds_read2st64_b32 v[38:39], v4 offset0:70 offset1:71
ds_read2st64_b32 v[40:41], v4 offset0:96 offset1:97
ds_read2st64_b32 v[42:43], v4 offset0:98 offset1:99
ds_read2st64_b32 v[44:45], v4 offset0:100 offset1:101
ds_read2st64_b32 v[46:47], v4 offset0:102 offset1:103
s_waitcnt lgkmcnt(7)
v_perm_b32 v208, v33, v32, s52
v_perm_b32 v212, v33, v32, s53
s_waitcnt lgkmcnt(6)
v_perm_b32 v209, v35, v34, s52
v_perm_b32 v213, v35, v34, s53
s_waitcnt lgkmcnt(5)
v_perm_b32 v210, v37, v36, s52
v_perm_b32 v214, v37, v36, s53
s_waitcnt lgkmcnt(4)
v_perm_b32 v211, v39, v38, s52
v_perm_b32 v215, v39, v38, s53
s_waitcnt lgkmcnt(3)
v_perm_b32 v216, v41, v40, s52
v_perm_b32 v220, v41, v40, s53
s_waitcnt lgkmcnt(2)
v_perm_b32 v217, v43, v42, s52
v_perm_b32 v221, v43, v42, s53
s_waitcnt lgkmcnt(1)
v_perm_b32 v218, v45, v44, s52
v_perm_b32 v222, v45, v44, s53
s_waitcnt lgkmcnt(0)
v_perm_b32 v219, v47, v46, s52
v_perm_b32 v223, v47, v46, s53
s_waitcnt vmcnt(4)
s_barrier
ds_read2st64_b32 v[16:17], v4 offset0:128 offset1:129
ds_read2st64_b32 v[18:19], v4 offset0:130 offset1:131
ds_read2st64_b32 v[20:21], v4 offset0:132 offset1:133
ds_read2st64_b32 v[22:23], v4 offset0:134 offset1:135
ds_read2st64_b32 v[24:25], v4 offset0:160 offset1:161
ds_read2st64_b32 v[26:27], v4 offset0:162 offset1:163
ds_read2st64_b32 v[28:29], v4 offset0:164 offset1:165
ds_read2st64_b32 v[30:31], v4 offset0:166 offset1:167
s_waitcnt lgkmcnt(7)
v_perm_b32 v224, v17, v16, s52
v_perm_b32 v228, v17, v16, s53
s_waitcnt lgkmcnt(6)
v_perm_b32 v225, v19, v18, s52
v_perm_b32 v229, v19, v18, s53
s_waitcnt lgkmcnt(5)
v_perm_b32 v226, v21, v20, s52
v_perm_b32 v230, v21, v20, s53
s_waitcnt lgkmcnt(4)
v_perm_b32 v227, v23, v22, s52
v_perm_b32 v231, v23, v22, s53
s_waitcnt lgkmcnt(3)
v_perm_b32 v232, v25, v24, s52
v_perm_b32 v236, v25, v24, s53
s_waitcnt lgkmcnt(2)
v_perm_b32 v233, v27, v26, s52
v_perm_b32 v237, v27, v26, s53
s_waitcnt lgkmcnt(1)
v_perm_b32 v234, v29, v28, s52
v_perm_b32 v238, v29, v28, s53
s_waitcnt lgkmcnt(0)
v_perm_b32 v235, v31, v30, s52
v_perm_b32 v239, v31, v30, s53
s_waitcnt vmcnt(0)
s_barrier
ds_read2st64_b32 v[32:33], v4 offset0:192 offset1:193
ds_read2st64_b32 v[34:35], v4 offset0:194 offset1:195
ds_read2st64_b32 v[36:37], v4 offset0:196 offset1:197
ds_read2st64_b32 v[38:39], v4 offset0:198 offset1:199
ds_read2st64_b32 v[40:41], v4 offset0:224 offset1:225
ds_read2st64_b32 v[42:43], v4 offset0:226 offset1:227
ds_read2st64_b32 v[44:45], v4 offset0:228 offset1:229
ds_read2st64_b32 v[46:47], v4 offset0:230 offset1:231
s_waitcnt lgkmcnt(7)
v_perm_b32 v240, v33, v32, s52
v_perm_b32 v244, v33, v32, s53
s_waitcnt lgkmcnt(6)
v_perm_b32 v241, v35, v34, s52
v_perm_b32 v245, v35, v34, s53
s_waitcnt lgkmcnt(5)
v_perm_b32 v242, v37, v36, s52
v_perm_b32 v246, v37, v36, s53
s_waitcnt lgkmcnt(4)
v_perm_b32 v243, v39, v38, s52
v_perm_b32 v247, v39, v38, s53
s_waitcnt lgkmcnt(3)
v_perm_b32 v248, v41, v40, s52
v_perm_b32 v252, v41, v40, s53
s_waitcnt lgkmcnt(2)
v_perm_b32 v249, v43, v42, s52
v_perm_b32 v253, v43, v42, s53
s_waitcnt lgkmcnt(1)
v_perm_b32 v250, v45, v44, s52
v_perm_b32 v254, v45, v44, s53
s_waitcnt lgkmcnt(0)
v_perm_b32 v251, v47, v46, s52
v_perm_b32 v255, v47, v46, s53
s_cmp_lg_u32 s32, 0
s_cbranch_scc1 L_w0
v_mov_b32 v8, 192
L_wc_2:
global_load_dword v9, v8, s[28:29] sc1
s_waitcnt vmcnt(0)
v_readfirstlane_b32 s54, v9
s_nop 0
s_cmp_ge_u32 s54, 128
s_cbranch_scc1 L_wcd_3
s_add_u32 s35, s35, 1
s_cmp_gt_u32 s35, 131072
s_cbranch_scc1 L_END
s_sleep 8
s_branch L_wc_2
L_wcd_3:
L_w0:
s_barrier
v_lshlrev_b32 v6, 4, v0
s_lshl_b32 s55, s32, 10
s_add_u32 s55, s55, 65536
v_add_u32 v6, s55, v6
s_cmp_lt_u32 s63, 3
s_cselect_b32 s54, 0, 3
s_add_u32 s63, s63, s54
s_mov_b32 s64, s63
v_lshlrev_b32 v1, 4, v0
v_mov_b32 v3, v1
v_mov_b32 v4, 1
s_lshl_b32 s57, s32, 13
s_lshl_b32 s58, s34, 2
s_add_u32 s58, s58, s32
s_lshl_b32 s58, s58, 7
s_add_u32 s58, s58, 5242880
s_mov_b32 s61, s64
s_barrier
s_lshl_b32 s56, s61, 15
s_lshl_b32 s55, s32, 13
s_add_u32 s56, s56, s55
s_add_u32 s66, s56, 4096
s_add_u32 m0, s57, 0
s_nop 0
buffer_load_dwordx4 v1, s[36:39], s56 offen offset:0 sc1 lds
buffer_load_dwordx4 v1, s[36:39], s56 offen offset:1024 sc1 lds
buffer_load_dwordx4 v1, s[36:39], s56 offen offset:2048 sc1 lds
buffer_load_dwordx4 v1, s[36:39], s56 offen offset:3072 sc1 lds
s_add_u32 m0, s57, 4096
s_nop 0
buffer_load_dwordx4 v1, s[36:39], s66 offen offset:0 sc1 lds
buffer_load_dwordx4 v1, s[36:39], s66 offen offset:1024 sc1 lds
buffer_load_dwordx4 v1, s[36:39], s66 offen offset:2048 sc1 lds
buffer_load_dwordx4 v1, s[36:39], s66 offen offset:3072 sc1 lds
s_waitcnt vmcnt(0)
s_barrier
L_qkv_loop:
ds_read_b128 v[64:67], v3 offset:0
ds_read_b128 v[68:71], v3 offset:16384
ds_read_b128 v[72:75], v3 offset:1024
ds_read_b128 v[76:79], v3 offset:17408
s_cmp_lt_u32 s64, 3
s_cselect_b32 s60, 3, 6
s_add_u32 s61, s64, s60
s_min_u32 s61, s61, 63
s_xor_b32 s57, s57, 0x8000
s_lshl_b32 s56, s61, 15
s_lshl_b32 s55, s32, 13
s_add_u32 s56, s56, s55
s_add_u32 s66, s56, 4096
s_waitcnt lgkmcnt(3)
v_mfma_f32_16x16x32_bf16 v[16:19], a[0:3], v[64:67], 0
ds_read_b128 v[80:83], v3 offset:2048
ds_read_b128 v[84:87], v3 offset:18432
s_waitcnt lgkmcnt(4)
v_mfma_f32_16x16x32_bf16 v[20:23], a[0:3], v[68:71], 0
v_mfma_f32_16x16x32_bf16 v[24:27], a[4:7], v[64:67], 0
s_add_u32 m0, s57, 0
s_nop 0
buffer_load_dwordx4 v1, s[36:39], s56 offen offset:0 sc1 lds
v_mfma_f32_16x16x32_bf16 v[28:31], a[4:7], v[68:71], 0
v_mfma_f32_16x16x32_bf16 v[32:35], v[64:67], a[128:131], 0
v_mfma_f32_16x16x32_bf16 v[36:39], v[68:71], a[128:131], 0
v_mfma_f32_16x16x32_bf16 v[40:43], v[64:67], a[132:135], 0
v_mfma_f32_16x16x32_bf16 v[44:47], v[68:71], a[132:135], 0
s_waitcnt lgkmcnt(3)
v_mfma_f32_16x16x32_bf16 v[16:19], a[8:11], v[72:75], v[16:19]
ds_read_b128 v[88:91], v3 offset:3072
ds_read_b128 v[92:95], v3 offset:19456
s_waitcnt lgkmcnt(4)
v_mfma_f32_16x16x32_bf16 v[20:23], a[8:11], v[76:79], v[20:23]
v_mfma_f32_16x16x32_bf16 v[24:27], a[12:15], v[72:75], v[24:27]
buffer_load_dwordx4 v1, s[36:39], s56 offen offset:1024 sc1 lds
v_mfma_f32_16x16x32_bf16 v[28:31], a[12:15], v[76:79], v[28:31]
v_mfma_f32_16x16x32_bf16 v[32:35], v[72:75], a[136:139], v[32:35]
v_mfma_f32_16x16x32_bf16 v[36:39], v[76:79], a[136:139], v[36:39]
v_mfma_f32_16x16x32_bf16 v[40:43], v[72:75], a[140:143], v[40:43]
v_mfma_f32_16x16x32_bf16 v[44:47], v[76:79], a[140:143], v[44:47]
s_waitcnt lgkmcnt(3)
v_mfma_f32_16x16x32_bf16 v[16:19], a[16:19], v[80:83], v[16:19]
ds_read_b128 v[96:99], v3 offset:4096
ds_read_b128 v[100:103], v3 offset:20480
s_waitcnt lgkmcnt(4)
v_mfma_f32_16x16x32_bf16 v[20:23], a[16:19], v[84:87], v[20:23]
v_mfma_f32_16x16x32_bf16 v[24:27], a[20:23], v[80:83], v[24:27]
buffer_load_dwordx4 v1, s[36:39], s56 offen offset:2048 sc1 lds
v_mfma_f32_16x16x32_bf16 v[28:31], a[20:23], v[84:87], v[28:31]
s_waitcnt vmcnt(3)
s_mov_b64 exec, 1
buffer_store_dword v4, off, s[36:39], s58 sc1
s_mov_b64 exec, -1
s_lshl_b32 s58, s62, 10
s_lshl_b32 s55, s32, 8
s_add_u32 s58, s58, s55
s_lshl_b32 s55, s64, 2
s_add_u32 s58, s58, s55
s_add_u32 s58, s58, 2097152
v_mfma_f32_16x16x32_bf16 v[32:35], v[80:83], a[144:147], v[32:35]
v_mfma_f32_16x16x32_bf16 v[36:39], v[84:87], a[144:147], v[36:39]
v_mfma_f32_16x16x32_bf16 v[40:43], v[80:83], a[148:151], v[40:43]
v_mfma_f32_16x16x32_bf16 v[44:47], v[84:87], a[148:151], v[44:47]
s_waitcnt lgkmcnt(3)
v_mfma_f32_16x16x32_bf16 v[16:19], a[24:27], v[88:91], v[16:19]
ds_read_b128 v[104:107], v3 offset:5120
ds_read_b128 v[108:111], v3 offset:21504
s_waitcnt lgkmcnt(4)
v_mfma_f32_16x16x32_bf16 v[20:23], a[24:27], v[92:95], v[20:23]
v_mfma_f32_16x16x32_bf16 v[24:27], a[28:31], v[88:91], v[24:27]
buffer_load_dwordx4 v1, s[36:39], s56 offen offset:3072 sc1 lds
v_mfma_f32_16x16x32_bf16 v[28:31], a[28:31], v[92:95], v[28:31]
v_mfma_f32_16x16x32_bf16 v[32:35], v[88:91], a[152:155], v[32:35]
v_mfma_f32_16x16x32_bf16 v[36:39], v[92:95], a[152:155], v[36:39]
v_mfma_f32_16x16x32_bf16 v[40:43], v[88:91], a[156:159], v[40:43]
v_mfma_f32_16x16x32_bf16 v[44:47], v[92:95], a[156:159], v[44:47]
s_waitcnt lgkmcnt(3)
v_mfma_f32_16x16x32_bf16 v[16:19], a[32:35], v[96:99], v[16:19]
ds_read_b128 v[64:67], v3 offset:6144
ds_read_b128 v[68:71], v3 offset:22528
s_waitcnt lgkmcnt(4)
v_mfma_f32_16x16x32_bf16 v[20:23], a[32:35], v[100:103], v[20:23]
v_mfma_f32_16x16x32_bf16 v[24:27], a[36:39], v[96:99], v[24:27]
s_add_u32 m0, s57, 4096
s_nop 0
buffer_load_dwordx4 v1, s[36:39], s66 offen offset:0 sc1 lds
v_mfma_f32_16x16x32_bf16 v[28:31], a[36:39], v[100:103], v[28:31]
v_mfma_f32_16x16x32_bf16 v[32:35], v[96:99], a[160:163], v[32:35]
v_mfma_f32_16x16x32_bf16 v[36:39], v[100:103], a[160:163], v[36:39]
v_mfma_f32_16x16x32_bf16 v[40:43], v[96:99], a[164:167], v[40:43]
v_mfma_f32_16x16x32_bf16 v[44:47], v[100:103], a[164:167], v[44:47]
s_waitcnt lgkmcnt(3)
v_mfma_f32_16x16x32_bf16 v[16:19], a[40:43], v[104:107], v[16:19]
ds_read_b128 v[72:75], v3 offset:7168
ds_read_b128 v[76:79], v3 offset:23552
s_waitcnt lgkmcnt(4)
v_mfma_f32_16x16x32_bf16 v[20:23], a[40:43], v[108:111], v[20:23]
v_mfma_f32_16x16x32_bf16 v[24:27], a[44:47], v[104:107], v[24:27]
buffer_load_dwordx4 v1, s[36:39], s66 offen offset:1024 sc1 lds
v_mfma_f32_16x16x32_bf16 v[28:31], a[44:47], v[108:111], v[28:31]
v_mfma_f32_16x16x32_bf16 v[32:35], v[104:107], a[168:171], v[32:35]
v_mfma_f32_16x16x32_bf16 v[36:39], v[108:111], a[168:171], v[36:39]
v_mfma_f32_16x16x32_bf16 v[40:43], v[104:107], a[172:175], v[40:43]
v_mfma_f32_16x16x32_bf16 v[44:47], v[108:111], a[172:175], v[44:47]
s_waitcnt lgkmcnt(3)
v_mfma_f32_16x16x32_bf16 v[16:19], a[48:51], v[64:67], v[16:19]
ds_read_b128 v[80:83], v3 offset:8192
ds_read_b128 v[84:87], v3 offset:24576
s_waitcnt lgkmcnt(4)
v_mfma_f32_16x16x32_bf16 v[20:23], a[48:51], v[68:71], v[20:23]
v_mfma_f32_16x16x32_bf16 v[24:27], a[52:55], v[64:67], v[24:27]
buffer_load_dwordx4 v1, s[36:39], s66 offen offset:2048 sc1 lds
v_mfma_f32_16x16x32_bf16 v[28:31], a[52:55], v[68:71], v[28:31]
v_mfma_f32_16x16x32_bf16 v[32:35], v[64:67], a[176:179], v[32:35]
v_mfma_f32_16x16x32_bf16 v[36:39], v[68:71], a[176:179], v[36:39]
v_mfma_f32_16x16x32_bf16 v[40:43], v[64:67], a[180:183], v[40:43]
v_mfma_f32_16x16x32_bf16 v[44:47], v[68:71], a[180:183], v[44:47]
s_waitcnt lgkmcnt(3)
v_mfma_f32_16x16x32_bf16 v[16:19], a[56:59], v[72:75], v[16:19]
ds_read_b128 v[88:91], v3 offset:9216
ds_read_b128 v[92:95], v3 offset:25600
s_waitcnt lgkmcnt(4)
v_mfma_f32_16x16x32_bf16 v[20:23], a[56:59], v[76:79], v[20:23]
v_mfma_f32_16x16x32_bf16 v[24:27], a[60:63], v[72:75], v[24:27]
buffer_load_dwordx4 v1, s[36:39], s66 offen offset:3072 sc1 lds
v_mfma_f32_16x16x32_bf16 v[28:31], a[60:63], v[76:79], v[28:31]
v_mfma_f32_16x16x32_bf16 v[32:35], v[72:75], a[184:187], v[32:35]
v_mfma_f32_16x16x32_bf16 v[36:39], v[76:79], a[184:187], v[36:39]
v_mfma_f32_16x16x32_bf16 v[40:43], v[72:75], a[188:191], v[40:43]
v_mfma_f32_16x16x32_bf16 v[44:47], v[76:79], a[188:191], v[44:47]
s_waitcnt lgkmcnt(3)
v_mfma_f32_16x16x32_bf16 v[16:19], a[64:67], v[80:83], v[16:19]
ds_read_b128 v[96:99], v3 offset:10240
ds_read_b128 v[100:103], v3 offset:26624
s_waitcnt lgkmcnt(4)
v_mfma_f32_16x16x32_bf16 v[20:23], a[64:67], v[84:87], v[20:23]
v_mfma_f32_16x16x32_bf16 v[24:27], a[68:71], v[80:83], v[24:27]
v_mfma_f32_16x16x32_bf16 v[28:31], a[68:71], v[84:87], v[28:31]
v_mfma_f32_16x16x32_bf16 v[32:35], v[80:83], a[192:195], v[32:35]
v_mfma_f32_16x16x32_bf16 v[36:39], v[84:87], a[192:195], v[36:39]
v_mfma_f32_16x16x32_bf16 v[40:43], v[80:83], a[196:199], v[40:43]
v_mfma_f32_16x16x32_bf16 v[44:47], v[84:87], a[196:199], v[44:47]
s_waitcnt lgkmcnt(3)
v_mfma_f32_16x16x32_bf16 v[16:19], a[72:75], v[88:91], v[16:19]
ds_read_b128 v[104:107], v3 offset:11264
ds_read_b128 v[108:111], v3 offset:27648
s_waitcnt lgkmcnt(4)
v_mfma_f32_16x16x32_bf16 v[20:23], a[72:75], v[92:95], v[20:23]
v_mfma_f32_16x16x32_bf16 v[24:27], a[76:79], v[88:91], v[24:27]
v_mfma_f32_16x16x32_bf16 v[28:31], a[76:79], v[92:95], v[28:31]
v_mfma_f32_16x16x32_bf16 v[32:35], v[88:91], a[200:203], v[32:35]
v_mfma_f32_16x16x32_bf16 v[36:39], v[92:95], a[200:203], v[36:39]
v_mfma_f32_16x16x32_bf16 v[40:43], v[88:91], a[204:207], v[40:43]
v_mfma_f32_16x16x32_bf16 v[44:47], v[92:95], a[204:207], v[44:47]
s_waitcnt lgkmcnt(3)
v_mfma_f32_16x16x32_bf16 v[16:19], a[80:83], v[96:99], v[16:19]
ds_read_b128 v[64:67], v3 offset:12288
ds_read_b128 v[68:71], v3 offset:28672
s_waitcnt lgkmcnt(4)
v_mfma_f32_16x16x32_bf16 v[20:23], a[80:83], v[100:103], v[20:23]
v_mfma_f32_16x16x32_bf16 v[24:27], a[84:87], v[96:99], v[24:27]
v_mfma_f32_16x16x32_bf16 v[28:31], a[84:87], v[100:103], v[28:31]
v_mfma_f32_16x16x32_bf16 v[32:35], v[96:99], a[208:211], v[32:35]
v_mfma_f32_16x16x32_bf16 v[36:39], v[100:103], a[208:211], v[36:39]
v_mfma_f32_16x16x32_bf16 v[40:43], v[96:99], a[212:215], v[40:43]
v_mfma_f32_16x16x32_bf16 v[44:47], v[100:103], a[212:215], v[44:47]
s_waitcnt lgkmcnt(3)
v_mfma_f32_16x16x32_bf16 v[16:19], a[88:91], v[104:107], v[16:19]
ds_read_b128 v[72:75], v3 offset:13312
ds_read_b128 v[76:79], v3 offset:29696
s_waitcnt lgkmcnt(4)
v_mfma_f32_16x16x32_bf16 v[20:23], a[88:91], v[108:111], v[20:23]
v_mfma_f32_16x16x32_bf16 v[24:27], a[92:95], v[104:107], v[24:27]
v_mfma_f32_16x16x32_bf16 v[28:31], a[92:95], v[108:111], v[28:31]
v_mfma_f32_16x16x32_bf16 v[32:35], v[104:107], a[216:219], v[32:35]
v_mfma_f32_16x16x32_bf16 v[36:39], v[108:111], a[216:219], v[36:39]
v_mfma_f32_16x16x32_bf16 v[40:43], v[104:107], a[220:223], v[40:43]
v_mfma_f32_16x16x32_bf16 v[44:47], v[108:111], a[220:223], v[44:47]
s_waitcnt lgkmcnt(3)
v_mfma_f32_16x16x32_bf16 v[16:19], a[96:99], v[64:67], v[16:19]
ds_read_b128 v[80:83], v3 offset:14336
ds_read_b128 v[84:87], v3 offset:30720
s_waitcnt lgkmcnt(4)
v_mfma_f32_16x16x32_bf16 v[20:23], a[96:99], v[68:71], v[20:23]
v_mfma_f32_16x16x32_bf16 v[24:27], a[100:103], v[64:67], v[24:27]
v_mfma_f32_16x16x32_bf16 v[28:31], a[100:103], v[68:71], v[28:31]
v_mfma_f32_16x16x32_bf16 v[32:35], v[64:67], a[224:227], v[32:35]
v_mfma_f32_16x16x32_bf16 v[36:39], v[68:71], a[224:227], v[36:39]
v_mfma_f32_16x16x32_bf16 v[40:43], v[64:67], a[228:231], v[40:43]
v_mfma_f32_16x16x32_bf16 v[44:47], v[68:71], a[228:231], v[44:47]
s_waitcnt lgkmcnt(3)
v_mfma_f32_16x16x32_bf16 v[16:19], a[104:107], v[72:75], v[16:19]
ds_read_b128 v[88:91], v3 offset:15360
ds_read_b128 v[92:95], v3 offset:31744
s_waitcnt lgkmcnt(4)
v_mfma_f32_16x16x32_bf16 v[20:23], a[104:107], v[76:79], v[20:23]
v_mfma_f32_16x16x32_bf16 v[24:27], a[108:111], v[72:75], v[24:27]
v_mfma_f32_16x16x32_bf16 v[28:31], a[108:111], v[76:79], v[28:31]
v_mfma_f32_16x16x32_bf16 v[32:35], v[72:75], a[232:235], v[32:35]
v_mfma_f32_16x16x32_bf16 v[36:39], v[76:79], a[232:235], v[36:39]
v_mfma_f32_16x16x32_bf16 v[40:43], v[72:75], a[236:239], v[40:43]
v_mfma_f32_16x16x32_bf16 v[44:47], v[76:79], a[236:239], v[44:47]
s_waitcnt lgkmcnt(3)
v_mfma_f32_16x16x32_bf16 v[16:19], a[112:115], v[80:83], v[16:19]
ds_read_b128 v[96:99], v3 offset:0
ds_read_b128 v[100:103], v3 offset:16384
s_waitcnt lgkmcnt(4)
v_mfma_f32_16x16x32_bf16 v[20:23], a[112:115], v[84:87], v[20:23]
v_mfma_f32_16x16x32_bf16 v[24:27], a[116:119], v[80:83], v[24:27]
v_mfma_f32_16x16x32_bf16 v[28:31], a[116:119], v[84:87], v[28:31]
v_mfma_f32_16x16x32_bf16 v[32:35], v[80:83], a[240:243], v[32:35]
v_mfma_f32_16x16x32_bf16 v[36:39], v[84:87], a[240:243], v[36:39]
v_mfma_f32_16x16x32_bf16 v[40:43], v[80:83], a[244:247], v[40:43]
v_mfma_f32_16x16x32_bf16 v[44:47], v[84:87], a[244:247], v[44:47]
s_waitcnt lgkmcnt(3)
v_mfma_f32_16x16x32_bf16 v[16:19], a[120:123], v[88:91], v[16:19]
ds_read_b128 v[104:107], v3 offset:1024
ds_read_b128 v[108:111], v3 offset:17408
s_waitcnt lgkmcnt(4)
v_mfma_f32_16x16x32_bf16 v[20:23], a[120:123], v[92:95], v[20:23]
v_mfma_f32_16x16x32_bf16 v[24:27], a[124:127], v[88:91], v[24:27]
v_mfma_f32_16x16x32_bf16 v[28:31], a[124:127], v[92:95], v[28:31]
v_mfma_f32_16x16x32_bf16 v[32:35], v[88:91], a[248:251], v[32:35]
v_mfma_f32_16x16x32_bf16 v[36:39], v[92:95], a[248:251], v[36:39]
v_mfma_f32_16x16x32_bf16 v[40:43], v[88:91], a[252:255], v[40:43]
v_mfma_f32_16x16x32_bf16 v[44:47], v[92:95], a[252:255], v[44:47]
s_waitcnt lgkmcnt(3)
v_mfma_f32_16x16x32_bf16 v[48:51], v[128:131], v[96:99], 0
ds_read_b128 v[64:67], v3 offset:2048
ds_read_b128 v[68:71], v3 offset:18432
s_waitcnt lgkmcnt(4)
v_mfma_f32_16x16x32_bf16 v[52:55], v[128:131], v[100:103], 0
v_mfma_f32_16x16x32_bf16 v[56:59], v[132:135], v[96:99], 0
s_lshl_b32 s54, s64, 19
s_lshl_b32 s55, s62, 14
v_mfma_f32_16x16x32_bf16 v[60:63], v[132:135], v[100:103], 0
s_add_u32 s54, s54, s55
s_lshl_b32 s55, s32, 12
s_waitcnt lgkmcnt(3)
v_mfma_f32_16x16x32_bf16 v[48:51], v[136:139], v[104:107], v[48:51]
ds_read_b128 v[72:75], v3 offset:3072
ds_read_b128 v[76:79], v3 offset:19456
s_waitcnt lgkmcnt(4)
v_mfma_f32_16x16x32_bf16 v[52:55], v[136:139], v[108:111], v[52:55]
s_add_u32 s54, s54, s55
s_add_u32 s54, s54, 16777216
v_mfma_f32_16x16x32_bf16 v[56:59], v[140:143], v[104:107], v[56:59]
v_cvt_pk_bf16_f32 v112, v16, v24
v_cvt_pk_bf16_f32 v113, v17, v25
v_mfma_f32_16x16x32_bf16 v[60:63], v[140:143], v[108:111], v[60:63]
v_cvt_pk_bf16_f32 v114, v18, v26
v_cvt_pk_bf16_f32 v115, v19, v27
s_waitcnt lgkmcnt(3)
v_mfma_f32_16x16x32_bf16 v[48:51], v[144:147], v[64:67], v[48:51]
ds_read_b128 v[80:83], v3 offset:4096
ds_read_b128 v[84:87], v3 offset:20480
s_waitcnt lgkmcnt(4)
v_mfma_f32_16x16x32_bf16 v[52:55], v[144:147], v[68:71], v[52:55]
buffer_store_dwordx4 v[112:115], v1, s[36:39], s54 offen offset:0 sc1
v_mfma_f32_16x16x32_bf16 v[56:59], v[148:151], v[64:67], v[56:59]
v_cvt_pk_bf16_f32 v116, v20, v28
v_cvt_pk_bf16_f32 v117, v21, v29
v_mfma_f32_16x16x32_bf16 v[60:63], v[148:151], v[68:71], v[60:63]
v_cvt_pk_bf16_f32 v118, v22, v30
v_cvt_pk_bf16_f32 v119, v23, v31
s_waitcnt lgkmcnt(3)
v_mfma_f32_16x16x32_bf16 v[48:51], v[152:155], v[72:75], v[48:51]
ds_read_b128 v[88:91], v3 offset:5120
ds_read_b128 v[92:95], v3 offset:21504
s_waitcnt lgkmcnt(4)
v_mfma_f32_16x16x32_bf16 v[52:55], v[152:155], v[76:79], v[52:55]
buffer_store_dwordx4 v[116:119], v1, s[36:39], s54 offen offset:1024 sc1
v_mfma_f32_16x16x32_bf16 v[56:59], v[156:159], v[72:75], v[56:59]
v_cvt_pk_bf16_f32 v120, v32, v33
v_cvt_pk_bf16_f32 v121, v34, v35
v_mfma_f32_16x16x32_bf16 v[60:63], v[156:159], v[76:79], v[60:63]
v_cvt_pk_bf16_f32 v122, v36, v37
v_cvt_pk_bf16_f32 v123, v38, v39
s_waitcnt lgkmcnt(3)
v_mfma_f32_16x16x32_bf16 v[48:51], v[160:163], v[80:83], v[48:51]
ds_read_b128 v[96:99], v3 offset:6144
ds_read_b128 v[100:103], v3 offset:22528
s_waitcnt lgkmcnt(4)
v_mfma_f32_16x16x32_bf16 v[52:55], v[160:163], v[84:87], v[52:55]
buffer_store_dwordx4 v[120:123], v1, s[36:39], s54 offen offset:2048 sc1
v_mfma_f32_16x16x32_bf16 v[56:59], v[164:167], v[80:83], v[56:59]
v_cvt_pk_bf16_f32 v124, v40, v41
v_cvt_pk_bf16_f32 v125, v42, v43
v_mfma_f32_16x16x32_bf16 v[60:63], v[164:167], v[84:87], v[60:63]
v_cvt_pk_bf16_f32 v126, v44, v45
v_cvt_pk_bf16_f32 v127, v46, v47
s_waitcnt lgkmcnt(3)
v_mfma_f32_16x16x32_bf16 v[48:51], v[168:171], v[88:91], v[48:51]
ds_read_b128 v[104:107], v3 offset:7168
ds_read_b128 v[108:111], v3 offset:23552
s_waitcnt lgkmcnt(4)
v_mfma_f32_16x16x32_bf16 v[52:55], v[168:171], v[92:95], v[52:55]
buffer_store_dwordx4 v[124:127], v1, s[36:39], s54 offen offset:3072 sc1
v_mfma_f32_16x16x32_bf16 v[56:59], v[172:175], v[88:91], v[56:59]
v_mfma_f32_16x16x32_bf16 v[60:63], v[172:175], v[92:95], v[60:63]
s_waitcnt lgkmcnt(3)
v_mfma_f32_16x16x32_bf16 v[48:51], v[176:179], v[96:99], v[48:51]
ds_read_b128 v[64:67], v3 offset:8192
ds_read_b128 v[68:71], v3 offset:24576
s_waitcnt lgkmcnt(4)
v_mfma_f32_16x16x32_bf16 v[52:55], v[176:179], v[100:103], v[52:55]
v_mfma_f32_16x16x32_bf16 v[56:59], v[180:183], v[96:99], v[56:59]
v_mfma_f32_16x16x32_bf16 v[60:63], v[180:183], v[100:103], v[60:63]
s_waitcnt lgkmcnt(3)
v_mfma_f32_16x16x32_bf16 v[48:51], v[184:187], v[104:107], v[48:51]
ds_read_b128 v[72:75], v3 offset:9216
ds_read_b128 v[76:79], v3 offset:25600
s_waitcnt lgkmcnt(4)
v_mfma_f32_16x16x32_bf16 v[52:55], v[184:187], v[108:111], v[52:55]
v_mfma_f32_16x16x32_bf16 v[56:59], v[188:191], v[104:107], v[56:59]
v_mfma_f32_16x16x32_bf16 v[60:63], v[188:191], v[108:111], v[60:63]
s_waitcnt lgkmcnt(3)
v_mfma_f32_16x16x32_bf16 v[48:51], v[192:195], v[64:67], v[48:51]
ds_read_b128 v[80:83], v3 offset:10240
ds_read_b128 v[84:87], v3 offset:26624
s_waitcnt lgkmcnt(4)
v_mfma_f32_16x16x32_bf16 v[52:55], v[192:195], v[68:71], v[52:55]
v_mfma_f32_16x16x32_bf16 v[56:59], v[196:199], v[64:67], v[56:59]
v_mfma_f32_16x16x32_bf16 v[60:63], v[196:199], v[68:71], v[60:63]
s_waitcnt lgkmcnt(3)
v_mfma_f32_16x16x32_bf16 v[48:51], v[200:203], v[72:75], v[48:51]
ds_read_b128 v[88:91], v3 offset:11264
ds_read_b128 v[92:95], v3 offset:27648
s_waitcnt lgkmcnt(4)
v_mfma_f32_16x16x32_bf16 v[52:55], v[200:203], v[76:79], v[52:55]
v_mfma_f32_16x16x32_bf16 v[56:59], v[204:207], v[72:75], v[56:59]
v_mfma_f32_16x16x32_bf16 v[60:63], v[204:207], v[76:79], v[60:63]
s_waitcnt lgkmcnt(3)
v_mfma_f32_16x16x32_bf16 v[48:51], v[208:211], v[80:83], v[48:51]
ds_read_b128 v[96:99], v3 offset:12288
ds_read_b128 v[100:103], v3 offset:28672
s_waitcnt lgkmcnt(4)
v_mfma_f32_16x16x32_bf16 v[52:55], v[208:211], v[84:87], v[52:55]
v_mfma_f32_16x16x32_bf16 v[56:59], v[212:215], v[80:83], v[56:59]
v_mfma_f32_16x16x32_bf16 v[60:63], v[212:215], v[84:87], v[60:63]
s_waitcnt lgkmcnt(3)
v_mfma_f32_16x16x32_bf16 v[48:51], v[216:219], v[88:91], v[48:51]
ds_read_b128 v[104:107], v3 offset:13312
ds_read_b128 v[108:111], v3 offset:29696
s_waitcnt lgkmcnt(4)
v_mfma_f32_16x16x32_bf16 v[52:55], v[216:219], v[92:95], v[52:55]
v_mfma_f32_16x16x32_bf16 v[56:59], v[220:223], v[88:91], v[56:59]
v_mfma_f32_16x16x32_bf16 v[60:63], v[220:223], v[92:95], v[60:63]
s_waitcnt lgkmcnt(3)
v_mfma_f32_16x16x32_bf16 v[48:51], v[224:227], v[96:99], v[48:51]
ds_read_b128 v[64:67], v3 offset:14336
ds_read_b128 v[68:71], v3 offset:30720
s_waitcnt lgkmcnt(4)
v_mfma_f32_16x16x32_bf16 v[52:55], v[224:227], v[100:103], v[52:55]
v_mfma_f32_16x16x32_bf16 v[56:59], v[228:231], v[96:99], v[56:59]
v_mfma_f32_16x16x32_bf16 v[60:63], v[228:231], v[100:103], v[60:63]
s_waitcnt lgkmcnt(3)
v_mfma_f32_16x16x32_bf16 v[48:51], v[232:235], v[104:107], v[48:51]
ds_read_b128 v[72:75], v3 offset:15360
ds_read_b128 v[76:79], v3 offset:31744
s_waitcnt lgkmcnt(4)
v_mfma_f32_16x16x32_bf16 v[52:55], v[232:235], v[108:111], v[52:55]
v_mfma_f32_16x16x32_bf16 v[56:59], v[236:239], v[104:107], v[56:59]
v_mfma_f32_16x16x32_bf16 v[60:63], v[236:239], v[108:111], v[60:63]
s_waitcnt lgkmcnt(3)
v_mfma_f32_16x16x32_bf16 v[48:51], v[240:243], v[64:67], v[48:51]
s_waitcnt lgkmcnt(2)
v_mfma_f32_16x16x32_bf16 v[52:55], v[240:243], v[68:71], v[52:55]
v_mfma_f32_16x16x32_bf16 v[56:59], v[244:247], v[64:67], v[56:59]
v_mfma_f32_16x16x32_bf16 v[60:63], v[244:247], v[68:71], v[60:63]
s_waitcnt lgkmcnt(1)
v_mfma_f32_16x16x32_bf16 v[48:51], v[248:251], v[72:75], v[48:51]
s_waitcnt lgkmcnt(0)
v_mfma_f32_16x16x32_bf16 v[52:55], v[248:251], v[76:79], v[52:55]
v_mfma_f32_16x16x32_bf16 v[56:59], v[252:255], v[72:75], v[56:59]
v_mfma_f32_16x16x32_bf16 v[60:63], v[252:255], v[76:79], v[60:63]
v_xor_b32 v3, 0x8000, v3
s_nop 2
v_cvt_pk_bf16_f32 v8, v48, v56
v_cvt_pk_bf16_f32 v9, v49, v57
v_cvt_pk_bf16_f32 v10, v50, v58
v_cvt_pk_bf16_f32 v11, v51, v59
ds_write_b128 v6, v[8:11] offset:0
v_cvt_pk_bf16_f32 v12, v52, v60
v_cvt_pk_bf16_f32 v13, v53, v61
v_cvt_pk_bf16_f32 v14, v54, v62
v_cvt_pk_bf16_f32 v15, v55, v63
ds_write_b128 v6, v[12:15] offset:4096
v_add_u32 v6, 8192, v6
s_waitcnt vmcnt(4) lgkmcnt(0)
s_barrier
s_add_u32 s64, s64, s60
s_cmp_lt_u32 s64, 64
s_cbranch_scc1 L_qkv_loop
s_waitcnt vmcnt(0)
s_mov_b64 exec, 1
buffer_store_dword v4, off, s[36:39], s58 sc1
s_mov_b64 exec, -1
s_barrier
s_cmp_lg_u32 s32, 0
s_cbranch_scc1 L_w1
v_mov_b32 v8, 64
L_wc_4:
global_load_dword v9, v8, s[28:29] sc1
s_waitcnt vmcnt(0)
v_readfirstlane_b32 s54, v9
s_nop 0
s_cmp_ge_u32 s54, 11
s_cbranch_scc1 L_wcd_5
s_add_u32 s35, s35, 1
s_cmp_gt_u32 s35, 131072
s_cbranch_scc1 L_END
s_sleep 8
s_branch L_wc_4
L_wcd_5:
L_w1:
s_barrier
s_cmp_ge_u32 s34, 208
s_cbranch_scc1 L_noffn
s_sub_u32 s55, s34, 32
s_mul_i32 s64, s55, 5958
s_lshr_b32 s64, s64, 16
s_mul_i32 s54, s64, 11
s_sub_u32 s54, s55, s54
s_lshl_b32 s65, s54, 2
s_add_u32 s65, s65, s32
s_lshl_b32 s54, s65, 16
s_add_u32 s54, s54, 100663296
buffer_load_dwordx4 a[0:3], v1, s[36:39], s54 offen offset:0 sc1
buffer_load_dwordx4 a[4:7], v1, s[36:39], s54 offen offset:1024 sc1
buffer_load_dwordx4 a[8:11], v1, s[36:39], s54 offen offset:2048 sc1
buffer_load_dwordx4 a[12:15], v1, s[36:39], s54 offen offset:3072 sc1
s_add_u32 s54, s54, 4096
buffer_load_dwordx4 a[16:19], v1, s[36:39], s54 offen offset:0 sc1
buffer_load_dwordx4 a[20:23], v1, s[36:39], s54 offen offset:1024 sc1
buffer_load_dwordx4 a[24:27], v1, s[36:39], s54 offen offset:2048 sc1
buffer_load_dwordx4 a[28:31], v1, s[36:39], s54 offen offset:3072 sc1
s_add_u32 s54, s54, 4096
s_waitcnt vmcnt(4)
buffer_load_dwordx4 a[32:35], v1, s[36:39], s54 offen offset:0 sc1
buffer_load_dwordx4 a[36:39], v1, s[36:39], s54 offen offset:1024 sc1
buffer_load_dwordx4 a[40:43], v1, s[36:39], s54 offen offset:2048 sc1
buffer_load_dwordx4 a[44:47], v1, s[36:39], s54 offen offset:3072 sc1
s_add_u32 s54, s54, 4096
s_waitcnt vmcnt(4)
buffer_load_dwordx4 a[48:51], v1, s[36:39], s54 offen offset:0 sc1
buffer_load_dwordx4 a[52:55], v1, s[36:39], s54 offen offset:1024 sc1
buffer_load_dwordx4 a[56:59], v1, s[36:39], s54 offen offset:2048 sc1
buffer_load_dwordx4 a[60:63], v1, s[36:39], s54 offen offset:3072 sc1
s_add_u32 s54, s54, 4096
s_waitcnt vmcnt(4)
buffer_load_dwordx4 a[64:67], v1, s[36:39], s54 offen offset:0 sc1
buffer_load_dwordx4 a[68:71], v1, s[36:39], s54 offen offset:1024 sc1
buffer_load_dwordx4 a[72:75], v1, s[36:39], s54 offen offset:2048 sc1
buffer_load_dwordx4 a[76:79], v1, s[36:39], s54 offen offset:3072 sc1
s_add_u32 s54, s54, 4096
s_waitcnt vmcnt(4)
buffer_load_dwordx4 a[80:83], v1, s[36:39], s54 offen offset:0 sc1
buffer_load_dwordx4 a[84:87], v1, s[36:39], s54 offen offset:1024 sc1
buffer_load_dwordx4 a[88:91], v1, s[36:39], s54 offen offset:2048 sc1
buffer_load_dwordx4 a[92:95], v1, s[36:39], s54 offen offset:3072 sc1
s_add_u32 s54, s54, 4096
s_waitcnt vmcnt(4)
buffer_load_dwordx4 a[96:99], v1, s[36:39], s54 offen offset:0 sc1
buffer_load_dwordx4 a[100:103], v1, s[36:39], s54 offen offset:1024 sc1
buffer_load_dwordx4 a[104:107], v1, s[36:39], s54 offen offset:2048 sc1
buffer_load_dwordx4 a[108:111], v1, s[36:39], s54 offen offset:3072 sc1
s_add_u32 s54, s54, 4096
s_waitcnt vmcnt(4)
buffer_load_dwordx4 a[112:115], v1, s[36:39], s54 offen offset:0 sc1
buffer_load_dwordx4 a[116:119], v1, s[36:39], s54 offen offset:1024 sc1
buffer_load_dwordx4 a[120:123], v1, s[36:39], s54 offen offset:2048 sc1
buffer_load_dwordx4 a[124:127], v1, s[36:39], s54 offen offset:3072 sc1
s_add_u32 s54, s54, 4096
s_waitcnt vmcnt(4)
buffer_load_dwordx4 a[128:131], v1, s[36:39], s54 offen offset:0 sc1
buffer_load_dwordx4 a[132:135], v1, s[36:39], s54 offen offset:1024 sc1
buffer_load_dwordx4 a[136:139], v1, s[36:39], s54 offen offset:2048 sc1
buffer_load_dwordx4 a[140:143], v1, s[36:39], s54 offen offset:3072 sc1
s_add_u32 s54, s54, 4096
s_waitcnt vmcnt(4)
buffer_load_dwordx4 a[144:147], v1, s[36:39], s54 offen offset:0 sc1
buffer_load_dwordx4 a[148:151], v1, s[36:39], s54 offen offset:1024 sc1
buffer_load_dwordx4 a[152:155], v1, s[36:39], s54 offen offset:2048 sc1
buffer_load_dwordx4 a[156:159], v1, s[36:39], s54 offen offset:3072 sc1
s_add_u32 s54, s54, 4096
s_waitcnt vmcnt(4)
buffer_load_dwordx4 a[160:163], v1, s[36:39], s54 offen offset:0 sc1
buffer_load_dwordx4 a[164:167], v1, s[36:39], s54 offen offset:1024 sc1
buffer_load_dwordx4 a[168:171], v1, s[36:39], s54 offen offset:2048 sc1
buffer_load_dwordx4 a[172:175], v1, s[36:39], s54 offen offset:3072 sc1
s_add_u32 s54, s54, 4096
s_waitcnt vmcnt(4)
buffer_load_dwordx4 a[176:179], v1, s[36:39], s54 offen offset:0 sc1
buffer_load_dwordx4 a[180:183], v1, s[36:39], s54 offen offset:1024 sc1
buffer_load_dwordx4 a[184:187], v1, s[36:39], s54 offen offset:2048 sc1
buffer_load_dwordx4 a[188:191], v1, s[36:39], s54 offen offset:3072 sc1
s_add_u32 s54, s54, 4096
s_waitcnt vmcnt(4)
buffer_load_dwordx4 a[192:195], v1, s[36:39], s54 offen offset:0 sc1
buffer_load_dwordx4 a[196:199], v1, s[36:39], s54 offen offset:1024 sc1
buffer_load_dwordx4 a[200:203], v1, s[36:39], s54 offen offset:2048 sc1
buffer_load_dwordx4 a[204:207], v1, s[36:39], s54 offen offset:3072 sc1
s_add_u32 s54, s54, 4096
s_waitcnt vmcnt(4)
buffer_load_dwordx4 a[208:211], v1, s[36:39], s54 offen offset:0 sc1
buffer_load_dwordx4 a[212:215], v1, s[36:39], s54 offen offset:1024 sc1
buffer_load_dwordx4 a[216:219], v1, s[36:39], s54 offen offset:2048 sc1
buffer_load_dwordx4 a[220:223], v1, s[36:39], s54 offen offset:3072 sc1
s_add_u32 s54, s54, 4096
s_waitcnt vmcnt(4)
buffer_load_dwordx4 a[224:227], v1, s[36:39], s54 offen offset:0 sc1
buffer_load_dwordx4 a[228:231], v1, s[36:39], s54 offen offset:1024 sc1
buffer_load_dwordx4 a[232:235], v1, s[36:39], s54 offen offset:2048 sc1
buffer_load_dwordx4 a[236:239], v1, s[36:39], s54 offen offset:3072 sc1
s_add_u32 s54, s54, 4096
s_waitcnt vmcnt(4)
buffer_load_dwordx4 a[240:243], v1, s[36:39], s54 offen offset:0 sc1
buffer_load_dwordx4 a[244:247], v1, s[36:39], s54 offen offset:1024 sc1
buffer_load_dwordx4 a[248:251], v1, s[36:39], s54 offen offset:2048 sc1
buffer_load_dwordx4 a[252:255], v1, s[36:39], s54 offen offset:3072 sc1
s_waitcnt vmcnt(0)
s_mov_b32 s59, 0xffff0000
v_lshlrev_b32 v1, 4, v0
v_mov_b32 v3, v1
v_mov_b32 v4, 1
s_lshl_b32 s57, s32, 13
s_lshl_b32 s58, s34, 2
s_add_u32 s58, s58, s32
s_lshl_b32 s58, s58, 7
s_add_u32 s58, s58, 5242880
s_mov_b32 s61, s64
s_barrier
s_lshl_b32 s56, s61, 15
s_lshl_b32 s55, s32, 13
s_add_u32 s56, s56, s55
s_add_u32 s66, s56, 4096
s_add_u32 m0, s57, 0
s_nop 0
buffer_load_dwordx4 v1, s[36:39], s56 offen offset:0 sc1 lds
buffer_load_dwordx4 v1, s[36:39], s56 offen offset:1024 sc1 lds
buffer_load_dwordx4 v1, s[36:39], s56 offen offset:2048 sc1 lds
buffer_load_dwordx4 v1, s[36:39], s56 offen offset:3072 sc1 lds
s_add_u32 m0, s57, 4096
s_nop 0
buffer_load_dwordx4 v1, s[36:39], s66 offen offset:0 sc1 lds
buffer_load_dwordx4 v1, s[36:39], s66 offen offset:1024 sc1 lds
buffer_load_dwordx4 v1, s[36:39], s66 offen offset:2048 sc1 lds
buffer_load_dwordx4 v1, s[36:39], s66 offen offset:3072 sc1 lds
s_waitcnt vmcnt(0)
s_barrier
L_ffn_loop:
ds_read_b128 v[64:67], v3 offset:0
ds_read_b128 v[68:71], v3 offset:1024
ds_read_b128 v[72:75], v3 offset:2048
ds_read_b128 v[76:79], v3 offset:3072
s_mov_b32 s60, 16
s_add_u32 s61, s64, s60
s_min_u32 s61, s61, 63
s_xor_b32 s57, s57, 0x8000
s_lshl_b32 s56, s61, 15
s_lshl_b32 s55, s32, 13
s_add_u32 s56, s56, s55
s_add_u32 s66, s56, 4096
s_waitcnt lgkmcnt(3)
v_mfma_f32_16x16x32_bf16 v[16:19], a[0:3], v[64:67], 0
ds_read_b128 v[80:83], v3 offset:4096
ds_read_b128 v[84:87], v3 offset:5120
v_mfma_f32_16x16x32_bf16 v[24:27], a[4:7], v[64:67], 0
v_mfma_f32_16x16x32_bf16 v[32:35], a[128:131], v[64:67], 0
s_add_u32 m0, s57, 0
s_nop 0
buffer_load_dwordx4 v1, s[36:39], s56 offen offset:0 sc1 lds
v_mfma_f32_16x16x32_bf16 v[40:43], a[132:135], v[64:67], 0
s_waitcnt lgkmcnt(4)
v_mfma_f32_16x16x32_bf16 v[16:19], a[8:11], v[68:71], v[16:19]
v_mfma_f32_16x16x32_bf16 v[24:27], a[12:15], v[68:71], v[24:27]
v_mfma_f32_16x16x32_bf16 v[32:35], a[136:139], v[68:71], v[32:35]
v_mfma_f32_16x16x32_bf16 v[40:43], a[140:143], v[68:71], v[40:43]
s_waitcnt lgkmcnt(3)
v_mfma_f32_16x16x32_bf16 v[16:19], a[16:19], v[72:75], v[16:19]
ds_read_b128 v[88:91], v3 offset:6144
ds_read_b128 v[92:95], v3 offset:7168
v_mfma_f32_16x16x32_bf16 v[24:27], a[20:23], v[72:75], v[24:27]
v_mfma_f32_16x16x32_bf16 v[32:35], a[144:147], v[72:75], v[32:35]
buffer_load_dwordx4 v1, s[36:39], s56 offen offset:1024 sc1 lds
v_mfma_f32_16x16x32_bf16 v[40:43], a[148:151], v[72:75], v[40:43]
s_waitcnt lgkmcnt(4)
v_mfma_f32_16x16x32_bf16 v[16:19], a[24:27], v[76:79], v[16:19]
v_mfma_f32_16x16x32_bf16 v[24:27], a[28:31], v[76:79], v[24:27]
v_mfma_f32_16x16x32_bf16 v[32:35], a[152:155], v[76:79], v[32:35]
v_mfma_f32_16x16x32_bf16 v[40:43], a[156:159], v[76:79], v[40:43]
s_waitcnt lgkmcnt(3)
v_mfma_f32_16x16x32_bf16 v[16:19], a[32:35], v[80:83], v[16:19]
ds_read_b128 v[96:99], v3 offset:8192
ds_read_b128 v[100:103], v3 offset:9216
v_mfma_f32_16x16x32_bf16 v[24:27], a[36:39], v[80:83], v[24:27]
v_mfma_f32_16x16x32_bf16 v[32:35], a[160:163], v[80:83], v[32:35]
buffer_load_dwordx4 v1, s[36:39], s56 offen offset:2048 sc1 lds
v_mfma_f32_16x16x32_bf16 v[40:43], a[164:167], v[80:83], v[40:43]
s_waitcnt lgkmcnt(4)
v_mfma_f32_16x16x32_bf16 v[16:19], a[40:43], v[84:87], v[16:19]
v_mfma_f32_16x16x32_bf16 v[24:27], a[44:47], v[84:87], v[24:27]
v_mfma_f32_16x16x32_bf16 v[32:35], a[168:171], v[84:87], v[32:35]
v_mfma_f32_16x16x32_bf16 v[40:43], a[172:175], v[84:87], v[40:43]
s_waitcnt lgkmcnt(3)
v_mfma_f32_16x16x32_bf16 v[16:19], a[48:51], v[88:91], v[16:19]
ds_read_b128 v[104:107], v3 offset:10240
ds_read_b128 v[108:111], v3 offset:11264
v_mfma_f32_16x16x32_bf16 v[24:27], a[52:55], v[88:91], v[24:27]
v_mfma_f32_16x16x32_bf16 v[32:35], a[176:179], v[88:91], v[32:35]
buffer_load_dwordx4 v1, s[36:39], s56 offen offset:3072 sc1 lds
v_mfma_f32_16x16x32_bf16 v[40:43], a[180:183], v[88:91], v[40:43]
s_waitcnt lgkmcnt(4)
v_mfma_f32_16x16x32_bf16 v[16:19], a[56:59], v[92:95], v[16:19]
v_mfma_f32_16x16x32_bf16 v[24:27], a[60:63], v[92:95], v[24:27]
v_mfma_f32_16x16x32_bf16 v[32:35], a[184:187], v[92:95], v[32:35]
v_mfma_f32_16x16x32_bf16 v[40:43], a[188:191], v[92:95], v[40:43]
s_waitcnt lgkmcnt(3)
v_mfma_f32_16x16x32_bf16 v[16:19], a[64:67], v[96:99], v[16:19]
ds_read_b128 v[64:67], v3 offset:12288
ds_read_b128 v[68:71], v3 offset:13312
v_mfma_f32_16x16x32_bf16 v[24:27], a[68:71], v[96:99], v[24:27]
v_mfma_f32_16x16x32_bf16 v[32:35], a[192:195], v[96:99], v[32:35]
s_add_u32 m0, s57, 4096
s_nop 0
buffer_load_dwordx4 v1, s[36:39], s66 offen offset:0 sc1 lds
v_mfma_f32_16x16x32_bf16 v[40:43], a[196:199], v[96:99], v[40:43]
s_waitcnt lgkmcnt(4)
v_mfma_f32_16x16x32_bf16 v[16:19], a[72:75], v[100:103], v[16:19]
v_mfma_f32_16x16x32_bf16 v[24:27], a[76:79], v[100:103], v[24:27]
v_mfma_f32_16x16x32_bf16 v[32:35], a[200:203], v[100:103], v[32:35]
v_mfma_f32_16x16x32_bf16 v[40:43], a[204:207], v[100:103], v[40:43]
s_waitcnt lgkmcnt(3)
v_mfma_f32_16x16x32_bf16 v[16:19], a[80:83], v[104:107], v[16:19]
ds_read_b128 v[72:75], v3 offset:14336
ds_read_b128 v[76:79], v3 offset:15360
v_mfma_f32_16x16x32_bf16 v[24:27], a[84:87], v[104:107], v[24:27]
v_mfma_f32_16x16x32_bf16 v[32:35], a[208:211], v[104:107], v[32:35]
buffer_load_dwordx4 v1, s[36:39], s66 offen offset:1024 sc1 lds
v_mfma_f32_16x16x32_bf16 v[40:43], a[212:215], v[104:107], v[40:43]
s_waitcnt lgkmcnt(4)
v_mfma_f32_16x16x32_bf16 v[16:19], a[88:91], v[108:111], v[16:19]
v_mfma_f32_16x16x32_bf16 v[24:27], a[92:95], v[108:111], v[24:27]
v_mfma_f32_16x16x32_bf16 v[32:35], a[216:219], v[108:111], v[32:35]
v_mfma_f32_16x16x32_bf16 v[40:43], a[220:223], v[108:111], v[40:43]
s_waitcnt lgkmcnt(3)
v_mfma_f32_16x16x32_bf16 v[16:19], a[96:99], v[64:67], v[16:19]
ds_read_b128 v[80:83], v3 offset:16384
ds_read_b128 v[84:87], v3 offset:17408
v_mfma_f32_16x16x32_bf16 v[24:27], a[100:103], v[64:67], v[24:27]
v_mfma_f32_16x16x32_bf16 v[32:35], a[224:227], v[64:67], v[32:35]
buffer_load_dwordx4 v1, s[36:39], s66 offen offset:2048 sc1 lds
v_mfma_f32_16x16x32_bf16 v[40:43], a[228:231], v[64:67], v[40:43]
s_waitcnt lgkmcnt(4)
v_mfma_f32_16x16x32_bf16 v[16:19], a[104:107], v[68:71], v[16:19]
v_mfma_f32_16x16x32_bf16 v[24:27], a[108:111], v[68:71], v[24:27]
v_mfma_f32_16x16x32_bf16 v[32:35], a[232:235], v[68:71], v[32:35]
v_mfma_f32_16x16x32_bf16 v[40:43], a[236:239], v[68:71], v[40:43]
s_waitcnt lgkmcnt(3)
v_mfma_f32_16x16x32_bf16 v[16:19], a[112:115], v[72:75], v[16:19]
ds_read_b128 v[88:91], v3 offset:18432
ds_read_b128 v[92:95], v3 offset:19456
v_mfma_f32_16x16x32_bf16 v[24:27], a[116:119], v[72:75], v[24:27]
v_mfma_f32_16x16x32_bf16 v[32:35], a[240:243], v[72:75], v[32:35]
buffer_load_dwordx4 v1, s[36:39], s66 offen offset:3072 sc1 lds
v_mfma_f32_16x16x32_bf16 v[40:43], a[244:247], v[72:75], v[40:43]
s_waitcnt lgkmcnt(4)
v_mfma_f32_16x16x32_bf16 v[16:19], a[120:123], v[76:79], v[16:19]
v_mfma_f32_16x16x32_bf16 v[24:27], a[124:127], v[76:79], v[24:27]
v_mfma_f32_16x16x32_bf16 v[32:35], a[248:251], v[76:79], v[32:35]
v_mfma_f32_16x16x32_bf16 v[40:43], a[252:255], v[76:79], v[40:43]
s_waitcnt lgkmcnt(3)
v_mfma_f32_16x16x32_bf16 v[20:23], a[0:3], v[80:83], 0
ds_read_b128 v[96:99], v3 offset:20480
ds_read_b128 v[100:103], v3 offset:21504
v_mfma_f32_16x16x32_bf16 v[28:31], a[4:7], v[80:83], 0
v_mfma_f32_16x16x32_bf16 v[36:39], a[128:131], v[80:83], 0
s_mul_i32 s54, s64, 90112
s_lshl_b32 s55, s65, 10
v_mfma_f32_16x16x32_bf16 v[44:47], a[132:135], v[80:83], 0
s_add_u32 s54, s54, s55
s_add_u32 s54, s54, 84934656
s_waitcnt lgkmcnt(4)
v_mfma_f32_16x16x32_bf16 v[20:23], a[8:11], v[84:87], v[20:23]
s_add_u32 s67, s54, 45056
v_cvt_pk_bf16_f32 v120, v16, v24
v_mfma_f32_16x16x32_bf16 v[28:31], a[12:15], v[84:87], v[28:31]
v_cvt_pk_bf16_f32 v121, v32, v40
v_lshlrev_b32 v16, 16, v120
v_mfma_f32_16x16x32_bf16 v[36:39], a[136:139], v[84:87], v[36:39]
v_and_b32 v24, s59, v120
v_lshlrev_b32 v32, 16, v121
v_mfma_f32_16x16x32_bf16 v[44:47], a[140:143], v[84:87], v[44:47]
v_and_b32 v40, s59, v121
v_max_f32 v16, 0, v16
s_waitcnt lgkmcnt(3)
v_mfma_f32_16x16x32_bf16 v[20:23], a[16:19], v[88:91], v[20:23]
ds_read_b128 v[104:107], v3 offset:22528
ds_read_b128 v[108:111], v3 offset:23552
v_mfma_f32_16x16x32_bf16 v[28:31], a[20:23], v[88:91], v[28:31]
v_max_f32 v24, 0, v24
v_mul_f32 v16, v16, v32
v_mfma_f32_16x16x32_bf16 v[36:39], a[144:147], v[88:91], v[36:39]
v_mul_f32 v24, v24, v40
v_cvt_pk_bf16_f32 v112, v16, v24
v_mfma_f32_16x16x32_bf16 v[44:47], a[148:151], v[88:91], v[44:47]
v_cvt_pk_bf16_f32 v120, v17, v25
v_cvt_pk_bf16_f32 v121, v33, v41
s_waitcnt lgkmcnt(4)
v_mfma_f32_16x16x32_bf16 v[20:23], a[24:27], v[92:95], v[20:23]
v_lshlrev_b32 v17, 16, v120
v_and_b32 v25, s59, v120
v_mfma_f32_16x16x32_bf16 v[28:31], a[28:31], v[92:95], v[28:31]
v_lshlrev_b32 v33, 16, v121
v_and_b32 v41, s59, v121
v_mfma_f32_16x16x32_bf16 v[36:39], a[152:155], v[92:95], v[36:39]
v_max_f32 v17, 0, v17
v_max_f32 v25, 0, v25
v_mfma_f32_16x16x32_bf16 v[44:47], a[156:159], v[92:95], v[44:47]
v_mul_f32 v17, v17, v33
v_mul_f32 v25, v25, v41
s_waitcnt lgkmcnt(3)
v_mfma_f32_16x16x32_bf16 v[20:23], a[32:35], v[96:99], v[20:23]
ds_read_b128 v[64:67], v3 offset:24576
ds_read_b128 v[68:71], v3 offset:25600
v_mfma_f32_16x16x32_bf16 v[28:31], a[36:39], v[96:99], v[28:31]
v_cvt_pk_bf16_f32 v113, v17, v25
v_cvt_pk_bf16_f32 v120, v18, v26
v_mfma_f32_16x16x32_bf16 v[36:39], a[160:163], v[96:99], v[36:39]
v_cvt_pk_bf16_f32 v121, v34, v42
v_lshlrev_b32 v18, 16, v120
v_mfma_f32_16x16x32_bf16 v[44:47], a[164:167], v[96:99], v[44:47]
v_and_b32 v26, s59, v120
v_lshlrev_b32 v34, 16, v121
s_waitcnt lgkmcnt(4)
v_mfma_f32_16x16x32_bf16 v[20:23], a[40:43], v[100:103], v[20:23]
v_and_b32 v42, s59, v121
v_max_f32 v18, 0, v18
v_mfma_f32_16x16x32_bf16 v[28:31], a[44:47], v[100:103], v[28:31]
v_max_f32 v26, 0, v26
v_mul_f32 v18, v18, v34
v_mfma_f32_16x16x32_bf16 v[36:39], a[168:171], v[100:103], v[36:39]
v_mul_f32 v26, v26, v42
v_cvt_pk_bf16_f32 v114, v18, v26
v_mfma_f32_16x16x32_bf16 v[44:47], a[172:175], v[100:103], v[44:47]
v_cvt_pk_bf16_f32 v120, v19, v27
v_cvt_pk_bf16_f32 v121, v35, v43
s_waitcnt lgkmcnt(3)
v_mfma_f32_16x16x32_bf16 v[20:23], a[48:51], v[104:107], v[20:23]
ds_read_b128 v[72:75], v3 offset:26624
ds_read_b128 v[76:79], v3 offset:27648
v_mfma_f32_16x16x32_bf16 v[28:31], a[52:55], v[104:107], v[28:31]
v_lshlrev_b32 v19, 16, v120
v_and_b32 v27, s59, v120
v_mfma_f32_16x16x32_bf16 v[36:39], a[176:179], v[104:107], v[36:39]
v_lshlrev_b32 v35, 16, v121
v_and_b32 v43, s59, v121
v_mfma_f32_16x16x32_bf16 v[44:47], a[180:183], v[104:107], v[44:47]
v_max_f32 v19, 0, v19
v_max_f32 v27, 0, v27
s_waitcnt lgkmcnt(4)
v_mfma_f32_16x16x32_bf16 v[20:23], a[56:59], v[108:111], v[20:23]
v_mul_f32 v19, v19, v35
v_mul_f32 v27, v27, v43
v_mfma_f32_16x16x32_bf16 v[28:31], a[60:63], v[108:111], v[28:31]
v_cvt_pk_bf16_f32 v115, v19, v27
v_mfma_f32_16x16x32_bf16 v[36:39], a[184:187], v[108:111], v[36:39]
buffer_store_dwordx4 v[112:115], v1, s[36:39], s54 offen sc1
v_mfma_f32_16x16x32_bf16 v[44:47], a[188:191], v[108:111], v[44:47]
s_waitcnt lgkmcnt(3)
v_mfma_f32_16x16x32_bf16 v[20:23], a[64:67], v[64:67], v[20:23]
ds_read_b128 v[80:83], v3 offset:28672
ds_read_b128 v[84:87], v3 offset:29696
v_mfma_f32_16x16x32_bf16 v[28:31], a[68:71], v[64:67], v[28:31]
v_mfma_f32_16x16x32_bf16 v[36:39], a[192:195], v[64:67], v[36:39]
v_mfma_f32_16x16x32_bf16 v[44:47], a[196:199], v[64:67], v[44:47]
s_waitcnt lgkmcnt(4)
v_mfma_f32_16x16x32_bf16 v[20:23], a[72:75], v[68:71], v[20:23]
v_mfma_f32_16x16x32_bf16 v[28:31], a[76:79], v[68:71], v[28:31]
v_mfma_f32_16x16x32_bf16 v[36:39], a[200:203], v[68:71], v[36:39]
v_mfma_f32_16x16x32_bf16 v[44:47], a[204:207], v[68:71], v[44:47]
s_waitcnt lgkmcnt(3)
v_mfma_f32_16x16x32_bf16 v[20:23], a[80:83], v[72:75], v[20:23]
ds_read_b128 v[88:91], v3 offset:30720
ds_read_b128 v[92:95], v3 offset:31744
v_mfma_f32_16x16x32_bf16 v[28:31], a[84:87], v[72:75], v[28:31]
v_mfma_f32_16x16x32_bf16 v[36:39], a[208:211], v[72:75], v[36:39]
v_mfma_f32_16x16x32_bf16 v[44:47], a[212:215], v[72:75], v[44:47]
s_waitcnt lgkmcnt(4)
v_mfma_f32_16x16x32_bf16 v[20:23], a[88:91], v[76:79], v[20:23]
v_mfma_f32_16x16x32_bf16 v[28:31], a[92:95], v[76:79], v[28:31]
v_mfma_f32_16x16x32_bf16 v[36:39], a[216:219], v[76:79], v[36:39]
v_mfma_f32_16x16x32_bf16 v[44:47], a[220:223], v[76:79], v[44:47]
s_waitcnt lgkmcnt(3)
v_mfma_f32_16x16x32_bf16 v[20:23], a[96:99], v[80:83], v[20:23]
v_mfma_f32_16x16x32_bf16 v[28:31], a[100:103], v[80:83], v[28:31]
v_mfma_f32_16x16x32_bf16 v[36:39], a[224:227], v[80:83], v[36:39]
v_mfma_f32_16x16x32_bf16 v[44:47], a[228:231], v[80:83], v[44:47]
s_waitcnt lgkmcnt(2)
v_mfma_f32_16x16x32_bf16 v[20:23], a[104:107], v[84:87], v[20:23]
v_mfma_f32_16x16x32_bf16 v[28:31], a[108:111], v[84:87], v[28:31]
v_mfma_f32_16x16x32_bf16 v[36:39], a[232:235], v[84:87], v[36:39]
v_mfma_f32_16x16x32_bf16 v[44:47], a[236:239], v[84:87], v[44:47]
s_waitcnt lgkmcnt(1)
v_mfma_f32_16x16x32_bf16 v[20:23], a[112:115], v[88:91], v[20:23]
v_mfma_f32_16x16x32_bf16 v[28:31], a[116:119], v[88:91], v[28:31]
v_mfma_f32_16x16x32_bf16 v[36:39], a[240:243], v[88:91], v[36:39]
v_mfma_f32_16x16x32_bf16 v[44:47], a[244:247], v[88:91], v[44:47]
s_waitcnt lgkmcnt(0)
v_mfma_f32_16x16x32_bf16 v[20:23], a[120:123], v[92:95], v[20:23]
v_mfma_f32_16x16x32_bf16 v[28:31], a[124:127], v[92:95], v[28:31]
v_mfma_f32_16x16x32_bf16 v[36:39], a[248:251], v[92:95], v[36:39]
v_mfma_f32_16x16x32_bf16 v[44:47], a[252:255], v[92:95], v[44:47]
v_xor_b32 v3, 0x8000, v3
v_cvt_pk_bf16_f32 v120, v20, v28
s_nop 5
v_cvt_pk_bf16_f32 v121, v36, v44
v_lshlrev_b32 v20, 16, v120
v_and_b32 v28, s59, v120
v_lshlrev_b32 v36, 16, v121
v_and_b32 v44, s59, v121
v_max_f32 v20, 0, v20
v_max_f32 v28, 0, v28
v_mul_f32 v20, v20, v36
v_mul_f32 v28, v28, v44
v_cvt_pk_bf16_f32 v116, v20, v28
v_cvt_pk_bf16_f32 v120, v21, v29
v_cvt_pk_bf16_f32 v121, v37, v45
v_lshlrev_b32 v21, 16, v120
v_and_b32 v29, s59, v120
v_lshlrev_b32 v37, 16, v121
v_and_b32 v45, s59, v121
v_max_f32 v21, 0, v21
v_max_f32 v29, 0, v29
v_mul_f32 v21, v21, v37
v_mul_f32 v29, v29, v45
v_cvt_pk_bf16_f32 v117, v21, v29
v_cvt_pk_bf16_f32 v120, v22, v30
v_cvt_pk_bf16_f32 v121, v38, v46
v_lshlrev_b32 v22, 16, v120
v_and_b32 v30, s59, v120
v_lshlrev_b32 v38, 16, v121
v_and_b32 v46, s59, v121
v_max_f32 v22, 0, v22
v_max_f32 v30, 0, v30
v_mul_f32 v22, v22, v38
v_mul_f32 v30, v30, v46
v_cvt_pk_bf16_f32 v118, v22, v30
v_cvt_pk_bf16_f32 v120, v23, v31
v_cvt_pk_bf16_f32 v121, v39, v47
v_lshlrev_b32 v23, 16, v120
v_and_b32 v31, s59, v120
v_lshlrev_b32 v39, 16, v121
v_and_b32 v47, s59, v121
v_max_f32 v23, 0, v23
v_max_f32 v31, 0, v31
v_mul_f32 v23, v23, v39
v_mul_f32 v31, v31, v47
v_cvt_pk_bf16_f32 v119, v23, v31
buffer_store_dwordx4 v[116:119], v1, s[36:39], s67 offen sc1
s_waitcnt vmcnt(2) lgkmcnt(0)
s_barrier
s_add_u32 s64, s64, s60
s_cmp_lt_u32 s64, 64
s_cbranch_scc1 L_ffn_loop
s_waitcnt vmcnt(0)
s_barrier
s_cmp_lg_u32 s32, 3
s_cbranch_scc1 L_noffn
v_mov_b32 v8, 196
s_mov_b64 exec, 1
global_atomic_add v8, v4, s[28:29]
s_mov_b64 exec, -1
L_noffn:
s_lshr_b32 s65, s34, 5
s_sub_u32 s65, s65, 1
s_bfe_u32 s54, s34, 0x10004
s_mul_i32 s54, s54, 6
s_add_u32 s65, s65, s54
s_mov_b32 s89, 12
s_and_b32 s66, s34, 15
s_mov_b32 s64, s63
s_lshr_b32 s67, s32, 1
s_and_b32 s68, s32, 1
s_cmp_lg_u32 s32, 0
s_cbranch_scc1 L_w2x
v_mov_b32 v8, 68
L_wc_6:
global_load_dword v9, v8, s[28:29] sc1
s_waitcnt vmcnt(0)
v_readfirstlane_b32 s54, v9
s_nop 0
s_cmp_ge_u32 s54, 16
s_cbranch_scc1 L_wcd_7
s_add_u32 s35, s35, 1
s_cmp_gt_u32 s35, 131072
s_cbranch_scc1 L_END
s_sleep 8
s_branch L_wc_6
L_wcd_7:
L_w2x:
s_barrier
s_lshl_b32 s54, s66, 2
s_add_u32 s54, s54, s32
s_mul_i32 s54, s54, 88064
s_add_u32 s54, s54, 92274688
v_lshlrev_b32 v1, 4, v0
buffer_load_dwordx4 v[168:171], v1, s[36:39], s54 offen offset:0 sc1
buffer_load_dwordx4 v[172:175], v1, s[36:39], s54 offen offset:1024 sc1
buffer_load_dwordx4 v[176:179], v1, s[36:39], s54 offen offset:2048 sc1
buffer_load_dwordx4 v[180:183], v1, s[36:39], s54 offen offset:3072 sc1
s_add_u32 s54, s54, 4096
buffer_load_dwordx4 v[184:187], v1, s[36:39], s54 offen offset:0 sc1
buffer_load_dwordx4 v[188:191], v1, s[36:39], s54 offen offset:1024 sc1
s_waitcnt vmcnt(2)
buffer_load_dwordx4 v[192:195], v1, s[36:39], s54 offen offset:2048 sc1
buffer_load_dwordx4 v[196:199], v1, s[36:39], s54 offen offset:3072 sc1
s_add_u32 s54, s54, 4096
buffer_load_dwordx4 v[200:203], v1, s[36:39], s54 offen offset:0 sc1
buffer_load_dwordx4 v[204:207], v1, s[36:39], s54 offen offset:1024 sc1
s_waitcnt vmcnt(2)
buffer_load_dwordx4 v[208:211], v1, s[36:39], s54 offen offset:2048 sc1
buffer_load_dwordx4 v[212:215], v1, s[36:39], s54 offen offset:3072 sc1
s_add_u32 s54, s54, 4096
buffer_load_dwordx4 v[216:219], v1, s[36:39], s54 offen offset:0 sc1
buffer_load_dwordx4 v[220:223], v1, s[36:39], s54 offen offset:1024 sc1
s_waitcnt vmcnt(2)
buffer_load_dwordx4 v[224:227], v1, s[36:39], s54 offen offset:2048 sc1
buffer_load_dwordx4 v[228:231], v1, s[36:39], s54 offen offset:3072 sc1
s_add_u32 s54, s54, 4096
buffer_load_dwordx4 v[232:235], v1, s[36:39], s54 offen offset:0 sc1
buffer_load_dwordx4 v[236:239], v1, s[36:39], s54 offen offset:1024 sc1
s_waitcnt vmcnt(2)
buffer_load_dwordx4 v[240:243], v1, s[36:39], s54 offen offset:2048 sc1
buffer_load_dwordx4 v[244:247], v1, s[36:39], s54 offen offset:3072 sc1
s_add_u32 s54, s54, 4096
buffer_load_dwordx4 v[248:251], v1, s[36:39], s54 offen offset:0 sc1
buffer_load_dwordx4 v[252:255], v1, s[36:39], s54 offen offset:1024 sc1
s_waitcnt vmcnt(2)
buffer_load_dwordx4 a[0:3], v1, s[36:39], s54 offen offset:2048 sc1
buffer_load_dwordx4 a[4:7], v1, s[36:39], s54 offen offset:3072 sc1
s_add_u32 s54, s54, 4096
buffer_load_dwordx4 a[8:11], v1, s[36:39], s54 offen offset:0 sc1
buffer_load_dwordx4 a[12:15], v1, s[36:39], s54 offen offset:1024 sc1
s_waitcnt vmcnt(2)
buffer_load_dwordx4 a[16:19], v1, s[36:39], s54 offen offset:2048 sc1
buffer_load_dwordx4 a[20:23], v1, s[36:39], s54 offen offset:3072 sc1
s_add_u32 s54, s54, 4096
buffer_load_dwordx4 a[24:27], v1, s[36:39], s54 offen offset:0 sc1
buffer_load_dwordx4 a[28:31], v1, s[36:39], s54 offen offset:1024 sc1
s_waitcnt vmcnt(2)
buffer_load_dwordx4 a[32:35], v1, s[36:39], s54 offen offset:2048 sc1
buffer_load_dwordx4 a[36:39], v1, s[36:39], s54 offen offset:3072 sc1
s_add_u32 s54, s54, 4096
buffer_load_dwordx4 a[40:43], v1, s[36:39], s54 offen offset:0 sc1
buffer_load_dwordx4 a[44:47], v1, s[36:39], s54 offen offset:1024 sc1
s_waitcnt vmcnt(2)
buffer_load_dwordx4 a[48:51], v1, s[36:39], s54 offen offset:2048 sc1
buffer_load_dwordx4 a[52:55], v1, s[36:39], s54 offen offset:3072 sc1
s_add_u32 s54, s54, 4096
buffer_load_dwordx4 a[56:59], v1, s[36:39], s54 offen offset:0 sc1
buffer_load_dwordx4 a[60:63], v1, s[36:39], s54 offen offset:1024 sc1
s_waitcnt vmcnt(2)
buffer_load_dwordx4 a[64:67], v1, s[36:39], s54 offen offset:2048 sc1
buffer_load_dwordx4 a[68:71], v1, s[36:39], s54 offen offset:3072 sc1
s_add_u32 s54, s54, 4096
buffer_load_dwordx4 a[72:75], v1, s[36:39], s54 offen offset:0 sc1
buffer_load_dwordx4 a[76:79], v1, s[36:39], s54 offen offset:1024 sc1
s_waitcnt vmcnt(2)
buffer_load_dwordx4 a[80:83], v1, s[36:39], s54 offen offset:2048 sc1
buffer_load_dwordx4 a[84:87], v1, s[36:39], s54 offen offset:3072 sc1
s_add_u32 s54, s54, 4096
buffer_load_dwordx4 a[88:91], v1, s[36:39], s54 offen offset:0 sc1
buffer_load_dwordx4 a[92:95], v1, s[36:39], s54 offen offset:1024 sc1
s_waitcnt vmcnt(2)
buffer_load_dwordx4 a[96:99], v1, s[36:39], s54 offen offset:2048 sc1
buffer_load_dwordx4 a[100:103], v1, s[36:39], s54 offen offset:3072 sc1
s_add_u32 s54, s54, 4096
buffer_load_dwordx4 a[104:107], v1, s[36:39], s54 offen offset:0 sc1
buffer_load_dwordx4 a[108:111], v1, s[36:39], s54 offen offset:1024 sc1
s_waitcnt vmcnt(2)
buffer_load_dwordx4 a[112:115], v1, s[36:39], s54 offen offset:2048 sc1
buffer_load_dwordx4 a[116:119], v1, s[36:39], s54 offen offset:3072 sc1
s_add_u32 s54, s54, 4096
buffer_load_dwordx4 a[120:123], v1, s[36:39], s54 offen offset:0 sc1
buffer_load_dwordx4 a[124:127], v1, s[36:39], s54 offen offset:1024 sc1
s_waitcnt vmcnt(2)
buffer_load_dwordx4 a[128:131], v1, s[36:39], s54 offen offset:2048 sc1
buffer_load_dwordx4 a[132:135], v1, s[36:39], s54 offen offset:3072 sc1
s_add_u32 s54, s54, 4096
buffer_load_dwordx4 a[136:139], v1, s[36:39], s54 offen offset:0 sc1
buffer_load_dwordx4 a[140:143], v1, s[36:39], s54 offen offset:1024 sc1
s_waitcnt vmcnt(2)
buffer_load_dwordx4 a[144:147], v1, s[36:39], s54 offen offset:2048 sc1
buffer_load_dwordx4 a[148:151], v1, s[36:39], s54 offen offset:3072 sc1
s_add_u32 s54, s54, 4096
buffer_load_dwordx4 a[152:155], v1, s[36:39], s54 offen offset:0 sc1
buffer_load_dwordx4 a[156:159], v1, s[36:39], s54 offen offset:1024 sc1
s_waitcnt vmcnt(2)
buffer_load_dwordx4 a[160:163], v1, s[36:39], s54 offen offset:2048 sc1
buffer_load_dwordx4 a[164:167], v1, s[36:39], s54 offen offset:3072 sc1
s_add_u32 s54, s54, 4096
buffer_load_dwordx4 a[168:171], v1, s[36:39], s54 offen offset:0 sc1
buffer_load_dwordx4 a[172:175], v1, s[36:39], s54 offen offset:1024 sc1
s_waitcnt vmcnt(2)
buffer_load_dwordx4 a[176:179], v1, s[36:39], s54 offen offset:2048 sc1
buffer_load_dwordx4 a[180:183], v1, s[36:39], s54 offen offset:3072 sc1
s_add_u32 s54, s54, 4096
buffer_load_dwordx4 a[184:187], v1, s[36:39], s54 offen offset:0 sc1
buffer_load_dwordx4 a[188:191], v1, s[36:39], s54 offen offset:1024 sc1
s_waitcnt vmcnt(2)
buffer_load_dwordx4 a[192:195], v1, s[36:39], s54 offen offset:2048 sc1
buffer_load_dwordx4 a[196:199], v1, s[36:39], s54 offen offset:3072 sc1
s_add_u32 s54, s54, 4096
buffer_load_dwordx4 a[200:203], v1, s[36:39], s54 offen offset:0 sc1
buffer_load_dwordx4 a[204:207], v1, s[36:39], s54 offen offset:1024 sc1
s_waitcnt vmcnt(2)
buffer_load_dwordx4 a[208:211], v1, s[36:39], s54 offen offset:2048 sc1
buffer_load_dwordx4 a[212:215], v1, s[36:39], s54 offen offset:3072 sc1
s_add_u32 s54, s54, 4096
buffer_load_dwordx4 a[216:219], v1, s[36:39], s54 offen offset:0 sc1
buffer_load_dwordx4 a[220:223], v1, s[36:39], s54 offen offset:1024 sc1
s_waitcnt vmcnt(2)
buffer_load_dwordx4 a[224:227], v1, s[36:39], s54 offen offset:2048 sc1
buffer_load_dwordx4 a[228:231], v1, s[36:39], s54 offen offset:3072 sc1
s_add_u32 s54, s54, 4096
buffer_load_dwordx4 a[232:235], v1, s[36:39], s54 offen offset:0 sc1
buffer_load_dwordx4 a[236:239], v1, s[36:39], s54 offen offset:1024 sc1
s_waitcnt vmcnt(2)
buffer_load_dwordx4 a[240:243], v1, s[36:39], s54 offen offset:2048 sc1
buffer_load_dwordx4 a[244:247], v1, s[36:39], s54 offen offset:3072 sc1
s_add_u32 s54, s54, 4096
buffer_load_dwordx4 a[248:251], v1, s[36:39], s54 offen offset:0 sc1
buffer_load_dwordx4 a[252:255], v1, s[36:39], s54 offen offset:1024 sc1
s_waitcnt vmcnt(0)
s_mov_b32 s40, s26
s_and_b32 s41, s27, 0xffff
s_mov_b32 s42, 0x200000
s_mov_b32 s43, 0x20000
s_mov_b32 s48, s4
s_and_b32 s49, s5, 0xffff
s_mov_b32 s50, 0x200000
s_mov_b32 s51, 0x20000
v_lshlrev_b32 v1, 4, v0
v_lshlrev_b32 v2, 3, v0
v_mov_b32 v3, 1
s_lshl_b32 s54, s67, 12
s_add_u32 s54, s54, 65536
v_add_u32 v4, s54, v1
v_and_b32 v11, 15, v0
v_and_b32 v5, 31, v0
v_lshlrev_b32 v5, 7, v5
v_min_u32 v6, 10, v0
v_lshlrev_b32 v6, 2, v6
s_mul_i32 s54, s32, 44
v_add_u32 v6, s54, v6
s_lshl_b32 s54, s32, 12
v_add_u32 v7, s54, v1
v_lshrrev_b32 v12, 4, v0
v_bfe_u32 v13, v0, 2, 2
v_and_b32 v14, 3, v0
v_lshlrev_b32 v13, 8, v13
v_lshlrev_b32 v15, 4, v12
v_lshlrev_b32 v14, 2, v14
v_add3_u32 v8, v13, v15, v14
s_lshl_b32 s54, s32, 6
v_add_u32 v8, s54, v8
v_lshlrev_b32 v12, 10, v12
v_lshlrev_b32 v13, 2, v11
s_lshl_b32 s54, s32, 12
s_lshl_b32 s55, s66, 6
s_add_u32 s54, s54, s55
v_add3_u32 v9, v12, v13, s54
v_and_b32 v10, 3, v0
v_lshlrev_b32 v10, 2, v10
v_lshrrev_b32 v12, 2, v11
v_lshlrev_b32 v12, 7, v12
v_and_b32 v13, 1, v11
v_lshlrev_b32 v13, 6, v13
v_and_b32 v14, 48, v0
v_add3_u32 v160, v12, v13, v14
s_lshl_b32 s54, s67, 4
v_add_u32 v12, s54, v11
v_lshrrev_b32 v13, 4, v0
v_lshlrev_b32 v13, 2, v13
v_sub_u32 v12, v12, v13
v_cmp_le_i32 s[72:73], 0, v12
v_cmp_le_i32 s[74:75], 1, v12
v_cmp_le_i32 s[76:77], 2, v12
v_cmp_le_i32 s[78:79], 3, v12
v_cmp_le_i32 s[80:81], 16, v12
v_cmp_le_i32 s[82:83], 17, v12
v_cmp_le_i32 s[84:85], 18, v12
v_cmp_le_i32 s[86:87], 19, v12
s_mov_b32 s70, 0x3e0293ee
s_mov_b32 s71, 0xffff0000
s_cmp_ge_u32 s64, 64
s_cbranch_scc1 L_noA0
s_lshl_b32 s59, s64, 19
s_lshl_b32 s57, s62, 14
s_add_u32 s59, s59, s57
s_add_u32 s59, s59, 16777216
s_lshl_b32 s57, s68, 13
s_add_u32 s57, s57, s59
s_add_u32 s58, s57, 4096
buffer_load_dwordx4 v[72:75], v1, s[36:39], s59 offen offset:0 sc1
buffer_load_dwordx4 v[76:79], v1, s[36:39], s59 offen offset:1024 sc1
s_add_u32 s59, s59, 4096
buffer_load_dwordx4 v[80:83], v1, s[36:39], s59 offen offset:0 sc1
buffer_load_dwordx4 v[84:87], v1, s[36:39], s59 offen offset:1024 sc1
s_add_u32 s59, s59, 4096
buffer_load_dwordx4 v[88:91], v1, s[36:39], s59 offen offset:0 sc1
buffer_load_dwordx4 v[92:95], v1, s[36:39], s59 offen offset:1024 sc1
s_add_u32 s59, s59, 4096
buffer_load_dwordx4 v[96:99], v1, s[36:39], s59 offen offset:0 sc1
buffer_load_dwordx4 v[100:103], v1, s[36:39], s59 offen offset:1024 sc1
buffer_load_dwordx4 v[48:51], v1, s[36:39], s57 offen offset:2048 sc1
buffer_load_dwordx4 v[52:55], v1, s[36:39], s57 offen offset:3072 sc1
buffer_load_dwordx4 v[56:59], v1, s[36:39], s58 offen offset:2048 sc1
buffer_load_dwordx4 v[60:63], v1, s[36:39], s58 offen offset:3072 sc1
ds_read_b128 v[32:35], v4 offset:0
ds_read_b128 v[36:39], v4 offset:1024
ds_read_b128 v[40:43], v4 offset:2048
ds_read_b128 v[44:47], v4 offset:3072
s_waitcnt lgkmcnt(3)
s_waitcnt vmcnt(11)
v_mfma_f32_16x16x32_bf16 v[64:67], v[72:75], v[32:35], 0
s_waitcnt vmcnt(10)
v_mfma_f32_16x16x32_bf16 v[68:71], v[76:79], v[32:35], 0
s_waitcnt lgkmcnt(2)
s_waitcnt vmcnt(9)
v_mfma_f32_16x16x32_bf16 v[64:67], v[80:83], v[36:39], v[64:67]
s_waitcnt vmcnt(8)
v_mfma_f32_16x16x32_bf16 v[68:71], v[84:87], v[36:39], v[68:71]
s_waitcnt lgkmcnt(1)
s_waitcnt vmcnt(7)
v_mfma_f32_16x16x32_bf16 v[64:67], v[88:91], v[40:43], v[64:67]
s_waitcnt vmcnt(6)
v_mfma_f32_16x16x32_bf16 v[68:71], v[92:95], v[40:43], v[68:71]
s_waitcnt lgkmcnt(0)
s_waitcnt vmcnt(5)
v_mfma_f32_16x16x32_bf16 v[64:67], v[96:99], v[44:47], v[64:67]
s_waitcnt vmcnt(4)
v_mfma_f32_16x16x32_bf16 v[68:71], v[100:103], v[44:47], v[68:71]
v_add_u32 v4, 8192, v4
v_mov_b32 v13, 0xceabfb8f
s_nop 1
v_mul_f32 v64, s70, v64
v_cndmask_b32 v64, v13, v64, s[72:73]
v_mul_f32 v65, s70, v65
v_cndmask_b32 v65, v13, v65, s[74:75]
v_mul_f32 v66, s70, v66
v_cndmask_b32 v66, v13, v66, s[76:77]
v_mul_f32 v67, s70, v67
v_cndmask_b32 v67, v13, v67, s[78:79]
v_mul_f32 v68, s70, v68
v_cndmask_b32 v68, v13, v68, s[80:81]
v_mul_f32 v69, s70, v69
v_cndmask_b32 v69, v13, v69, s[82:83]
v_mul_f32 v70, s70, v70
v_cndmask_b32 v70, v13, v70, s[84:85]
v_mul_f32 v71, s70, v71
v_cndmask_b32 v71, v13, v71, s[86:87]
v_max3_f32 v161, v64, v65, v66
v_max3_f32 v161, v161, v67, v68
v_max3_f32 v161, v161, v69, v70
v_max_f32 v161, v161, v71
L_noA0:
s_waitcnt vmcnt(0) lgkmcnt(0)
s_mov_b32 s88, 0
s_lshl_b32 s69, s62, 7
s_add_u32 s69, s69, 2179072
v_mov_b32 v162, 32768
L_task:
s_lshr_b32 s54, s65, 1
s_min_u32 s54, s54, s64
s_cmp_ge_u32 s54, 64
s_cbranch_scc1 L_WEND
s_cmp_lt_u32 s64, 64
s_cbranch_scc1 L_coop
s_lshl_b32 s57, s54, 12
s_lshl_b32 s58, s32, 10
s_add_u32 s57, s57, s58
s_add_u32 s57, s57, 2359296
s_mov_b64 exec, 0xff
L_pw:
buffer_load_dword v13, v5, s[36:39], s57 offen sc1
s_waitcnt vmcnt(0)
v_cmp_eq_u32 vcc, 0, v13
s_cbranch_vccz L_pwd
s_add_u32 s35, s35, 1
s_cmp_gt_u32 s35, 262144
s_cbranch_scc1 L_END
s_sleep 1
s_cmp_ge_u32 s54, 59
s_cbranch_scc1 L_pw
s_sleep 16
s_branch L_pw
L_pwd:
s_mov_b64 exec, -1
s_branch L_final
L_coop:
s_cmp_lg_u32 s32, 0
s_cbranch_scc1 L_join
s_lshr_b32 s54, s65, 1
s_min_u32 s57, s54, 63
s_lshl_b32 s57, s57, 12
s_add_u32 s57, s57, 2359296
s_mov_b32 exec_hi, 0
L_poll:
s_cmp_ge_u32 s64, 64
s_cbranch_scc1 L_noattn
buffer_load_dword v12, v10, s[36:39], s69 offen sc1
s_waitcnt vmcnt(0)
s_mov_b32 s56, 1
v_cmp_ge_u32 vcc, s64, v12
s_cbranch_vccz L_dec
v_readfirstlane_b32 s55, v12
s_mov_b32 s56, 3
s_cmp_ge_u32 s55, 61
s_cbranch_scc1 L_dec
s_cmp_le_u32 s64, s54
s_cbranch_scc1 L_idle
s_cmp_le_u32 s55, s54
s_cbranch_scc1 L_idle
s_cmp_lt_u32 s64, 48
s_cbranch_scc1 L_noattn
s_min_u32 s58, s64, 61
s_cmp_le_u32 s58, s55
s_cbranch_scc1 L_idle
L_noattn:
buffer_load_dword v13, v5, s[36:39], s57 offen sc1
s_waitcnt vmcnt(0)
s_mov_b32 s56, 2
v_cmp_eq_u32 vcc, 0, v13
s_cbranch_vccz L_dec
L_idle:
s_mov_b32 s56, 0
s_add_u32 s35, s35, 1
s_cmp_gt_u32 s35, 262144
s_cbranch_scc1 L_dec
s_sleep 1
s_cmp_ge_u32 s64, 61
s_cbranch_scc1 L_poll
s_sleep 12
s_branch L_poll
L_dec:
s_mov_b64 exec, -1
v_mov_b32 v12, s56
ds_write_b32 v162, v12
s_waitcnt lgkmcnt(0)
L_join:
s_barrier
ds_read_b32 v12, v162
s_waitcnt lgkmcnt(0)
v_xor_b32 v162, 4, v162
v_readfirstlane_b32 s56, v12
s_nop 0
s_cmp_eq_u32 s56, 1
s_cbranch_scc1 L_attn
s_cmp_eq_u32 s56, 0
s_cbranch_scc1 L_WEND
s_cmp_eq_u32 s56, 3
s_cbranch_scc1 L_pa
L_final:
s_cmp_lg_u32 s88, 0
s_cbranch_scc1 L_final2
s_mov_b32 s88, 1
s_cmp_lg_u32 s32, 0
s_cbranch_scc1 L_w3
v_mov_b32 v12, 196
L_wc_8:
global_load_dword v13, v12, s[28:29] sc1
s_waitcnt vmcnt(0)
v_readfirstlane_b32 s54, v13
s_nop 0
s_cmp_ge_u32 s54, 176
s_cbranch_scc1 L_wcd_9
s_add_u32 s35, s35, 1
s_cmp_gt_u32 s35, 131072
s_cbranch_scc1 L_END
s_sleep 16
s_branch L_wc_8
L_wcd_9:
L_w3:
s_barrier
s_lshl_b32 s57, s65, 14
buffer_load_dword v163, v9, s[48:51], s57 offen
s_mul_i32 s57, s65, 45056
s_mul_i32 s58, s32, 11264
s_add_u32 s57, s57, s58
s_add_u32 s57, s57, 84934656
buffer_load_dwordx4 v[88:91], v1, s[36:39], s57 offen offset:0 sc1
buffer_load_dwordx4 v[92:95], v1, s[36:39], s57 offen offset:1024 sc1
buffer_load_dwordx4 v[96:99], v1, s[36:39], s57 offen offset:2048 sc1
buffer_load_dwordx4 v[100:103], v1, s[36:39], s57 offen offset:3072 sc1
s_add_u32 s57, s57, 4096
buffer_load_dwordx4 v[104:107], v1, s[36:39], s57 offen offset:0 sc1
buffer_load_dwordx4 v[108:111], v1, s[36:39], s57 offen offset:1024 sc1
buffer_load_dwordx4 v[112:115], v1, s[36:39], s57 offen offset:2048 sc1
buffer_load_dwordx4 v[116:119], v1, s[36:39], s57 offen offset:3072 sc1
s_add_u32 s57, s57, 4096
buffer_load_dwordx4 v[120:123], v1, s[36:39], s57 offen offset:0 sc1
buffer_load_dwordx4 v[124:127], v1, s[36:39], s57 offen offset:1024 sc1
buffer_load_dwordx4 v[128:131], v1, s[36:39], s57 offen offset:2048 sc1
s_waitcnt vmcnt(11)
v_mov_b32 v11, v163
s_waitcnt vmcnt(10)
v_mfma_f32_16x16x32_bf16 v[24:27], v[168:171], v[88:91], 0
v_mfma_f32_16x16x32_bf16 v[28:31], v[172:175], v[88:91], 0
s_waitcnt vmcnt(9)
v_mfma_f32_16x16x32_bf16 v[24:27], v[176:179], v[92:95], v[24:27]
v_mfma_f32_16x16x32_bf16 v[28:31], v[180:183], v[92:95], v[28:31]
s_waitcnt vmcnt(8)
v_mfma_f32_16x16x32_bf16 v[24:27], v[184:187], v[96:99], v[24:27]
v_mfma_f32_16x16x32_bf16 v[28:31], v[188:191], v[96:99], v[28:31]
s_waitcnt vmcnt(7)
v_mfma_f32_16x16x32_bf16 v[24:27], v[192:195], v[100:103], v[24:27]
v_mfma_f32_16x16x32_bf16 v[28:31], v[196:199], v[100:103], v[28:31]
s_waitcnt vmcnt(6)
v_mfma_f32_16x16x32_bf16 v[24:27], v[200:203], v[104:107], v[24:27]
v_mfma_f32_16x16x32_bf16 v[28:31], v[204:207], v[104:107], v[28:31]
s_waitcnt vmcnt(5)
v_mfma_f32_16x16x32_bf16 v[24:27], v[208:211], v[108:111], v[24:27]
v_mfma_f32_16x16x32_bf16 v[28:31], v[212:215], v[108:111], v[28:31]
s_waitcnt vmcnt(4)
v_mfma_f32_16x16x32_bf16 v[24:27], v[216:219], v[112:115], v[24:27]
v_mfma_f32_16x16x32_bf16 v[28:31], v[220:223], v[112:115], v[28:31]
s_waitcnt vmcnt(3)
v_mfma_f32_16x16x32_bf16 v[24:27], v[224:227], v[116:119], v[24:27]
v_mfma_f32_16x16x32_bf16 v[28:31], v[228:231], v[116:119], v[28:31]
s_waitcnt vmcnt(2)
v_mfma_f32_16x16x32_bf16 v[24:27], v[232:235], v[120:123], v[24:27]
v_mfma_f32_16x16x32_bf16 v[28:31], v[236:239], v[120:123], v[28:31]
s_waitcnt vmcnt(1)
v_mfma_f32_16x16x32_bf16 v[24:27], v[240:243], v[124:127], v[24:27]
v_mfma_f32_16x16x32_bf16 v[28:31], v[244:247], v[124:127], v[28:31]
s_waitcnt vmcnt(0)
v_mfma_f32_16x16x32_bf16 v[24:27], v[248:251], v[128:131], v[24:27]
v_mfma_f32_16x16x32_bf16 v[28:31], v[252:255], v[128:131], v[28:31]
L_final2:
s_lshl_b32 s57, s65, 17
s_lshl_b32 s58, s32, 15
s_add_u32 s57, s57, s58
s_add_u32 s57, s57, 68157440
buffer_load_dwordx4 v[72:75], v1, s[36:39], s57 offen offset:0 sc1
buffer_load_dwordx4 v[76:79], v1, s[36:39], s57 offen offset:1024 sc1
buffer_load_dwordx4 v[80:83], v1, s[36:39], s57 offen offset:2048 sc1
buffer_load_dwordx4 v[84:87], v1, s[36:39], s57 offen offset:3072 sc1
s_add_u32 s57, s57, 4096
buffer_load_dwordx4 v[88:91], v1, s[36:39], s57 offen offset:0 sc1
buffer_load_dwordx4 v[92:95], v1, s[36:39], s57 offen offset:1024 sc1
buffer_load_dwordx4 v[96:99], v1, s[36:39], s57 offen offset:2048 sc1
buffer_load_dwordx4 v[100:103], v1, s[36:39], s57 offen offset:3072 sc1
s_add_u32 s57, s57, 4096
buffer_load_dwordx4 v[104:107], v1, s[36:39], s57 offen offset:0 sc1
buffer_load_dwordx4 v[108:111], v1, s[36:39], s57 offen offset:1024 sc1
buffer_load_dwordx4 v[112:115], v1, s[36:39], s57 offen offset:2048 sc1
buffer_load_dwordx4 v[116:119], v1, s[36:39], s57 offen offset:3072 sc1
s_add_u32 s57, s57, 4096
buffer_load_dwordx4 v[120:123], v1, s[36:39], s57 offen offset:0 sc1
buffer_load_dwordx4 v[124:127], v1, s[36:39], s57 offen offset:1024 sc1
buffer_load_dwordx4 v[128:131], v1, s[36:39], s57 offen offset:2048 sc1
buffer_load_dwordx4 v[132:135], v1, s[36:39], s57 offen offset:3072 sc1
s_add_u32 s57, s57, 4096
buffer_load_dwordx4 v[136:139], v1, s[36:39], s57 offen offset:0 sc1
buffer_load_dwordx4 v[140:143], v1, s[36:39], s57 offen offset:1024 sc1
buffer_load_dwordx4 v[144:147], v1, s[36:39], s57 offen offset:2048 sc1
buffer_load_dwordx4 v[148:151], v1, s[36:39], s57 offen offset:3072 sc1
s_add_u32 s57, s57, 4096
buffer_load_dwordx4 v[152:155], v1, s[36:39], s57 offen offset:0 sc1
buffer_load_dwordx4 v[156:159], v1, s[36:39], s57 offen offset:1024 sc1
s_waitcnt vmcnt(21)
v_mfma_f32_16x16x32_bf16 v[16:19], a[0:3], v[72:75], 0
v_mfma_f32_16x16x32_bf16 v[20:23], a[4:7], v[72:75], 0
buffer_load_dwordx4 v[72:75], v1, s[36:39], s57 offen offset:2048 sc1
s_waitcnt vmcnt(21)
v_mfma_f32_16x16x32_bf16 v[16:19], a[8:11], v[76:79], v[16:19]
v_mfma_f32_16x16x32_bf16 v[20:23], a[12:15], v[76:79], v[20:23]
buffer_load_dwordx4 v[76:79], v1, s[36:39], s57 offen offset:3072 sc1
s_waitcnt vmcnt(21)
v_mfma_f32_16x16x32_bf16 v[16:19], a[16:19], v[80:83], v[16:19]
v_mfma_f32_16x16x32_bf16 v[20:23], a[20:23], v[80:83], v[20:23]
s_add_u32 s57, s57, 4096
buffer_load_dwordx4 v[80:83], v1, s[36:39], s57 offen offset:0 sc1
s_waitcnt vmcnt(21)
v_mfma_f32_16x16x32_bf16 v[16:19], a[24:27], v[84:87], v[16:19]
v_mfma_f32_16x16x32_bf16 v[20:23], a[28:31], v[84:87], v[20:23]
buffer_load_dwordx4 v[84:87], v1, s[36:39], s57 offen offset:1024 sc1
s_waitcnt vmcnt(21)
v_mfma_f32_16x16x32_bf16 v[16:19], a[32:35], v[88:91], v[16:19]
v_mfma_f32_16x16x32_bf16 v[20:23], a[36:39], v[88:91], v[20:23]
buffer_load_dwordx4 v[88:91], v1, s[36:39], s57 offen offset:2048 sc1
s_waitcnt vmcnt(21)
v_mfma_f32_16x16x32_bf16 v[16:19], a[40:43], v[92:95], v[16:19]
v_mfma_f32_16x16x32_bf16 v[20:23], a[44:47], v[92:95], v[20:23]
buffer_load_dwordx4 v[92:95], v1, s[36:39], s57 offen offset:3072 sc1
s_waitcnt vmcnt(21)
v_mfma_f32_16x16x32_bf16 v[16:19], a[48:51], v[96:99], v[16:19]
v_mfma_f32_16x16x32_bf16 v[20:23], a[52:55], v[96:99], v[20:23]
s_add_u32 s57, s57, 4096
buffer_load_dwordx4 v[96:99], v1, s[36:39], s57 offen offset:0 sc1
s_waitcnt vmcnt(21)
v_mfma_f32_16x16x32_bf16 v[16:19], a[56:59], v[100:103], v[16:19]
v_mfma_f32_16x16x32_bf16 v[20:23], a[60:63], v[100:103], v[20:23]
buffer_load_dwordx4 v[100:103], v1, s[36:39], s57 offen offset:1024 sc1
s_waitcnt vmcnt(21)
v_mfma_f32_16x16x32_bf16 v[16:19], a[64:67], v[104:107], v[16:19]
v_mfma_f32_16x16x32_bf16 v[20:23], a[68:71], v[104:107], v[20:23]
buffer_load_dwordx4 v[104:107], v1, s[36:39], s57 offen offset:2048 sc1
s_waitcnt vmcnt(21)
v_mfma_f32_16x16x32_bf16 v[16:19], a[72:75], v[108:111], v[16:19]
v_mfma_f32_16x16x32_bf16 v[20:23], a[76:79], v[108:111], v[20:23]
buffer_load_dwordx4 v[108:111], v1, s[36:39], s57 offen offset:3072 sc1
s_waitcnt vmcnt(21)
v_mfma_f32_16x16x32_bf16 v[16:19], a[80:83], v[112:115], v[16:19]
v_mfma_f32_16x16x32_bf16 v[20:23], a[84:87], v[112:115], v[20:23]
s_waitcnt vmcnt(20)
v_mfma_f32_16x16x32_bf16 v[16:19], a[88:91], v[116:119], v[16:19]
v_mfma_f32_16x16x32_bf16 v[20:23], a[92:95], v[116:119], v[20:23]
s_waitcnt vmcnt(19)
v_mfma_f32_16x16x32_bf16 v[16:19], a[96:99], v[120:123], v[16:19]
v_mfma_f32_16x16x32_bf16 v[20:23], a[100:103], v[120:123], v[20:23]
s_waitcnt vmcnt(18)
v_mfma_f32_16x16x32_bf16 v[16:19], a[104:107], v[124:127], v[16:19]
v_mfma_f32_16x16x32_bf16 v[20:23], a[108:111], v[124:127], v[20:23]
s_waitcnt vmcnt(17)
v_mfma_f32_16x16x32_bf16 v[16:19], a[112:115], v[128:131], v[16:19]
v_mfma_f32_16x16x32_bf16 v[20:23], a[116:119], v[128:131], v[20:23]
s_waitcnt vmcnt(16)
v_mfma_f32_16x16x32_bf16 v[16:19], a[120:123], v[132:135], v[16:19]
v_mfma_f32_16x16x32_bf16 v[20:23], a[124:127], v[132:135], v[20:23]
s_waitcnt vmcnt(15)
v_mfma_f32_16x16x32_bf16 v[16:19], a[128:131], v[136:139], v[16:19]
v_mfma_f32_16x16x32_bf16 v[20:23], a[132:135], v[136:139], v[20:23]
s_waitcnt vmcnt(14)
v_mfma_f32_16x16x32_bf16 v[16:19], a[136:139], v[140:143], v[16:19]
v_mfma_f32_16x16x32_bf16 v[20:23], a[140:143], v[140:143], v[20:23]
s_waitcnt vmcnt(13)
v_mfma_f32_16x16x32_bf16 v[16:19], a[144:147], v[144:147], v[16:19]
v_mfma_f32_16x16x32_bf16 v[20:23], a[148:151], v[144:147], v[20:23]
s_waitcnt vmcnt(12)
v_mfma_f32_16x16x32_bf16 v[16:19], a[152:155], v[148:151], v[16:19]
v_mfma_f32_16x16x32_bf16 v[20:23], a[156:159], v[148:151], v[20:23]
s_waitcnt vmcnt(11)
v_mfma_f32_16x16x32_bf16 v[16:19], a[160:163], v[152:155], v[16:19]
v_mfma_f32_16x16x32_bf16 v[20:23], a[164:167], v[152:155], v[20:23]
s_waitcnt vmcnt(10)
v_mfma_f32_16x16x32_bf16 v[16:19], a[168:171], v[156:159], v[16:19]
v_mfma_f32_16x16x32_bf16 v[20:23], a[172:175], v[156:159], v[20:23]
s_waitcnt vmcnt(9)
v_mfma_f32_16x16x32_bf16 v[16:19], a[176:179], v[72:75], v[16:19]
v_mfma_f32_16x16x32_bf16 v[20:23], a[180:183], v[72:75], v[20:23]
s_waitcnt vmcnt(8)
v_mfma_f32_16x16x32_bf16 v[16:19], a[184:187], v[76:79], v[16:19]
v_mfma_f32_16x16x32_bf16 v[20:23], a[188:191], v[76:79], v[20:23]
s_waitcnt vmcnt(7)
v_mfma_f32_16x16x32_bf16 v[16:19], a[192:195], v[80:83], v[16:19]
v_mfma_f32_16x16x32_bf16 v[20:23], a[196:199], v[80:83], v[20:23]
s_waitcnt vmcnt(6)
v_mfma_f32_16x16x32_bf16 v[16:19], a[200:203], v[84:87], v[16:19]
v_mfma_f32_16x16x32_bf16 v[20:23], a[204:207], v[84:87], v[20:23]
s_waitcnt vmcnt(5)
v_mfma_f32_16x16x32_bf16 v[16:19], a[208:211], v[88:91], v[16:19]
v_mfma_f32_16x16x32_bf16 v[20:23], a[212:215], v[88:91], v[20:23]
s_waitcnt vmcnt(4)
v_mfma_f32_16x16x32_bf16 v[16:19], a[216:219], v[92:95], v[16:19]
v_mfma_f32_16x16x32_bf16 v[20:23], a[220:223], v[92:95], v[20:23]
s_waitcnt vmcnt(3)
v_mfma_f32_16x16x32_bf16 v[16:19], a[224:227], v[96:99], v[16:19]
v_mfma_f32_16x16x32_bf16 v[20:23], a[228:231], v[96:99], v[20:23]
s_waitcnt vmcnt(2)
v_mfma_f32_16x16x32_bf16 v[16:19], a[232:235], v[100:103], v[16:19]
v_mfma_f32_16x16x32_bf16 v[20:23], a[236:239], v[100:103], v[20:23]
s_waitcnt vmcnt(1)
v_mfma_f32_16x16x32_bf16 v[16:19], a[240:243], v[104:107], v[16:19]
v_mfma_f32_16x16x32_bf16 v[20:23], a[244:247], v[104:107], v[20:23]
s_waitcnt vmcnt(0)
v_mfma_f32_16x16x32_bf16 v[16:19], a[248:251], v[108:111], v[16:19]
v_mfma_f32_16x16x32_bf16 v[20:23], a[252:255], v[108:111], v[20:23]
s_add_u32 s59, s65, s89
s_cmp_ge_u32 s59, 128
s_cbranch_scc1 L_nnf
s_lshl_b32 s57, s59, 14
buffer_load_dword v163, v9, s[48:51], s57 offen
s_mul_i32 s57, s59, 45056
s_mul_i32 s58, s32, 11264
s_add_u32 s57, s57, s58
s_add_u32 s57, s57, 84934656
buffer_load_dwordx4 v[88:91], v1, s[36:39], s57 offen offset:0 sc1
buffer_load_dwordx4 v[92:95], v1, s[36:39], s57 offen offset:1024 sc1
buffer_load_dwordx4 v[96:99], v1, s[36:39], s57 offen offset:2048 sc1
buffer_load_dwordx4 v[100:103], v1, s[36:39], s57 offen offset:3072 sc1
s_add_u32 s57, s57, 4096
buffer_load_dwordx4 v[104:107], v1, s[36:39], s57 offen offset:0 sc1
buffer_load_dwordx4 v[108:111], v1, s[36:39], s57 offen offset:1024 sc1
buffer_load_dwordx4 v[112:115], v1, s[36:39], s57 offen offset:2048 sc1
buffer_load_dwordx4 v[116:119], v1, s[36:39], s57 offen offset:3072 sc1
s_add_u32 s57, s57, 4096
buffer_load_dwordx4 v[120:123], v1, s[36:39], s57 offen offset:0 sc1
buffer_load_dwordx4 v[124:127], v1, s[36:39], s57 offen offset:1024 sc1
buffer_load_dwordx4 v[128:131], v1, s[36:39], s57 offen offset:2048 sc1
L_nnf:
s_nop 3
ds_write_b128 v7, v[16:19] offset:0
ds_write_b128 v7, v[20:23] offset:1024
ds_write_b128 v7, v[24:27] offset:2048
ds_write_b128 v7, v[28:31] offset:3072
s_waitcnt lgkmcnt(0)
s_barrier
ds_read_b32 v72, v8 offset:0
ds_read_b32 v73, v8 offset:1024
ds_read_b32 v74, v8 offset:2048
ds_read_b32 v75, v8 offset:3072
ds_read_b32 v76, v8 offset:4096
ds_read_b32 v77, v8 offset:5120
ds_read_b32 v78, v8 offset:6144
ds_read_b32 v79, v8 offset:7168
ds_read_b32 v80, v8 offset:8192
ds_read_b32 v81, v8 offset:9216
ds_read_b32 v82, v8 offset:10240
ds_read_b32 v83, v8 offset:11264
ds_read_b32 v84, v8 offset:12288
ds_read_b32 v85, v8 offset:13312
ds_read_b32 v86, v8 offset:14336
ds_read_b32 v87, v8 offset:15360
v_xor_b32 v7, 0x4000, v7
s_waitcnt lgkmcnt(11)
v_add_f32 v72, v72, v76
s_waitcnt lgkmcnt(10)
v_add_f32 v73, v73, v77
s_waitcnt lgkmcnt(9)
v_add_f32 v74, v74, v78
s_waitcnt lgkmcnt(8)
v_add_f32 v75, v75, v79
s_waitcnt lgkmcnt(3)
v_add_f32 v80, v80, v84
s_waitcnt lgkmcnt(2)
v_add_f32 v81, v81, v85
s_waitcnt lgkmcnt(1)
v_add_f32 v82, v82, v86
s_waitcnt lgkmcnt(0)
v_add_f32 v83, v83, v87
v_xor_b32 v8, 0x4000, v8
v_add_f32 v72, v72, v80
v_add_f32 v73, v73, v81
v_add_f32 v74, v74, v82
v_add_f32 v75, v75, v83
v_cvt_pk_bf16_f32 v76, v72, v73
v_cvt_pk_bf16_f32 v77, v74, v75
v_lshlrev_b32 v72, 16, v76
v_and_b32 v73, s71, v76
v_lshlrev_b32 v74, 16, v77
v_and_b32 v75, s71, v77
s_mov_b32 s57, 0xbfb8aa3b
s_lshl_b32 s56, s65, 14
v_mul_f32 v78, s57, v74
v_mul_f32 v79, s57, v75
v_exp_f32 v78, v78
v_exp_f32 v79, v79
v_add_f32 v78, 1.0, v78
v_add_f32 v79, 1.0, v79
v_rcp_f32 v78, v78
v_rcp_f32 v79, v79
v_mul_f32 v74, v74, v78
v_mul_f32 v75, v75, v79
v_cvt_pk_bf16_f32 v77, v74, v75
v_lshlrev_b32 v74, 16, v77
v_and_b32 v75, s71, v77
v_mul_f32 v72, v72, v74
v_mul_f32 v73, v73, v75
v_cvt_pk_bf16_f32 v76, v72, v73
v_lshlrev_b32 v72, 16, v76
v_and_b32 v73, s71, v76
v_lshlrev_b32 v74, 16, v11
v_and_b32 v75, s71, v11
v_add_f32 v72, v72, v74
v_add_f32 v73, v73, v75
v_cvt_pk_bf16_f32 v76, v72, v73
buffer_store_dword v76, v9, s[40:43], s56 offen
s_add_u32 s65, s65, s89
s_cmp_ge_u32 s65, 128
s_cbranch_scc1 L_task
s_waitcnt vmcnt(12)
v_mov_b32 v11, v163
s_waitcnt vmcnt(11)
v_mfma_f32_16x16x32_bf16 v[24:27], v[168:171], v[88:91], 0
v_mfma_f32_16x16x32_bf16 v[28:31], v[172:175], v[88:91], 0
s_waitcnt vmcnt(10)
v_mfma_f32_16x16x32_bf16 v[24:27], v[176:179], v[92:95], v[24:27]
v_mfma_f32_16x16x32_bf16 v[28:31], v[180:183], v[92:95], v[28:31]
s_waitcnt vmcnt(9)
v_mfma_f32_16x16x32_bf16 v[24:27], v[184:187], v[96:99], v[24:27]
v_mfma_f32_16x16x32_bf16 v[28:31], v[188:191], v[96:99], v[28:31]
s_waitcnt vmcnt(8)
v_mfma_f32_16x16x32_bf16 v[24:27], v[192:195], v[100:103], v[24:27]
v_mfma_f32_16x16x32_bf16 v[28:31], v[196:199], v[100:103], v[28:31]
s_waitcnt vmcnt(7)
v_mfma_f32_16x16x32_bf16 v[24:27], v[200:203], v[104:107], v[24:27]
v_mfma_f32_16x16x32_bf16 v[28:31], v[204:207], v[104:107], v[28:31]
s_waitcnt vmcnt(6)
v_mfma_f32_16x16x32_bf16 v[24:27], v[208:211], v[108:111], v[24:27]
v_mfma_f32_16x16x32_bf16 v[28:31], v[212:215], v[108:111], v[28:31]
s_waitcnt vmcnt(5)
v_mfma_f32_16x16x32_bf16 v[24:27], v[216:219], v[112:115], v[24:27]
v_mfma_f32_16x16x32_bf16 v[28:31], v[220:223], v[112:115], v[28:31]
s_waitcnt vmcnt(4)
v_mfma_f32_16x16x32_bf16 v[24:27], v[224:227], v[116:119], v[24:27]
v_mfma_f32_16x16x32_bf16 v[28:31], v[228:231], v[116:119], v[28:31]
s_waitcnt vmcnt(3)
v_mfma_f32_16x16x32_bf16 v[24:27], v[232:235], v[120:123], v[24:27]
v_mfma_f32_16x16x32_bf16 v[28:31], v[236:239], v[120:123], v[28:31]
s_waitcnt vmcnt(2)
v_mfma_f32_16x16x32_bf16 v[24:27], v[240:243], v[124:127], v[24:27]
v_mfma_f32_16x16x32_bf16 v[28:31], v[244:247], v[124:127], v[28:31]
s_waitcnt vmcnt(1)
v_mfma_f32_16x16x32_bf16 v[24:27], v[248:251], v[128:131], v[24:27]
v_mfma_f32_16x16x32_bf16 v[28:31], v[252:255], v[128:131], v[28:31]
s_branch L_task
L_pa2:
s_add_u32 s35, s35, 1
s_cmp_gt_u32 s35, 262144
s_cbranch_scc1 L_END
s_sleep 1
L_pa:
s_mov_b32 s54, s64
buffer_load_dword v12, v10, s[36:39], s69 offen sc1
s_waitcnt vmcnt(0)
v_cmp_ge_u32 vcc, s54, v12
s_cbranch_vccnz L_pa2
L_attn:
s_lshl_b32 s56, s64, 18
s_lshl_b32 s57, s62, 13
s_add_u32 s56, s56, s57
s_add_u32 s56, s56, 50593792
s_add_u32 s57, s56, 4096
s_lshl_b32 s58, s68, 12
s_add_u32 s58, s58, s56
buffer_load_dwordx4 v[104:107], v160, s[36:39], s56 offen offset:0 sc1
buffer_load_dwordx4 v[108:111], v160, s[36:39], s56 offen offset:2048 sc1
buffer_load_dwordx4 v[112:115], v160, s[36:39], s57 offen offset:0 sc1
buffer_load_dwordx4 v[116:119], v160, s[36:39], s57 offen offset:2048 sc1
buffer_load_dwordx2 v[120:121], v2, s[36:39], s58 offen offset:1024 sc1
buffer_load_dwordx2 v[124:125], v2, s[36:39], s58 offen offset:3072 sc1
s_lshl_b32 s56, s64, 1
s_add_u32 s56, s56, s67
s_lshl_b32 s57, s56, 17
s_lshl_b32 s58, s62, 12
s_add_u32 s57, s57, s58
s_lshl_b32 s58, s68, 11
s_add_u32 s57, s57, s58
s_add_u32 s57, s57, 68157440
s_lshl_b32 s56, s64, 12
s_lshl_b32 s58, s62, 7
s_add_u32 s56, s56, s58
s_add_u32 s56, s56, 2359296
v_mov_b32 v137, 0
s_waitcnt vmcnt(5)
v_mfma_f32_16x16x32_bf16 v[128:131], v[104:107], v[32:35], 0
s_waitcnt vmcnt(4)
v_mfma_f32_16x16x32_bf16 v[128:131], v[108:111], v[36:39], v[128:131]
s_waitcnt vmcnt(3)
v_mfma_f32_16x16x32_bf16 v[128:131], v[112:115], v[40:43], v[128:131]
s_waitcnt vmcnt(2)
v_mfma_f32_16x16x32_bf16 v[128:131], v[116:119], v[44:47], v[128:131]
s_waitcnt vmcnt(1)
v_mov_b32 v122, v121
v_mov_b32 v123, v120
s_waitcnt vmcnt(0)
v_mov_b32 v126, v125
v_mov_b32 v127, v124
s_nop 1
v_mul_f32 v128, s70, v128
v_mul_f32 v129, s70, v129
v_max3_f32 v14, v161, v128, v129
v_mov_b32 v15, v14
s_nop 1
v_permlane16_swap_b32 v14, v15
v_max_f32 v14, v14, v15
v_mov_b32 v15, v14
s_nop 1
v_permlane32_swap_b32 v14, v15
v_max_f32 v14, v14, v15
v_sub_f32 v64, v64, v14
v_sub_f32 v65, v65, v14
v_sub_f32 v66, v66, v14
v_sub_f32 v67, v67, v14
v_sub_f32 v68, v68, v14
v_sub_f32 v69, v69, v14
v_sub_f32 v70, v70, v14
v_sub_f32 v71, v71, v14
v_sub_f32 v128, v128, v14
v_sub_f32 v129, v129, v14
v_exp_f32 v64, v64
v_exp_f32 v65, v65
v_exp_f32 v66, v66
v_exp_f32 v67, v67
v_exp_f32 v68, v68
v_exp_f32 v69, v69
v_exp_f32 v70, v70
v_exp_f32 v71, v71
v_exp_f32 v128, v128
v_exp_f32 v129, v129
v_add_f32 v14, v64, v65
v_add_f32 v14, v14, v66
v_add_f32 v14, v14, v67
v_add_f32 v14, v14, v68
v_add_f32 v14, v14, v69
v_add_f32 v14, v14, v70
v_add_f32 v14, v14, v71
v_add_f32 v14, v14, v128
v_add_f32 v14, v14, v129
v_mov_b32 v15, v14
s_nop 1
v_permlane16_swap_b32 v14, v15
v_add_f32 v14, v14, v15
v_mov_b32 v15, v14
s_nop 1
v_permlane32_swap_b32 v14, v15
v_add_f32 v14, v14, v15
v_rcp_f32 v14, v14
s_nop 0
v_mul_f32 v64, v64, v14
v_mul_f32 v65, v65, v14
v_mul_f32 v66, v66, v14
v_mul_f32 v67, v67, v14
v_mul_f32 v68, v68, v14
v_mul_f32 v69, v69, v14
v_mul_f32 v70, v70, v14
v_mul_f32 v71, v71, v14
v_mul_f32 v128, v128, v14
v_mul_f32 v129, v129, v14
v_cvt_pk_bf16_f32 v132, v64, v65
v_cvt_pk_bf16_f32 v133, v66, v67
v_cvt_pk_bf16_f32 v134, v68, v69
v_cvt_pk_bf16_f32 v135, v70, v71
v_cvt_pk_bf16_f32 v136, v128, v129
s_nop 0
v_mfma_f32_16x16x32_bf16 v[140:143], v[48:51], v[132:135], 0
v_mfma_f32_16x16x32_bf16 v[144:147], v[52:55], v[132:135], 0
v_mfma_f32_16x16x32_bf16 v[148:151], v[56:59], v[132:135], 0
v_mfma_f32_16x16x32_bf16 v[152:155], v[60:63], v[132:135], 0
v_mfma_f32_16x16x16_bf16 v[140:143], v[120:121], v[136:137], v[140:143]
v_mfma_f32_16x16x16_bf16 v[144:147], v[122:123], v[136:137], v[144:147]
v_mfma_f32_16x16x16_bf16 v[148:151], v[124:125], v[136:137], v[148:151]
v_mfma_f32_16x16x16_bf16 v[152:155], v[126:127], v[136:137], v[152:155]
v_cvt_pk_bf16_f32 v104, v140, v144
v_cvt_pk_bf16_f32 v105, v141, v145
v_cvt_pk_bf16_f32 v106, v142, v146
v_cvt_pk_bf16_f32 v107, v143, v147
buffer_store_dwordx4 v[104:107], v1, s[36:39], s57 offen offset:0 sc1
s_nop 2
v_cvt_pk_bf16_f32 v108, v148, v152
v_cvt_pk_bf16_f32 v109, v149, v153
v_cvt_pk_bf16_f32 v110, v150, v154
v_cvt_pk_bf16_f32 v111, v151, v155
buffer_store_dwordx4 v[108:111], v1, s[36:39], s57 offen offset:1024 sc1
s_cmp_lt_u32 s64, 3
s_cselect_b32 s54, 3, 6
s_add_u32 s64, s64, s54
s_cmp_lt_u32 s64, 64
s_cbranch_scc1 L_nxA
s_waitcnt vmcnt(0)
s_barrier
s_cmp_lg_u32 s32, 0
s_cbranch_scc1 L_task
s_mov_b64 exec, 1
buffer_store_dword v3, off, s[36:39], s56 sc1
s_mov_b64 exec, -1
s_branch L_task
L_nxA:
s_lshl_b32 s59, s64, 19
s_lshl_b32 s57, s62, 14
s_add_u32 s59, s59, s57
s_add_u32 s59, s59, 16777216
s_lshl_b32 s57, s68, 13
s_add_u32 s57, s57, s59
s_add_u32 s58, s57, 4096
buffer_load_dwordx4 v[72:75], v1, s[36:39], s59 offen offset:0 sc1
buffer_load_dwordx4 v[76:79], v1, s[36:39], s59 offen offset:1024 sc1
s_add_u32 s59, s59, 4096
buffer_load_dwordx4 v[80:83], v1, s[36:39], s59 offen offset:0 sc1
buffer_load_dwordx4 v[84:87], v1, s[36:39], s59 offen offset:1024 sc1
s_add_u32 s59, s59, 4096
buffer_load_dwordx4 v[88:91], v1, s[36:39], s59 offen offset:0 sc1
buffer_load_dwordx4 v[92:95], v1, s[36:39], s59 offen offset:1024 sc1
s_add_u32 s59, s59, 4096
buffer_load_dwordx4 v[96:99], v1, s[36:39], s59 offen offset:0 sc1
buffer_load_dwordx4 v[100:103], v1, s[36:39], s59 offen offset:1024 sc1
buffer_load_dwordx4 v[48:51], v1, s[36:39], s57 offen offset:2048 sc1
buffer_load_dwordx4 v[52:55], v1, s[36:39], s57 offen offset:3072 sc1
buffer_load_dwordx4 v[56:59], v1, s[36:39], s58 offen offset:2048 sc1
buffer_load_dwordx4 v[60:63], v1, s[36:39], s58 offen offset:3072 sc1
s_waitcnt vmcnt(12)
s_barrier
s_cmp_lg_u32 s32, 0
s_cbranch_scc1 L_nofl
s_mov_b64 exec, 1
buffer_store_dword v3, off, s[36:39], s56 sc1
s_mov_b64 exec, -1
L_nofl:
ds_read_b128 v[32:35], v4 offset:0
ds_read_b128 v[36:39], v4 offset:1024
ds_read_b128 v[40:43], v4 offset:2048
ds_read_b128 v[44:47], v4 offset:3072
s_waitcnt lgkmcnt(3)
s_waitcnt vmcnt(11)
v_mfma_f32_16x16x32_bf16 v[64:67], v[72:75], v[32:35], 0
s_waitcnt vmcnt(10)
v_mfma_f32_16x16x32_bf16 v[68:71], v[76:79], v[32:35], 0
s_waitcnt lgkmcnt(2)
s_waitcnt vmcnt(9)
v_mfma_f32_16x16x32_bf16 v[64:67], v[80:83], v[36:39], v[64:67]
s_waitcnt vmcnt(8)
v_mfma_f32_16x16x32_bf16 v[68:71], v[84:87], v[36:39], v[68:71]
s_waitcnt lgkmcnt(1)
s_waitcnt vmcnt(7)
v_mfma_f32_16x16x32_bf16 v[64:67], v[88:91], v[40:43], v[64:67]
s_waitcnt vmcnt(6)
v_mfma_f32_16x16x32_bf16 v[68:71], v[92:95], v[40:43], v[68:71]
s_waitcnt lgkmcnt(0)
s_waitcnt vmcnt(5)
v_mfma_f32_16x16x32_bf16 v[64:67], v[96:99], v[44:47], v[64:67]
s_waitcnt vmcnt(4)
v_mfma_f32_16x16x32_bf16 v[68:71], v[100:103], v[44:47], v[68:71]
v_add_u32 v4, 8192, v4
v_mov_b32 v13, 0xceabfb8f
s_nop 1
v_mul_f32 v64, s70, v64
v_cndmask_b32 v64, v13, v64, s[72:73]
v_mul_f32 v65, s70, v65
v_cndmask_b32 v65, v13, v65, s[74:75]
v_mul_f32 v66, s70, v66
v_cndmask_b32 v66, v13, v66, s[76:77]
v_mul_f32 v67, s70, v67
v_cndmask_b32 v67, v13, v67, s[78:79]
v_mul_f32 v68, s70, v68
v_cndmask_b32 v68, v13, v68, s[80:81]
v_mul_f32 v69, s70, v69
v_cndmask_b32 v69, v13, v69, s[82:83]
v_mul_f32 v70, s70, v70
v_cndmask_b32 v70, v13, v70, s[84:85]
v_mul_f32 v71, s70, v71
v_cndmask_b32 v71, v13, v71, s[86:87]
v_max3_f32 v161, v64, v65, v66
v_max3_f32 v161, v161, v67, v68
v_max3_f32 v161, v161, v69, v70
v_max_f32 v161, v161, v71
s_waitcnt vmcnt(0)
s_branch L_task
L_WEND:
s_branch L_END
L_side:
s_cmp_ge_u32 s34, 27
s_cbranch_scc1 L_END
s_cmp_lg_u32 s32, 0
s_cbranch_scc1 L_side2
L_side2:
s_waitcnt vmcnt(0)
s_barrier
s_cmp_lt_u32 s34, 11
s_cbranch_scc1 L_side3
s_sub_u32 s66, s34, 11
s_mov_b32 s40, s14
s_and_b32 s41, s15, 0xffff
s_mov_b32 s42, 0x400000
s_mov_b32 s43, 0x20000
s_mov_b32 s44, s24
s_and_b32 s45, s25, 0xffff
s_mov_b32 s46, 0x158000
s_mov_b32 s47, 0x20000
v_lshrrev_b32 v1, 4, v0
v_lshlrev_b32 v1, 13, v1
v_and_b32 v2, 15, v0
v_lshlrev_b32 v2, 2, v2
s_lshl_b32 s54, s66, 6
v_add3_u32 v1, v1, v2, s54
v_add_u32 v2, 1024, v1
s_lshl_b32 s56, s32, 20
s_mul_i32 s57, s32, 360448
s_add_u32 s54, s57, 0
buffer_load_dword v16, v1, s[44:47], s54 offen
buffer_load_dword v17, v2, s[44:47], s54 offen
s_add_u32 s54, s57, 2048
buffer_load_dword v18, v1, s[44:47], s54 offen
buffer_load_dword v19, v2, s[44:47], s54 offen
s_add_u32 s54, s57, 4096
buffer_load_dword v20, v1, s[44:47], s54 offen
buffer_load_dword v21, v2, s[44:47], s54 offen
s_add_u32 s54, s57, 6144
buffer_load_dword v22, v1, s[44:47], s54 offen
buffer_load_dword v23, v2, s[44:47], s54 offen
s_add_u32 s54, s57, 32768
buffer_load_dword v24, v1, s[44:47], s54 offen
buffer_load_dword v25, v2, s[44:47], s54 offen
s_add_u32 s54, s57, 34816
buffer_load_dword v26, v1, s[44:47], s54 offen
buffer_load_dword v27, v2, s[44:47], s54 offen
s_add_u32 s54, s57, 36864
buffer_load_dword v28, v1, s[44:47], s54 offen
buffer_load_dword v29, v2, s[44:47], s54 offen
s_add_u32 s54, s57, 38912
buffer_load_dword v30, v1, s[44:47], s54 offen
buffer_load_dword v31, v2, s[44:47], s54 offen
s_add_u32 s54, s57, 65536
buffer_load_dword v32, v1, s[44:47], s54 offen
buffer_load_dword v33, v2, s[44:47], s54 offen
s_add_u32 s54, s57, 67584
buffer_load_dword v34, v1, s[44:47], s54 offen
buffer_load_dword v35, v2, s[44:47], s54 offen
s_add_u32 s54, s57, 69632
buffer_load_dword v36, v1, s[44:47], s54 offen
buffer_load_dword v37, v2, s[44:47], s54 offen
s_add_u32 s54, s57, 71680
buffer_load_dword v38, v1, s[44:47], s54 offen
buffer_load_dword v39, v2, s[44:47], s54 offen
s_add_u32 s54, s57, 98304
buffer_load_dword v40, v1, s[44:47], s54 offen
buffer_load_dword v41, v2, s[44:47], s54 offen
s_add_u32 s54, s57, 100352
buffer_load_dword v42, v1, s[44:47], s54 offen
buffer_load_dword v43, v2, s[44:47], s54 offen
s_add_u32 s54, s57, 102400
buffer_load_dword v44, v1, s[44:47], s54 offen
buffer_load_dword v45, v2, s[44:47], s54 offen
s_add_u32 s54, s57, 104448
buffer_load_dword v46, v1, s[44:47], s54 offen
buffer_load_dword v47, v2, s[44:47], s54 offen
s_add_u32 s54, s57, 131072
buffer_load_dword v48, v1, s[44:47], s54 offen
buffer_load_dword v49, v2, s[44:47], s54 offen
s_add_u32 s54, s57, 133120
buffer_load_dword v50, v1, s[44:47], s54 offen
buffer_load_dword v51, v2, s[44:47], s54 offen
s_add_u32 s54, s57, 135168
buffer_load_dword v52, v1, s[44:47], s54 offen
buffer_load_dword v53, v2, s[44:47], s54 offen
s_add_u32 s54, s57, 137216
buffer_load_dword v54, v1, s[44:47], s54 offen
buffer_load_dword v55, v2, s[44:47], s54 offen
s_add_u32 s54, s57, 163840
buffer_load_dword v56, v1, s[44:47], s54 offen
buffer_load_dword v57, v2, s[44:47], s54 offen
s_add_u32 s54, s57, 165888
buffer_load_dword v58, v1, s[44:47], s54 offen
buffer_load_dword v59, v2, s[44:47], s54 offen
s_add_u32 s54, s57, 167936
buffer_load_dword v60, v1, s[44:47], s54 offen
buffer_load_dword v61, v2, s[44:47], s54 offen
s_add_u32 s54, s57, 169984
buffer_load_dword v62, v1, s[44:47], s54 offen
buffer_load_dword v63, v2, s[44:47], s54 offen
s_add_u32 s54, s57, 196608
buffer_load_dword v64, v1, s[44:47], s54 offen
buffer_load_dword v65, v2, s[44:47], s54 offen
s_add_u32 s54, s57, 198656
buffer_load_dword v66, v1, s[44:47], s54 offen
buffer_load_dword v67, v2, s[44:47], s54 offen
s_add_u32 s54, s57, 200704
buffer_load_dword v68, v1, s[44:47], s54 offen
buffer_load_dword v69, v2, s[44:47], s54 offen
s_add_u32 s54, s57, 202752
buffer_load_dword v70, v1, s[44:47], s54 offen
buffer_load_dword v71, v2, s[44:47], s54 offen
s_waitcnt vmcnt(54)
v_perm_b32 v168, v17, v16, s52
v_perm_b32 v172, v17, v16, s53
s_waitcnt vmcnt(52)
v_perm_b32 v169, v19, v18, s52
v_perm_b32 v173, v19, v18, s53
s_waitcnt vmcnt(50)
v_perm_b32 v170, v21, v20, s52
v_perm_b32 v174, v21, v20, s53
s_waitcnt vmcnt(48)
v_perm_b32 v171, v23, v22, s52
v_perm_b32 v175, v23, v22, s53
s_add_u32 s54, s57, 229376
buffer_load_dword v16, v1, s[44:47], s54 offen
buffer_load_dword v17, v2, s[44:47], s54 offen
s_add_u32 s54, s57, 231424
buffer_load_dword v18, v1, s[44:47], s54 offen
buffer_load_dword v19, v2, s[44:47], s54 offen
s_add_u32 s54, s57, 233472
buffer_load_dword v20, v1, s[44:47], s54 offen
buffer_load_dword v21, v2, s[44:47], s54 offen
s_add_u32 s54, s57, 235520
buffer_load_dword v22, v1, s[44:47], s54 offen
buffer_load_dword v23, v2, s[44:47], s54 offen
s_waitcnt vmcnt(54)
v_perm_b32 v176, v25, v24, s52
v_perm_b32 v180, v25, v24, s53
s_waitcnt vmcnt(52)
v_perm_b32 v177, v27, v26, s52
v_perm_b32 v181, v27, v26, s53
s_waitcnt vmcnt(50)
v_perm_b32 v178, v29, v28, s52
v_perm_b32 v182, v29, v28, s53
s_waitcnt vmcnt(48)
v_perm_b32 v179, v31, v30, s52
v_perm_b32 v183, v31, v30, s53
s_add_u32 s54, s57, 262144
buffer_load_dword v24, v1, s[44:47], s54 offen
buffer_load_dword v25, v2, s[44:47], s54 offen
s_add_u32 s54, s57, 264192
buffer_load_dword v26, v1, s[44:47], s54 offen
buffer_load_dword v27, v2, s[44:47], s54 offen
s_add_u32 s54, s57, 266240
buffer_load_dword v28, v1, s[44:47], s54 offen
buffer_load_dword v29, v2, s[44:47], s54 offen
s_add_u32 s54, s57, 268288
buffer_load_dword v30, v1, s[44:47], s54 offen
buffer_load_dword v31, v2, s[44:47], s54 offen
s_waitcnt vmcnt(54)
v_perm_b32 v184, v33, v32, s52
v_perm_b32 v188, v33, v32, s53
s_waitcnt vmcnt(52)
v_perm_b32 v185, v35, v34, s52
v_perm_b32 v189, v35, v34, s53
s_waitcnt vmcnt(50)
v_perm_b32 v186, v37, v36, s52
v_perm_b32 v190, v37, v36, s53
s_waitcnt vmcnt(48)
v_perm_b32 v187, v39, v38, s52
v_perm_b32 v191, v39, v38, s53
s_add_u32 s54, s57, 294912
buffer_load_dword v32, v1, s[44:47], s54 offen
buffer_load_dword v33, v2, s[44:47], s54 offen
s_add_u32 s54, s57, 296960
buffer_load_dword v34, v1, s[44:47], s54 offen
buffer_load_dword v35, v2, s[44:47], s54 offen
s_add_u32 s54, s57, 299008
buffer_load_dword v36, v1, s[44:47], s54 offen
buffer_load_dword v37, v2, s[44:47], s54 offen
s_add_u32 s54, s57, 301056
buffer_load_dword v38, v1, s[44:47], s54 offen
buffer_load_dword v39, v2, s[44:47], s54 offen
s_waitcnt vmcnt(54)
v_perm_b32 v192, v41, v40, s52
v_perm_b32 v196, v41, v40, s53
s_waitcnt vmcnt(52)
v_perm_b32 v193, v43, v42, s52
v_perm_b32 v197, v43, v42, s53
s_waitcnt vmcnt(50)
v_perm_b32 v194, v45, v44, s52
v_perm_b32 v198, v45, v44, s53
s_waitcnt vmcnt(48)
v_perm_b32 v195, v47, v46, s52
v_perm_b32 v199, v47, v46, s53
s_add_u32 s54, s57, 327680
buffer_load_dword v40, v1, s[44:47], s54 offen
buffer_load_dword v41, v2, s[44:47], s54 offen
s_add_u32 s54, s57, 329728
buffer_load_dword v42, v1, s[44:47], s54 offen
buffer_load_dword v43, v2, s[44:47], s54 offen
s_add_u32 s54, s57, 331776
buffer_load_dword v44, v1, s[44:47], s54 offen
buffer_load_dword v45, v2, s[44:47], s54 offen
s_add_u32 s54, s57, 333824
buffer_load_dword v46, v1, s[44:47], s54 offen
buffer_load_dword v47, v2, s[44:47], s54 offen
s_waitcnt vmcnt(54)
v_perm_b32 v200, v49, v48, s52
v_perm_b32 v204, v49, v48, s53
s_waitcnt vmcnt(52)
v_perm_b32 v201, v51, v50, s52
v_perm_b32 v205, v51, v50, s53
s_waitcnt vmcnt(50)
v_perm_b32 v202, v53, v52, s52
v_perm_b32 v206, v53, v52, s53
s_waitcnt vmcnt(48)
v_perm_b32 v203, v55, v54, s52
v_perm_b32 v207, v55, v54, s53
s_add_u32 s54, s56, 0
buffer_load_dword v48, v1, s[40:43], s54 offen
buffer_load_dword v49, v2, s[40:43], s54 offen
s_add_u32 s54, s56, 2048
buffer_load_dword v50, v1, s[40:43], s54 offen
buffer_load_dword v51, v2, s[40:43], s54 offen
s_add_u32 s54, s56, 4096
buffer_load_dword v52, v1, s[40:43], s54 offen
buffer_load_dword v53, v2, s[40:43], s54 offen
s_add_u32 s54, s56, 6144
buffer_load_dword v54, v1, s[40:43], s54 offen
buffer_load_dword v55, v2, s[40:43], s54 offen
s_waitcnt vmcnt(54)
v_perm_b32 v208, v57, v56, s52
v_perm_b32 v212, v57, v56, s53
s_waitcnt vmcnt(52)
v_perm_b32 v209, v59, v58, s52
v_perm_b32 v213, v59, v58, s53
s_waitcnt vmcnt(50)
v_perm_b32 v210, v61, v60, s52
v_perm_b32 v214, v61, v60, s53
s_waitcnt vmcnt(48)
v_perm_b32 v211, v63, v62, s52
v_perm_b32 v215, v63, v62, s53
s_add_u32 s54, s56, 32768
buffer_load_dword v56, v1, s[40:43], s54 offen
buffer_load_dword v57, v2, s[40:43], s54 offen
s_add_u32 s54, s56, 34816
buffer_load_dword v58, v1, s[40:43], s54 offen
buffer_load_dword v59, v2, s[40:43], s54 offen
s_add_u32 s54, s56, 36864
buffer_load_dword v60, v1, s[40:43], s54 offen
buffer_load_dword v61, v2, s[40:43], s54 offen
s_add_u32 s54, s56, 38912
buffer_load_dword v62, v1, s[40:43], s54 offen
buffer_load_dword v63, v2, s[40:43], s54 offen
s_waitcnt vmcnt(54)
v_perm_b32 v216, v65, v64, s52
v_perm_b32 v220, v65, v64, s53
s_waitcnt vmcnt(52)
v_perm_b32 v217, v67, v66, s52
v_perm_b32 v221, v67, v66, s53
s_waitcnt vmcnt(50)
v_perm_b32 v218, v69, v68, s52
v_perm_b32 v222, v69, v68, s53
s_waitcnt vmcnt(48)
v_perm_b32 v219, v71, v70, s52
v_perm_b32 v223, v71, v70, s53
s_add_u32 s54, s56, 65536
buffer_load_dword v64, v1, s[40:43], s54 offen
buffer_load_dword v65, v2, s[40:43], s54 offen
s_add_u32 s54, s56, 67584
buffer_load_dword v66, v1, s[40:43], s54 offen
buffer_load_dword v67, v2, s[40:43], s54 offen
s_add_u32 s54, s56, 69632
buffer_load_dword v68, v1, s[40:43], s54 offen
buffer_load_dword v69, v2, s[40:43], s54 offen
s_add_u32 s54, s56, 71680
buffer_load_dword v70, v1, s[40:43], s54 offen
buffer_load_dword v71, v2, s[40:43], s54 offen
s_waitcnt vmcnt(54)
v_perm_b32 v224, v17, v16, s52
v_perm_b32 v228, v17, v16, s53
s_waitcnt vmcnt(52)
v_perm_b32 v225, v19, v18, s52
v_perm_b32 v229, v19, v18, s53
s_waitcnt vmcnt(50)
v_perm_b32 v226, v21, v20, s52
v_perm_b32 v230, v21, v20, s53
s_waitcnt vmcnt(48)
v_perm_b32 v227, v23, v22, s52
v_perm_b32 v231, v23, v22, s53
s_add_u32 s54, s56, 98304
buffer_load_dword v16, v1, s[40:43], s54 offen
buffer_load_dword v17, v2, s[40:43], s54 offen
s_add_u32 s54, s56, 100352
buffer_load_dword v18, v1, s[40:43], s54 offen
buffer_load_dword v19, v2, s[40:43], s54 offen
s_add_u32 s54, s56, 102400
buffer_load_dword v20, v1, s[40:43], s54 offen
buffer_load_dword v21, v2, s[40:43], s54 offen
s_add_u32 s54, s56, 104448
buffer_load_dword v22, v1, s[40:43], s54 offen
buffer_load_dword v23, v2, s[40:43], s54 offen
s_waitcnt vmcnt(54)
v_perm_b32 v232, v25, v24, s52
v_perm_b32 v236, v25, v24, s53
s_waitcnt vmcnt(52)
v_perm_b32 v233, v27, v26, s52
v_perm_b32 v237, v27, v26, s53
s_waitcnt vmcnt(50)
v_perm_b32 v234, v29, v28, s52
v_perm_b32 v238, v29, v28, s53
s_waitcnt vmcnt(48)
v_perm_b32 v235, v31, v30, s52
v_perm_b32 v239, v31, v30, s53
s_add_u32 s54, s56, 131072
buffer_load_dword v24, v1, s[40:43], s54 offen
buffer_load_dword v25, v2, s[40:43], s54 offen
s_add_u32 s54, s56, 133120
buffer_load_dword v26, v1, s[40:43], s54 offen
buffer_load_dword v27, v2, s[40:43], s54 offen
s_add_u32 s54, s56, 135168
buffer_load_dword v28, v1, s[40:43], s54 offen
buffer_load_dword v29, v2, s[40:43], s54 offen
s_add_u32 s54, s56, 137216
buffer_load_dword v30, v1, s[40:43], s54 offen
buffer_load_dword v31, v2, s[40:43], s54 offen
s_waitcnt vmcnt(54)
v_perm_b32 v240, v33, v32, s52
v_perm_b32 v244, v33, v32, s53
s_waitcnt vmcnt(52)
v_perm_b32 v241, v35, v34, s52
v_perm_b32 v245, v35, v34, s53
s_waitcnt vmcnt(50)
v_perm_b32 v242, v37, v36, s52
v_perm_b32 v246, v37, v36, s53
s_waitcnt vmcnt(48)
v_perm_b32 v243, v39, v38, s52
v_perm_b32 v247, v39, v38, s53
s_add_u32 s54, s56, 163840
buffer_load_dword v32, v1, s[40:43], s54 offen
buffer_load_dword v33, v2, s[40:43], s54 offen
s_add_u32 s54, s56, 165888
buffer_load_dword v34, v1, s[40:43], s54 offen
buffer_load_dword v35, v2, s[40:43], s54 offen
s_add_u32 s54, s56, 167936
buffer_load_dword v36, v1, s[40:43], s54 offen
buffer_load_dword v37, v2, s[40:43], s54 offen
s_add_u32 s54, s56, 169984
buffer_load_dword v38, v1, s[40:43], s54 offen
buffer_load_dword v39, v2, s[40:43], s54 offen
s_waitcnt vmcnt(54)
v_perm_b32 v248, v41, v40, s52
v_perm_b32 v252, v41, v40, s53
s_waitcnt vmcnt(52)
v_perm_b32 v249, v43, v42, s52
v_perm_b32 v253, v43, v42, s53
s_waitcnt vmcnt(50)
v_perm_b32 v250, v45, v44, s52
v_perm_b32 v254, v45, v44, s53
s_waitcnt vmcnt(48)
v_perm_b32 v251, v47, v46, s52
v_perm_b32 v255, v47, v46, s53
s_add_u32 s54, s56, 196608
buffer_load_dword v40, v1, s[40:43], s54 offen
buffer_load_dword v41, v2, s[40:43], s54 offen
s_add_u32 s54, s56, 198656
buffer_load_dword v42, v1, s[40:43], s54 offen
buffer_load_dword v43, v2, s[40:43], s54 offen
s_add_u32 s54, s56, 200704
buffer_load_dword v44, v1, s[40:43], s54 offen
buffer_load_dword v45, v2, s[40:43], s54 offen
s_add_u32 s54, s56, 202752
buffer_load_dword v46, v1, s[40:43], s54 offen
buffer_load_dword v47, v2, s[40:43], s54 offen
s_waitcnt vmcnt(54)
v_perm_b32 v72, v49, v48, s52
v_accvgpr_write_b32 a0, v72
v_perm_b32 v73, v49, v48, s53
v_accvgpr_write_b32 a4, v73
s_waitcnt vmcnt(52)
v_perm_b32 v72, v51, v50, s52
v_accvgpr_write_b32 a1, v72
v_perm_b32 v73, v51, v50, s53
v_accvgpr_write_b32 a5, v73
s_waitcnt vmcnt(50)
v_perm_b32 v72, v53, v52, s52
v_accvgpr_write_b32 a2, v72
v_perm_b32 v73, v53, v52, s53
v_accvgpr_write_b32 a6, v73
s_waitcnt vmcnt(48)
v_perm_b32 v72, v55, v54, s52
v_accvgpr_write_b32 a3, v72
v_perm_b32 v73, v55, v54, s53
v_accvgpr_write_b32 a7, v73
s_add_u32 s54, s56, 229376
buffer_load_dword v48, v1, s[40:43], s54 offen
buffer_load_dword v49, v2, s[40:43], s54 offen
s_add_u32 s54, s56, 231424
buffer_load_dword v50, v1, s[40:43], s54 offen
buffer_load_dword v51, v2, s[40:43], s54 offen
s_add_u32 s54, s56, 233472
buffer_load_dword v52, v1, s[40:43], s54 offen
buffer_load_dword v53, v2, s[40:43], s54 offen
s_add_u32 s54, s56, 235520
buffer_load_dword v54, v1, s[40:43], s54 offen
buffer_load_dword v55, v2, s[40:43], s54 offen
s_waitcnt vmcnt(54)
v_perm_b32 v72, v57, v56, s52
v_accvgpr_write_b32 a8, v72
v_perm_b32 v73, v57, v56, s53
v_accvgpr_write_b32 a12, v73
s_waitcnt vmcnt(52)
v_perm_b32 v72, v59, v58, s52
v_accvgpr_write_b32 a9, v72
v_perm_b32 v73, v59, v58, s53
v_accvgpr_write_b32 a13, v73
s_waitcnt vmcnt(50)
v_perm_b32 v72, v61, v60, s52
v_accvgpr_write_b32 a10, v72
v_perm_b32 v73, v61, v60, s53
v_accvgpr_write_b32 a14, v73
s_waitcnt vmcnt(48)
v_perm_b32 v72, v63, v62, s52
v_accvgpr_write_b32 a11, v72
v_perm_b32 v73, v63, v62, s53
v_accvgpr_write_b32 a15, v73
s_add_u32 s54, s56, 262144
buffer_load_dword v56, v1, s[40:43], s54 offen
buffer_load_dword v57, v2, s[40:43], s54 offen
s_add_u32 s54, s56, 264192
buffer_load_dword v58, v1, s[40:43], s54 offen
buffer_load_dword v59, v2, s[40:43], s54 offen
s_add_u32 s54, s56, 266240
buffer_load_dword v60, v1, s[40:43], s54 offen
buffer_load_dword v61, v2, s[40:43], s54 offen
s_add_u32 s54, s56, 268288
buffer_load_dword v62, v1, s[40:43], s54 offen
buffer_load_dword v63, v2, s[40:43], s54 offen
s_waitcnt vmcnt(54)
v_perm_b32 v72, v65, v64, s52
v_accvgpr_write_b32 a16, v72
v_perm_b32 v73, v65, v64, s53
v_accvgpr_write_b32 a20, v73
s_waitcnt vmcnt(52)
v_perm_b32 v72, v67, v66, s52
v_accvgpr_write_b32 a17, v72
v_perm_b32 v73, v67, v66, s53
v_accvgpr_write_b32 a21, v73
s_waitcnt vmcnt(50)
v_perm_b32 v72, v69, v68, s52
v_accvgpr_write_b32 a18, v72
v_perm_b32 v73, v69, v68, s53
v_accvgpr_write_b32 a22, v73
s_waitcnt vmcnt(48)
v_perm_b32 v72, v71, v70, s52
v_accvgpr_write_b32 a19, v72
v_perm_b32 v73, v71, v70, s53
v_accvgpr_write_b32 a23, v73
s_add_u32 s54, s56, 294912
buffer_load_dword v64, v1, s[40:43], s54 offen
buffer_load_dword v65, v2, s[40:43], s54 offen
s_add_u32 s54, s56, 296960
buffer_load_dword v66, v1, s[40:43], s54 offen
buffer_load_dword v67, v2, s[40:43], s54 offen
s_add_u32 s54, s56, 299008
buffer_load_dword v68, v1, s[40:43], s54 offen
buffer_load_dword v69, v2, s[40:43], s54 offen
s_add_u32 s54, s56, 301056
buffer_load_dword v70, v1, s[40:43], s54 offen
buffer_load_dword v71, v2, s[40:43], s54 offen
s_waitcnt vmcnt(54)
v_perm_b32 v72, v17, v16, s52
v_accvgpr_write_b32 a24, v72
v_perm_b32 v73, v17, v16, s53
v_accvgpr_write_b32 a28, v73
s_waitcnt vmcnt(52)
v_perm_b32 v72, v19, v18, s52
v_accvgpr_write_b32 a25, v72
v_perm_b32 v73, v19, v18, s53
v_accvgpr_write_b32 a29, v73
s_waitcnt vmcnt(50)
v_perm_b32 v72, v21, v20, s52
v_accvgpr_write_b32 a26, v72
v_perm_b32 v73, v21, v20, s53
v_accvgpr_write_b32 a30, v73
s_waitcnt vmcnt(48)
v_perm_b32 v72, v23, v22, s52
v_accvgpr_write_b32 a27, v72
v_perm_b32 v73, v23, v22, s53
v_accvgpr_write_b32 a31, v73
s_add_u32 s54, s56, 327680
buffer_load_dword v16, v1, s[40:43], s54 offen
buffer_load_dword v17, v2, s[40:43], s54 offen
s_add_u32 s54, s56, 329728
buffer_load_dword v18, v1, s[40:43], s54 offen
buffer_load_dword v19, v2, s[40:43], s54 offen
s_add_u32 s54, s56, 331776
buffer_load_dword v20, v1, s[40:43], s54 offen
buffer_load_dword v21, v2, s[40:43], s54 offen
s_add_u32 s54, s56, 333824
buffer_load_dword v22, v1, s[40:43], s54 offen
buffer_load_dword v23, v2, s[40:43], s54 offen
s_waitcnt vmcnt(54)
v_perm_b32 v72, v25, v24, s52
v_accvgpr_write_b32 a32, v72
v_perm_b32 v73, v25, v24, s53
v_accvgpr_write_b32 a36, v73
s_waitcnt vmcnt(52)
v_perm_b32 v72, v27, v26, s52
v_accvgpr_write_b32 a33, v72
v_perm_b32 v73, v27, v26, s53
v_accvgpr_write_b32 a37, v73
s_waitcnt vmcnt(50)
v_perm_b32 v72, v29, v28, s52
v_accvgpr_write_b32 a34, v72
v_perm_b32 v73, v29, v28, s53
v_accvgpr_write_b32 a38, v73
s_waitcnt vmcnt(48)
v_perm_b32 v72, v31, v30, s52
v_accvgpr_write_b32 a35, v72
v_perm_b32 v73, v31, v30, s53
v_accvgpr_write_b32 a39, v73
s_add_u32 s54, s56, 360448
buffer_load_dword v24, v1, s[40:43], s54 offen
buffer_load_dword v25, v2, s[40:43], s54 offen
s_add_u32 s54, s56, 362496
buffer_load_dword v26, v1, s[40:43], s54 offen
buffer_load_dword v27, v2, s[40:43], s54 offen
s_add_u32 s54, s56, 364544
buffer_load_dword v28, v1, s[40:43], s54 offen
buffer_load_dword v29, v2, s[40:43], s54 offen
s_add_u32 s54, s56, 366592
buffer_load_dword v30, v1, s[40:43], s54 offen
buffer_load_dword v31, v2, s[40:43], s54 offen
s_waitcnt vmcnt(54)
v_perm_b32 v72, v33, v32, s52
v_accvgpr_write_b32 a40, v72
v_perm_b32 v73, v33, v32, s53
v_accvgpr_write_b32 a44, v73
s_waitcnt vmcnt(52)
v_perm_b32 v72, v35, v34, s52
v_accvgpr_write_b32 a41, v72
v_perm_b32 v73, v35, v34, s53
v_accvgpr_write_b32 a45, v73
s_waitcnt vmcnt(50)
v_perm_b32 v72, v37, v36, s52
v_accvgpr_write_b32 a42, v72
v_perm_b32 v73, v37, v36, s53
v_accvgpr_write_b32 a46, v73
s_waitcnt vmcnt(48)
v_perm_b32 v72, v39, v38, s52
v_accvgpr_write_b32 a43, v72
v_perm_b32 v73, v39, v38, s53
v_accvgpr_write_b32 a47, v73
s_add_u32 s54, s56, 393216
buffer_load_dword v32, v1, s[40:43], s54 offen
buffer_load_dword v33, v2, s[40:43], s54 offen
s_add_u32 s54, s56, 395264
buffer_load_dword v34, v1, s[40:43], s54 offen
buffer_load_dword v35, v2, s[40:43], s54 offen
s_add_u32 s54, s56, 397312
buffer_load_dword v36, v1, s[40:43], s54 offen
buffer_load_dword v37, v2, s[40:43], s54 offen
s_add_u32 s54, s56, 399360
buffer_load_dword v38, v1, s[40:43], s54 offen
buffer_load_dword v39, v2, s[40:43], s54 offen
s_waitcnt vmcnt(54)
v_perm_b32 v72, v41, v40, s52
v_accvgpr_write_b32 a48, v72
v_perm_b32 v73, v41, v40, s53
v_accvgpr_write_b32 a52, v73
s_waitcnt vmcnt(52)
v_perm_b32 v72, v43, v42, s52
v_accvgpr_write_b32 a49, v72
v_perm_b32 v73, v43, v42, s53
v_accvgpr_write_b32 a53, v73
s_waitcnt vmcnt(50)
v_perm_b32 v72, v45, v44, s52
v_accvgpr_write_b32 a50, v72
v_perm_b32 v73, v45, v44, s53
v_accvgpr_write_b32 a54, v73
s_waitcnt vmcnt(48)
v_perm_b32 v72, v47, v46, s52
v_accvgpr_write_b32 a51, v72
v_perm_b32 v73, v47, v46, s53
v_accvgpr_write_b32 a55, v73
s_add_u32 s54, s56, 425984
buffer_load_dword v40, v1, s[40:43], s54 offen
buffer_load_dword v41, v2, s[40:43], s54 offen
s_add_u32 s54, s56, 428032
buffer_load_dword v42, v1, s[40:43], s54 offen
buffer_load_dword v43, v2, s[40:43], s54 offen
s_add_u32 s54, s56, 430080
buffer_load_dword v44, v1, s[40:43], s54 offen
buffer_load_dword v45, v2, s[40:43], s54 offen
s_add_u32 s54, s56, 432128
buffer_load_dword v46, v1, s[40:43], s54 offen
buffer_load_dword v47, v2, s[40:43], s54 offen
s_waitcnt vmcnt(54)
v_perm_b32 v72, v49, v48, s52
v_accvgpr_write_b32 a56, v72
v_perm_b32 v73, v49, v48, s53
v_accvgpr_write_b32 a60, v73
s_waitcnt vmcnt(52)
v_perm_b32 v72, v51, v50, s52
v_accvgpr_write_b32 a57, v72
v_perm_b32 v73, v51, v50, s53
v_accvgpr_write_b32 a61, v73
s_waitcnt vmcnt(50)
v_perm_b32 v72, v53, v52, s52
v_accvgpr_write_b32 a58, v72
v_perm_b32 v73, v53, v52, s53
v_accvgpr_write_b32 a62, v73
s_waitcnt vmcnt(48)
v_perm_b32 v72, v55, v54, s52
v_accvgpr_write_b32 a59, v72
v_perm_b32 v73, v55, v54, s53
v_accvgpr_write_b32 a63, v73
s_add_u32 s54, s56, 458752
buffer_load_dword v48, v1, s[40:43], s54 offen
buffer_load_dword v49, v2, s[40:43], s54 offen
s_add_u32 s54, s56, 460800
buffer_load_dword v50, v1, s[40:43], s54 offen
buffer_load_dword v51, v2, s[40:43], s54 offen
s_add_u32 s54, s56, 462848
buffer_load_dword v52, v1, s[40:43], s54 offen
buffer_load_dword v53, v2, s[40:43], s54 offen
s_add_u32 s54, s56, 464896
buffer_load_dword v54, v1, s[40:43], s54 offen
buffer_load_dword v55, v2, s[40:43], s54 offen
s_waitcnt vmcnt(54)
v_perm_b32 v72, v57, v56, s52
v_accvgpr_write_b32 a64, v72
v_perm_b32 v73, v57, v56, s53
v_accvgpr_write_b32 a68, v73
s_waitcnt vmcnt(52)
v_perm_b32 v72, v59, v58, s52
v_accvgpr_write_b32 a65, v72
v_perm_b32 v73, v59, v58, s53
v_accvgpr_write_b32 a69, v73
s_waitcnt vmcnt(50)
v_perm_b32 v72, v61, v60, s52
v_accvgpr_write_b32 a66, v72
v_perm_b32 v73, v61, v60, s53
v_accvgpr_write_b32 a70, v73
s_waitcnt vmcnt(48)
v_perm_b32 v72, v63, v62, s52
v_accvgpr_write_b32 a67, v72
v_perm_b32 v73, v63, v62, s53
v_accvgpr_write_b32 a71, v73
s_add_u32 s54, s56, 491520
buffer_load_dword v56, v1, s[40:43], s54 offen
buffer_load_dword v57, v2, s[40:43], s54 offen
s_add_u32 s54, s56, 493568
buffer_load_dword v58, v1, s[40:43], s54 offen
buffer_load_dword v59, v2, s[40:43], s54 offen
s_add_u32 s54, s56, 495616
buffer_load_dword v60, v1, s[40:43], s54 offen
buffer_load_dword v61, v2, s[40:43], s54 offen
s_add_u32 s54, s56, 497664
buffer_load_dword v62, v1, s[40:43], s54 offen
buffer_load_dword v63, v2, s[40:43], s54 offen
s_waitcnt vmcnt(54)
v_perm_b32 v72, v65, v64, s52
v_accvgpr_write_b32 a72, v72
v_perm_b32 v73, v65, v64, s53
v_accvgpr_write_b32 a76, v73
s_waitcnt vmcnt(52)
v_perm_b32 v72, v67, v66, s52
v_accvgpr_write_b32 a73, v72
v_perm_b32 v73, v67, v66, s53
v_accvgpr_write_b32 a77, v73
s_waitcnt vmcnt(50)
v_perm_b32 v72, v69, v68, s52
v_accvgpr_write_b32 a74, v72
v_perm_b32 v73, v69, v68, s53
v_accvgpr_write_b32 a78, v73
s_waitcnt vmcnt(48)
v_perm_b32 v72, v71, v70, s52
v_accvgpr_write_b32 a75, v72
v_perm_b32 v73, v71, v70, s53
v_accvgpr_write_b32 a79, v73
s_add_u32 s54, s56, 524288
buffer_load_dword v64, v1, s[40:43], s54 offen
buffer_load_dword v65, v2, s[40:43], s54 offen
s_add_u32 s54, s56, 526336
buffer_load_dword v66, v1, s[40:43], s54 offen
buffer_load_dword v67, v2, s[40:43], s54 offen
s_add_u32 s54, s56, 528384
buffer_load_dword v68, v1, s[40:43], s54 offen
buffer_load_dword v69, v2, s[40:43], s54 offen
s_add_u32 s54, s56, 530432
buffer_load_dword v70, v1, s[40:43], s54 offen
buffer_load_dword v71, v2, s[40:43], s54 offen
s_waitcnt vmcnt(54)
v_perm_b32 v72, v17, v16, s52
v_accvgpr_write_b32 a80, v72
v_perm_b32 v73, v17, v16, s53
v_accvgpr_write_b32 a84, v73
s_waitcnt vmcnt(52)
v_perm_b32 v72, v19, v18, s52
v_accvgpr_write_b32 a81, v72
v_perm_b32 v73, v19, v18, s53
v_accvgpr_write_b32 a85, v73
s_waitcnt vmcnt(50)
v_perm_b32 v72, v21, v20, s52
v_accvgpr_write_b32 a82, v72
v_perm_b32 v73, v21, v20, s53
v_accvgpr_write_b32 a86, v73
s_waitcnt vmcnt(48)
v_perm_b32 v72, v23, v22, s52
v_accvgpr_write_b32 a83, v72
v_perm_b32 v73, v23, v22, s53
v_accvgpr_write_b32 a87, v73
s_add_u32 s54, s56, 557056
buffer_load_dword v16, v1, s[40:43], s54 offen
buffer_load_dword v17, v2, s[40:43], s54 offen
s_add_u32 s54, s56, 559104
buffer_load_dword v18, v1, s[40:43], s54 offen
buffer_load_dword v19, v2, s[40:43], s54 offen
s_add_u32 s54, s56, 561152
buffer_load_dword v20, v1, s[40:43], s54 offen
buffer_load_dword v21, v2, s[40:43], s54 offen
s_add_u32 s54, s56, 563200
buffer_load_dword v22, v1, s[40:43], s54 offen
buffer_load_dword v23, v2, s[40:43], s54 offen
s_waitcnt vmcnt(54)
v_perm_b32 v72, v25, v24, s52
v_accvgpr_write_b32 a88, v72
v_perm_b32 v73, v25, v24, s53
v_accvgpr_write_b32 a92, v73
s_waitcnt vmcnt(52)
v_perm_b32 v72, v27, v26, s52
v_accvgpr_write_b32 a89, v72
v_perm_b32 v73, v27, v26, s53
v_accvgpr_write_b32 a93, v73
s_waitcnt vmcnt(50)
v_perm_b32 v72, v29, v28, s52
v_accvgpr_write_b32 a90, v72
v_perm_b32 v73, v29, v28, s53
v_accvgpr_write_b32 a94, v73
s_waitcnt vmcnt(48)
v_perm_b32 v72, v31, v30, s52
v_accvgpr_write_b32 a91, v72
v_perm_b32 v73, v31, v30, s53
v_accvgpr_write_b32 a95, v73
s_add_u32 s54, s56, 589824
buffer_load_dword v24, v1, s[40:43], s54 offen
buffer_load_dword v25, v2, s[40:43], s54 offen
s_add_u32 s54, s56, 591872
buffer_load_dword v26, v1, s[40:43], s54 offen
buffer_load_dword v27, v2, s[40:43], s54 offen
s_add_u32 s54, s56, 593920
buffer_load_dword v28, v1, s[40:43], s54 offen
buffer_load_dword v29, v2, s[40:43], s54 offen
s_add_u32 s54, s56, 595968
buffer_load_dword v30, v1, s[40:43], s54 offen
buffer_load_dword v31, v2, s[40:43], s54 offen
s_waitcnt vmcnt(54)
v_perm_b32 v72, v33, v32, s52
v_accvgpr_write_b32 a96, v72
v_perm_b32 v73, v33, v32, s53
v_accvgpr_write_b32 a100, v73
s_waitcnt vmcnt(52)
v_perm_b32 v72, v35, v34, s52
v_accvgpr_write_b32 a97, v72
v_perm_b32 v73, v35, v34, s53
v_accvgpr_write_b32 a101, v73
s_waitcnt vmcnt(50)
v_perm_b32 v72, v37, v36, s52
v_accvgpr_write_b32 a98, v72
v_perm_b32 v73, v37, v36, s53
v_accvgpr_write_b32 a102, v73
s_waitcnt vmcnt(48)
v_perm_b32 v72, v39, v38, s52
v_accvgpr_write_b32 a99, v72
v_perm_b32 v73, v39, v38, s53
v_accvgpr_write_b32 a103, v73
s_add_u32 s54, s56, 622592
buffer_load_dword v32, v1, s[40:43], s54 offen
buffer_load_dword v33, v2, s[40:43], s54 offen
s_add_u32 s54, s56, 624640
buffer_load_dword v34, v1, s[40:43], s54 offen
buffer_load_dword v35, v2, s[40:43], s54 offen
s_add_u32 s54, s56, 626688
buffer_load_dword v36, v1, s[40:43], s54 offen
buffer_load_dword v37, v2, s[40:43], s54 offen
s_add_u32 s54, s56, 628736
buffer_load_dword v38, v1, s[40:43], s54 offen
buffer_load_dword v39, v2, s[40:43], s54 offen
s_waitcnt vmcnt(54)
v_perm_b32 v72, v41, v40, s52
v_accvgpr_write_b32 a104, v72
v_perm_b32 v73, v41, v40, s53
v_accvgpr_write_b32 a108, v73
s_waitcnt vmcnt(52)
v_perm_b32 v72, v43, v42, s52
v_accvgpr_write_b32 a105, v72
v_perm_b32 v73, v43, v42, s53
v_accvgpr_write_b32 a109, v73
s_waitcnt vmcnt(50)
v_perm_b32 v72, v45, v44, s52
v_accvgpr_write_b32 a106, v72
v_perm_b32 v73, v45, v44, s53
v_accvgpr_write_b32 a110, v73
s_waitcnt vmcnt(48)
v_perm_b32 v72, v47, v46, s52
v_accvgpr_write_b32 a107, v72
v_perm_b32 v73, v47, v46, s53
v_accvgpr_write_b32 a111, v73
s_add_u32 s54, s56, 655360
buffer_load_dword v40, v1, s[40:43], s54 offen
buffer_load_dword v41, v2, s[40:43], s54 offen
s_add_u32 s54, s56, 657408
buffer_load_dword v42, v1, s[40:43], s54 offen
buffer_load_dword v43, v2, s[40:43], s54 offen
s_add_u32 s54, s56, 659456
buffer_load_dword v44, v1, s[40:43], s54 offen
buffer_load_dword v45, v2, s[40:43], s54 offen
s_add_u32 s54, s56, 661504
buffer_load_dword v46, v1, s[40:43], s54 offen
buffer_load_dword v47, v2, s[40:43], s54 offen
s_waitcnt vmcnt(54)
v_perm_b32 v72, v49, v48, s52
v_accvgpr_write_b32 a112, v72
v_perm_b32 v73, v49, v48, s53
v_accvgpr_write_b32 a116, v73
s_waitcnt vmcnt(52)
v_perm_b32 v72, v51, v50, s52
v_accvgpr_write_b32 a113, v72
v_perm_b32 v73, v51, v50, s53
v_accvgpr_write_b32 a117, v73
s_waitcnt vmcnt(50)
v_perm_b32 v72, v53, v52, s52
v_accvgpr_write_b32 a114, v72
v_perm_b32 v73, v53, v52, s53
v_accvgpr_write_b32 a118, v73
s_waitcnt vmcnt(48)
v_perm_b32 v72, v55, v54, s52
v_accvgpr_write_b32 a115, v72
v_perm_b32 v73, v55, v54, s53
v_accvgpr_write_b32 a119, v73
s_add_u32 s54, s56, 688128
buffer_load_dword v48, v1, s[40:43], s54 offen
buffer_load_dword v49, v2, s[40:43], s54 offen
s_add_u32 s54, s56, 690176
buffer_load_dword v50, v1, s[40:43], s54 offen
buffer_load_dword v51, v2, s[40:43], s54 offen
s_add_u32 s54, s56, 692224
buffer_load_dword v52, v1, s[40:43], s54 offen
buffer_load_dword v53, v2, s[40:43], s54 offen
s_add_u32 s54, s56, 694272
buffer_load_dword v54, v1, s[40:43], s54 offen
buffer_load_dword v55, v2, s[40:43], s54 offen
s_waitcnt vmcnt(54)
v_perm_b32 v72, v57, v56, s52
v_accvgpr_write_b32 a120, v72
v_perm_b32 v73, v57, v56, s53
v_accvgpr_write_b32 a124, v73
s_waitcnt vmcnt(52)
v_perm_b32 v72, v59, v58, s52
v_accvgpr_write_b32 a121, v72
v_perm_b32 v73, v59, v58, s53
v_accvgpr_write_b32 a125, v73
s_waitcnt vmcnt(50)
v_perm_b32 v72, v61, v60, s52
v_accvgpr_write_b32 a122, v72
v_perm_b32 v73, v61, v60, s53
v_accvgpr_write_b32 a126, v73
s_waitcnt vmcnt(48)
v_perm_b32 v72, v63, v62, s52
v_accvgpr_write_b32 a123, v72
v_perm_b32 v73, v63, v62, s53
v_accvgpr_write_b32 a127, v73
s_add_u32 s54, s56, 720896
buffer_load_dword v56, v1, s[40:43], s54 offen
buffer_load_dword v57, v2, s[40:43], s54 offen
s_add_u32 s54, s56, 722944
buffer_load_dword v58, v1, s[40:43], s54 offen
buffer_load_dword v59, v2, s[40:43], s54 offen
s_add_u32 s54, s56, 724992
buffer_load_dword v60, v1, s[40:43], s54 offen
buffer_load_dword v61, v2, s[40:43], s54 offen
s_add_u32 s54, s56, 727040
buffer_load_dword v62, v1, s[40:43], s54 offen
buffer_load_dword v63, v2, s[40:43], s54 offen
s_waitcnt vmcnt(54)
v_perm_b32 v72, v65, v64, s52
v_accvgpr_write_b32 a128, v72
v_perm_b32 v73, v65, v64, s53
v_accvgpr_write_b32 a132, v73
s_waitcnt vmcnt(52)
v_perm_b32 v72, v67, v66, s52
v_accvgpr_write_b32 a129, v72
v_perm_b32 v73, v67, v66, s53
v_accvgpr_write_b32 a133, v73
s_waitcnt vmcnt(50)
v_perm_b32 v72, v69, v68, s52
v_accvgpr_write_b32 a130, v72
v_perm_b32 v73, v69, v68, s53
v_accvgpr_write_b32 a134, v73
s_waitcnt vmcnt(48)
v_perm_b32 v72, v71, v70, s52
v_accvgpr_write_b32 a131, v72
v_perm_b32 v73, v71, v70, s53
v_accvgpr_write_b32 a135, v73
s_add_u32 s54, s56, 753664
buffer_load_dword v64, v1, s[40:43], s54 offen
buffer_load_dword v65, v2, s[40:43], s54 offen
s_add_u32 s54, s56, 755712
buffer_load_dword v66, v1, s[40:43], s54 offen
buffer_load_dword v67, v2, s[40:43], s54 offen
s_add_u32 s54, s56, 757760
buffer_load_dword v68, v1, s[40:43], s54 offen
buffer_load_dword v69, v2, s[40:43], s54 offen
s_add_u32 s54, s56, 759808
buffer_load_dword v70, v1, s[40:43], s54 offen
buffer_load_dword v71, v2, s[40:43], s54 offen
s_waitcnt vmcnt(54)
v_perm_b32 v72, v17, v16, s52
v_accvgpr_write_b32 a136, v72
v_perm_b32 v73, v17, v16, s53
v_accvgpr_write_b32 a140, v73
s_waitcnt vmcnt(52)
v_perm_b32 v72, v19, v18, s52
v_accvgpr_write_b32 a137, v72
v_perm_b32 v73, v19, v18, s53
v_accvgpr_write_b32 a141, v73
s_waitcnt vmcnt(50)
v_perm_b32 v72, v21, v20, s52
v_accvgpr_write_b32 a138, v72
v_perm_b32 v73, v21, v20, s53
v_accvgpr_write_b32 a142, v73
s_waitcnt vmcnt(48)
v_perm_b32 v72, v23, v22, s52
v_accvgpr_write_b32 a139, v72
v_perm_b32 v73, v23, v22, s53
v_accvgpr_write_b32 a143, v73
s_add_u32 s54, s56, 786432
buffer_load_dword v16, v1, s[40:43], s54 offen
buffer_load_dword v17, v2, s[40:43], s54 offen
s_add_u32 s54, s56, 788480
buffer_load_dword v18, v1, s[40:43], s54 offen
buffer_load_dword v19, v2, s[40:43], s54 offen
s_add_u32 s54, s56, 790528
buffer_load_dword v20, v1, s[40:43], s54 offen
buffer_load_dword v21, v2, s[40:43], s54 offen
s_add_u32 s54, s56, 792576
buffer_load_dword v22, v1, s[40:43], s54 offen
buffer_load_dword v23, v2, s[40:43], s54 offen
s_waitcnt vmcnt(54)
v_perm_b32 v72, v25, v24, s52
v_accvgpr_write_b32 a144, v72
v_perm_b32 v73, v25, v24, s53
v_accvgpr_write_b32 a148, v73
s_waitcnt vmcnt(52)
v_perm_b32 v72, v27, v26, s52
v_accvgpr_write_b32 a145, v72
v_perm_b32 v73, v27, v26, s53
v_accvgpr_write_b32 a149, v73
s_waitcnt vmcnt(50)
v_perm_b32 v72, v29, v28, s52
v_accvgpr_write_b32 a146, v72
v_perm_b32 v73, v29, v28, s53
v_accvgpr_write_b32 a150, v73
s_waitcnt vmcnt(48)
v_perm_b32 v72, v31, v30, s52
v_accvgpr_write_b32 a147, v72
v_perm_b32 v73, v31, v30, s53
v_accvgpr_write_b32 a151, v73
s_add_u32 s54, s56, 819200
buffer_load_dword v24, v1, s[40:43], s54 offen
buffer_load_dword v25, v2, s[40:43], s54 offen
s_add_u32 s54, s56, 821248
buffer_load_dword v26, v1, s[40:43], s54 offen
buffer_load_dword v27, v2, s[40:43], s54 offen
s_add_u32 s54, s56, 823296
buffer_load_dword v28, v1, s[40:43], s54 offen
buffer_load_dword v29, v2, s[40:43], s54 offen
s_add_u32 s54, s56, 825344
buffer_load_dword v30, v1, s[40:43], s54 offen
buffer_load_dword v31, v2, s[40:43], s54 offen
s_waitcnt vmcnt(54)
v_perm_b32 v72, v33, v32, s52
v_accvgpr_write_b32 a152, v72
v_perm_b32 v73, v33, v32, s53
v_accvgpr_write_b32 a156, v73
s_waitcnt vmcnt(52)
v_perm_b32 v72, v35, v34, s52
v_accvgpr_write_b32 a153, v72
v_perm_b32 v73, v35, v34, s53
v_accvgpr_write_b32 a157, v73
s_waitcnt vmcnt(50)
v_perm_b32 v72, v37, v36, s52
v_accvgpr_write_b32 a154, v72
v_perm_b32 v73, v37, v36, s53
v_accvgpr_write_b32 a158, v73
s_waitcnt vmcnt(48)
v_perm_b32 v72, v39, v38, s52
v_accvgpr_write_b32 a155, v72
v_perm_b32 v73, v39, v38, s53
v_accvgpr_write_b32 a159, v73
s_add_u32 s54, s56, 851968
buffer_load_dword v32, v1, s[40:43], s54 offen
buffer_load_dword v33, v2, s[40:43], s54 offen
s_add_u32 s54, s56, 854016
buffer_load_dword v34, v1, s[40:43], s54 offen
buffer_load_dword v35, v2, s[40:43], s54 offen
s_add_u32 s54, s56, 856064
buffer_load_dword v36, v1, s[40:43], s54 offen
buffer_load_dword v37, v2, s[40:43], s54 offen
s_add_u32 s54, s56, 858112
buffer_load_dword v38, v1, s[40:43], s54 offen
buffer_load_dword v39, v2, s[40:43], s54 offen
s_waitcnt vmcnt(54)
v_perm_b32 v72, v41, v40, s52
v_accvgpr_write_b32 a160, v72
v_perm_b32 v73, v41, v40, s53
v_accvgpr_write_b32 a164, v73
s_waitcnt vmcnt(52)
v_perm_b32 v72, v43, v42, s52
v_accvgpr_write_b32 a161, v72
v_perm_b32 v73, v43, v42, s53
v_accvgpr_write_b32 a165, v73
s_waitcnt vmcnt(50)
v_perm_b32 v72, v45, v44, s52
v_accvgpr_write_b32 a162, v72
v_perm_b32 v73, v45, v44, s53
v_accvgpr_write_b32 a166, v73
s_waitcnt vmcnt(48)
v_perm_b32 v72, v47, v46, s52
v_accvgpr_write_b32 a163, v72
v_perm_b32 v73, v47, v46, s53
v_accvgpr_write_b32 a167, v73
s_add_u32 s54, s56, 884736
buffer_load_dword v40, v1, s[40:43], s54 offen
buffer_load_dword v41, v2, s[40:43], s54 offen
s_add_u32 s54, s56, 886784
buffer_load_dword v42, v1, s[40:43], s54 offen
buffer_load_dword v43, v2, s[40:43], s54 offen
s_add_u32 s54, s56, 888832
buffer_load_dword v44, v1, s[40:43], s54 offen
buffer_load_dword v45, v2, s[40:43], s54 offen
s_add_u32 s54, s56, 890880
buffer_load_dword v46, v1, s[40:43], s54 offen
buffer_load_dword v47, v2, s[40:43], s54 offen
s_waitcnt vmcnt(54)
v_perm_b32 v72, v49, v48, s52
v_accvgpr_write_b32 a168, v72
v_perm_b32 v73, v49, v48, s53
v_accvgpr_write_b32 a172, v73
s_waitcnt vmcnt(52)
v_perm_b32 v72, v51, v50, s52
v_accvgpr_write_b32 a169, v72
v_perm_b32 v73, v51, v50, s53
v_accvgpr_write_b32 a173, v73
s_waitcnt vmcnt(50)
v_perm_b32 v72, v53, v52, s52
v_accvgpr_write_b32 a170, v72
v_perm_b32 v73, v53, v52, s53
v_accvgpr_write_b32 a174, v73
s_waitcnt vmcnt(48)
v_perm_b32 v72, v55, v54, s52
v_accvgpr_write_b32 a171, v72
v_perm_b32 v73, v55, v54, s53
v_accvgpr_write_b32 a175, v73
s_add_u32 s54, s56, 917504
buffer_load_dword v48, v1, s[40:43], s54 offen
buffer_load_dword v49, v2, s[40:43], s54 offen
s_add_u32 s54, s56, 919552
buffer_load_dword v50, v1, s[40:43], s54 offen
buffer_load_dword v51, v2, s[40:43], s54 offen
s_add_u32 s54, s56, 921600
buffer_load_dword v52, v1, s[40:43], s54 offen
buffer_load_dword v53, v2, s[40:43], s54 offen
s_add_u32 s54, s56, 923648
buffer_load_dword v54, v1, s[40:43], s54 offen
buffer_load_dword v55, v2, s[40:43], s54 offen
s_waitcnt vmcnt(54)
v_perm_b32 v72, v57, v56, s52
v_accvgpr_write_b32 a176, v72
v_perm_b32 v73, v57, v56, s53
v_accvgpr_write_b32 a180, v73
s_waitcnt vmcnt(52)
v_perm_b32 v72, v59, v58, s52
v_accvgpr_write_b32 a177, v72
v_perm_b32 v73, v59, v58, s53
v_accvgpr_write_b32 a181, v73
s_waitcnt vmcnt(50)
v_perm_b32 v72, v61, v60, s52
v_accvgpr_write_b32 a178, v72
v_perm_b32 v73, v61, v60, s53
v_accvgpr_write_b32 a182, v73
s_waitcnt vmcnt(48)
v_perm_b32 v72, v63, v62, s52
v_accvgpr_write_b32 a179, v72
v_perm_b32 v73, v63, v62, s53
v_accvgpr_write_b32 a183, v73
s_add_u32 s54, s56, 950272
buffer_load_dword v56, v1, s[40:43], s54 offen
buffer_load_dword v57, v2, s[40:43], s54 offen
s_add_u32 s54, s56, 952320
buffer_load_dword v58, v1, s[40:43], s54 offen
buffer_load_dword v59, v2, s[40:43], s54 offen
s_add_u32 s54, s56, 954368
buffer_load_dword v60, v1, s[40:43], s54 offen
buffer_load_dword v61, v2, s[40:43], s54 offen
s_add_u32 s54, s56, 956416
buffer_load_dword v62, v1, s[40:43], s54 offen
buffer_load_dword v63, v2, s[40:43], s54 offen
s_waitcnt vmcnt(54)
v_perm_b32 v72, v65, v64, s52
v_accvgpr_write_b32 a184, v72
v_perm_b32 v73, v65, v64, s53
v_accvgpr_write_b32 a188, v73
s_waitcnt vmcnt(52)
v_perm_b32 v72, v67, v66, s52
v_accvgpr_write_b32 a185, v72
v_perm_b32 v73, v67, v66, s53
v_accvgpr_write_b32 a189, v73
s_waitcnt vmcnt(50)
v_perm_b32 v72, v69, v68, s52
v_accvgpr_write_b32 a186, v72
v_perm_b32 v73, v69, v68, s53
v_accvgpr_write_b32 a190, v73
s_waitcnt vmcnt(48)
v_perm_b32 v72, v71, v70, s52
v_accvgpr_write_b32 a187, v72
v_perm_b32 v73, v71, v70, s53
v_accvgpr_write_b32 a191, v73
s_add_u32 s54, s56, 983040
buffer_load_dword v64, v1, s[40:43], s54 offen
buffer_load_dword v65, v2, s[40:43], s54 offen
s_add_u32 s54, s56, 985088
buffer_load_dword v66, v1, s[40:43], s54 offen
buffer_load_dword v67, v2, s[40:43], s54 offen
s_add_u32 s54, s56, 987136
buffer_load_dword v68, v1, s[40:43], s54 offen
buffer_load_dword v69, v2, s[40:43], s54 offen
s_add_u32 s54, s56, 989184
buffer_load_dword v70, v1, s[40:43], s54 offen
buffer_load_dword v71, v2, s[40:43], s54 offen
s_waitcnt vmcnt(54)
v_perm_b32 v72, v17, v16, s52
v_accvgpr_write_b32 a192, v72
v_perm_b32 v73, v17, v16, s53
v_accvgpr_write_b32 a196, v73
s_waitcnt vmcnt(52)
v_perm_b32 v72, v19, v18, s52
v_accvgpr_write_b32 a193, v72
v_perm_b32 v73, v19, v18, s53
v_accvgpr_write_b32 a197, v73
s_waitcnt vmcnt(50)
v_perm_b32 v72, v21, v20, s52
v_accvgpr_write_b32 a194, v72
v_perm_b32 v73, v21, v20, s53
v_accvgpr_write_b32 a198, v73
s_waitcnt vmcnt(48)
v_perm_b32 v72, v23, v22, s52
v_accvgpr_write_b32 a195, v72
v_perm_b32 v73, v23, v22, s53
v_accvgpr_write_b32 a199, v73
s_add_u32 s54, s56, 1015808
buffer_load_dword v16, v1, s[40:43], s54 offen
buffer_load_dword v17, v2, s[40:43], s54 offen
s_add_u32 s54, s56, 1017856
buffer_load_dword v18, v1, s[40:43], s54 offen
buffer_load_dword v19, v2, s[40:43], s54 offen
s_add_u32 s54, s56, 1019904
buffer_load_dword v20, v1, s[40:43], s54 offen
buffer_load_dword v21, v2, s[40:43], s54 offen
s_add_u32 s54, s56, 1021952
buffer_load_dword v22, v1, s[40:43], s54 offen
buffer_load_dword v23, v2, s[40:43], s54 offen
s_waitcnt vmcnt(54)
v_perm_b32 v72, v25, v24, s52
v_accvgpr_write_b32 a200, v72
v_perm_b32 v73, v25, v24, s53
v_accvgpr_write_b32 a204, v73
s_waitcnt vmcnt(52)
v_perm_b32 v72, v27, v26, s52
v_accvgpr_write_b32 a201, v72
v_perm_b32 v73, v27, v26, s53
v_accvgpr_write_b32 a205, v73
s_waitcnt vmcnt(50)
v_perm_b32 v72, v29, v28, s52
v_accvgpr_write_b32 a202, v72
v_perm_b32 v73, v29, v28, s53
v_accvgpr_write_b32 a206, v73
s_waitcnt vmcnt(48)
v_perm_b32 v72, v31, v30, s52
v_accvgpr_write_b32 a203, v72
v_perm_b32 v73, v31, v30, s53
v_accvgpr_write_b32 a207, v73
s_waitcnt vmcnt(46)
v_perm_b32 v72, v33, v32, s52
v_accvgpr_write_b32 a208, v72
v_perm_b32 v73, v33, v32, s53
v_accvgpr_write_b32 a212, v73
s_waitcnt vmcnt(44)
v_perm_b32 v72, v35, v34, s52
v_accvgpr_write_b32 a209, v72
v_perm_b32 v73, v35, v34, s53
v_accvgpr_write_b32 a213, v73
s_waitcnt vmcnt(42)
v_perm_b32 v72, v37, v36, s52
v_accvgpr_write_b32 a210, v72
v_perm_b32 v73, v37, v36, s53
v_accvgpr_write_b32 a214, v73
s_waitcnt vmcnt(40)
v_perm_b32 v72, v39, v38, s52
v_accvgpr_write_b32 a211, v72
v_perm_b32 v73, v39, v38, s53
v_accvgpr_write_b32 a215, v73
s_waitcnt vmcnt(38)
v_perm_b32 v72, v41, v40, s52
v_accvgpr_write_b32 a216, v72
v_perm_b32 v73, v41, v40, s53
v_accvgpr_write_b32 a220, v73
s_waitcnt vmcnt(36)
v_perm_b32 v72, v43, v42, s52
v_accvgpr_write_b32 a217, v72
v_perm_b32 v73, v43, v42, s53
v_accvgpr_write_b32 a221, v73
s_waitcnt vmcnt(34)
v_perm_b32 v72, v45, v44, s52
v_accvgpr_write_b32 a218, v72
v_perm_b32 v73, v45, v44, s53
v_accvgpr_write_b32 a222, v73
s_waitcnt vmcnt(32)
v_perm_b32 v72, v47, v46, s52
v_accvgpr_write_b32 a219, v72
v_perm_b32 v73, v47, v46, s53
v_accvgpr_write_b32 a223, v73
s_waitcnt vmcnt(30)
v_perm_b32 v72, v49, v48, s52
v_accvgpr_write_b32 a224, v72
v_perm_b32 v73, v49, v48, s53
v_accvgpr_write_b32 a228, v73
s_waitcnt vmcnt(28)
v_perm_b32 v72, v51, v50, s52
v_accvgpr_write_b32 a225, v72
v_perm_b32 v73, v51, v50, s53
v_accvgpr_write_b32 a229, v73
s_waitcnt vmcnt(26)
v_perm_b32 v72, v53, v52, s52
v_accvgpr_write_b32 a226, v72
v_perm_b32 v73, v53, v52, s53
v_accvgpr_write_b32 a230, v73
s_waitcnt vmcnt(24)
v_perm_b32 v72, v55, v54, s52
v_accvgpr_write_b32 a227, v72
v_perm_b32 v73, v55, v54, s53
v_accvgpr_write_b32 a231, v73
s_waitcnt vmcnt(22)
v_perm_b32 v72, v57, v56, s52
v_accvgpr_write_b32 a232, v72
v_perm_b32 v73, v57, v56, s53
v_accvgpr_write_b32 a236, v73
s_waitcnt vmcnt(20)
v_perm_b32 v72, v59, v58, s52
v_accvgpr_write_b32 a233, v72
v_perm_b32 v73, v59, v58, s53
v_accvgpr_write_b32 a237, v73
s_waitcnt vmcnt(18)
v_perm_b32 v72, v61, v60, s52
v_accvgpr_write_b32 a234, v72
v_perm_b32 v73, v61, v60, s53
v_accvgpr_write_b32 a238, v73
s_waitcnt vmcnt(16)
v_perm_b32 v72, v63, v62, s52
v_accvgpr_write_b32 a235, v72
v_perm_b32 v73, v63, v62, s53
v_accvgpr_write_b32 a239, v73
s_waitcnt vmcnt(14)
v_perm_b32 v72, v65, v64, s52
v_accvgpr_write_b32 a240, v72
v_perm_b32 v73, v65, v64, s53
v_accvgpr_write_b32 a244, v73
s_waitcnt vmcnt(12)
v_perm_b32 v72, v67, v66, s52
v_accvgpr_write_b32 a241, v72
v_perm_b32 v73, v67, v66, s53
v_accvgpr_write_b32 a245, v73
s_waitcnt vmcnt(10)
v_perm_b32 v72, v69, v68, s52
v_accvgpr_write_b32 a242, v72
v_perm_b32 v73, v69, v68, s53
v_accvgpr_write_b32 a246, v73
s_waitcnt vmcnt(8)
v_perm_b32 v72, v71, v70, s52
v_accvgpr_write_b32 a243, v72
v_perm_b32 v73, v71, v70, s53
v_accvgpr_write_b32 a247, v73
s_waitcnt vmcnt(6)
v_perm_b32 v72, v17, v16, s52
v_accvgpr_write_b32 a248, v72
v_perm_b32 v73, v17, v16, s53
v_accvgpr_write_b32 a252, v73
s_waitcnt vmcnt(4)
v_perm_b32 v72, v19, v18, s52
v_accvgpr_write_b32 a249, v72
v_perm_b32 v73, v19, v18, s53
v_accvgpr_write_b32 a253, v73
s_waitcnt vmcnt(2)
v_perm_b32 v72, v21, v20, s52
v_accvgpr_write_b32 a250, v72
v_perm_b32 v73, v21, v20, s53
v_accvgpr_write_b32 a254, v73
s_waitcnt vmcnt(0)
v_perm_b32 v72, v23, v22, s52
v_accvgpr_write_b32 a251, v72
v_perm_b32 v73, v23, v22, s53
v_accvgpr_write_b32 a255, v73
s_lshl_b32 s54, s66, 2
s_add_u32 s54, s54, s32
s_mul_i32 s54, s54, 88064
s_add_u32 s54, s54, 92274688
v_lshlrev_b32 v1, 4, v0
buffer_store_dwordx4 v[168:171], v1, s[36:39], s54 offen offset:0 sc1
buffer_store_dwordx4 v[172:175], v1, s[36:39], s54 offen offset:1024 sc1
buffer_store_dwordx4 v[176:179], v1, s[36:39], s54 offen offset:2048 sc1
buffer_store_dwordx4 v[180:183], v1, s[36:39], s54 offen offset:3072 sc1
s_add_u32 s54, s54, 4096
buffer_store_dwordx4 v[184:187], v1, s[36:39], s54 offen offset:0 sc1
buffer_store_dwordx4 v[188:191], v1, s[36:39], s54 offen offset:1024 sc1
buffer_store_dwordx4 v[192:195], v1, s[36:39], s54 offen offset:2048 sc1
buffer_store_dwordx4 v[196:199], v1, s[36:39], s54 offen offset:3072 sc1
s_add_u32 s54, s54, 4096
buffer_store_dwordx4 v[200:203], v1, s[36:39], s54 offen offset:0 sc1
buffer_store_dwordx4 v[204:207], v1, s[36:39], s54 offen offset:1024 sc1
buffer_store_dwordx4 v[208:211], v1, s[36:39], s54 offen offset:2048 sc1
buffer_store_dwordx4 v[212:215], v1, s[36:39], s54 offen offset:3072 sc1
s_add_u32 s54, s54, 4096
buffer_store_dwordx4 v[216:219], v1, s[36:39], s54 offen offset:0 sc1
buffer_store_dwordx4 v[220:223], v1, s[36:39], s54 offen offset:1024 sc1
buffer_store_dwordx4 v[224:227], v1, s[36:39], s54 offen offset:2048 sc1
buffer_store_dwordx4 v[228:231], v1, s[36:39], s54 offen offset:3072 sc1
s_add_u32 s54, s54, 4096
buffer_store_dwordx4 v[232:235], v1, s[36:39], s54 offen offset:0 sc1
buffer_store_dwordx4 v[236:239], v1, s[36:39], s54 offen offset:1024 sc1
buffer_store_dwordx4 v[240:243], v1, s[36:39], s54 offen offset:2048 sc1
buffer_store_dwordx4 v[244:247], v1, s[36:39], s54 offen offset:3072 sc1
s_add_u32 s54, s54, 4096
buffer_store_dwordx4 v[248:251], v1, s[36:39], s54 offen offset:0 sc1
buffer_store_dwordx4 v[252:255], v1, s[36:39], s54 offen offset:1024 sc1
buffer_store_dwordx4 a[0:3], v1, s[36:39], s54 offen offset:2048 sc1
buffer_store_dwordx4 a[4:7], v1, s[36:39], s54 offen offset:3072 sc1
s_add_u32 s54, s54, 4096
buffer_store_dwordx4 a[8:11], v1, s[36:39], s54 offen offset:0 sc1
buffer_store_dwordx4 a[12:15], v1, s[36:39], s54 offen offset:1024 sc1
buffer_store_dwordx4 a[16:19], v1, s[36:39], s54 offen offset:2048 sc1
buffer_store_dwordx4 a[20:23], v1, s[36:39], s54 offen offset:3072 sc1
s_add_u32 s54, s54, 4096
buffer_store_dwordx4 a[24:27], v1, s[36:39], s54 offen offset:0 sc1
buffer_store_dwordx4 a[28:31], v1, s[36:39], s54 offen offset:1024 sc1
buffer_store_dwordx4 a[32:35], v1, s[36:39], s54 offen offset:2048 sc1
buffer_store_dwordx4 a[36:39], v1, s[36:39], s54 offen offset:3072 sc1
s_add_u32 s54, s54, 4096
buffer_store_dwordx4 a[40:43], v1, s[36:39], s54 offen offset:0 sc1
buffer_store_dwordx4 a[44:47], v1, s[36:39], s54 offen offset:1024 sc1
buffer_store_dwordx4 a[48:51], v1, s[36:39], s54 offen offset:2048 sc1
buffer_store_dwordx4 a[52:55], v1, s[36:39], s54 offen offset:3072 sc1
s_add_u32 s54, s54, 4096
buffer_store_dwordx4 a[56:59], v1, s[36:39], s54 offen offset:0 sc1
buffer_store_dwordx4 a[60:63], v1, s[36:39], s54 offen offset:1024 sc1
buffer_store_dwordx4 a[64:67], v1, s[36:39], s54 offen offset:2048 sc1
buffer_store_dwordx4 a[68:71], v1, s[36:39], s54 offen offset:3072 sc1
s_add_u32 s54, s54, 4096
s_waitcnt vmcnt(36)
buffer_store_dwordx4 a[72:75], v1, s[36:39], s54 offen offset:0 sc1
buffer_store_dwordx4 a[76:79], v1, s[36:39], s54 offen offset:1024 sc1
buffer_store_dwordx4 a[80:83], v1, s[36:39], s54 offen offset:2048 sc1
buffer_store_dwordx4 a[84:87], v1, s[36:39], s54 offen offset:3072 sc1
s_add_u32 s54, s54, 4096
s_waitcnt vmcnt(36)
buffer_store_dwordx4 a[88:91], v1, s[36:39], s54 offen offset:0 sc1
buffer_store_dwordx4 a[92:95], v1, s[36:39], s54 offen offset:1024 sc1
buffer_store_dwordx4 a[96:99], v1, s[36:39], s54 offen offset:2048 sc1
buffer_store_dwordx4 a[100:103], v1, s[36:39], s54 offen offset:3072 sc1
s_add_u32 s54, s54, 4096
s_waitcnt vmcnt(36)
buffer_store_dwordx4 a[104:107], v1, s[36:39], s54 offen offset:0 sc1
buffer_store_dwordx4 a[108:111], v1, s[36:39], s54 offen offset:1024 sc1
buffer_store_dwordx4 a[112:115], v1, s[36:39], s54 offen offset:2048 sc1
buffer_store_dwordx4 a[116:119], v1, s[36:39], s54 offen offset:3072 sc1
s_add_u32 s54, s54, 4096
s_waitcnt vmcnt(36)
buffer_store_dwordx4 a[120:123], v1, s[36:39], s54 offen offset:0 sc1
buffer_store_dwordx4 a[124:127], v1, s[36:39], s54 offen offset:1024 sc1
buffer_store_dwordx4 a[128:131], v1, s[36:39], s54 offen offset:2048 sc1
buffer_store_dwordx4 a[132:135], v1, s[36:39], s54 offen offset:3072 sc1
s_add_u32 s54, s54, 4096
s_waitcnt vmcnt(36)
buffer_store_dwordx4 a[136:139], v1, s[36:39], s54 offen offset:0 sc1
buffer_store_dwordx4 a[140:143], v1, s[36:39], s54 offen offset:1024 sc1
buffer_store_dwordx4 a[144:147], v1, s[36:39], s54 offen offset:2048 sc1
buffer_store_dwordx4 a[148:151], v1, s[36:39], s54 offen offset:3072 sc1
s_add_u32 s54, s54, 4096
s_waitcnt vmcnt(36)
buffer_store_dwordx4 a[152:155], v1, s[36:39], s54 offen offset:0 sc1
buffer_store_dwordx4 a[156:159], v1, s[36:39], s54 offen offset:1024 sc1
buffer_store_dwordx4 a[160:163], v1, s[36:39], s54 offen offset:2048 sc1
buffer_store_dwordx4 a[164:167], v1, s[36:39], s54 offen offset:3072 sc1
s_add_u32 s54, s54, 4096
s_waitcnt vmcnt(36)
buffer_store_dwordx4 a[168:171], v1, s[36:39], s54 offen offset:0 sc1
buffer_store_dwordx4 a[172:175], v1, s[36:39], s54 offen offset:1024 sc1
buffer_store_dwordx4 a[176:179], v1, s[36:39], s54 offen offset:2048 sc1
buffer_store_dwordx4 a[180:183], v1, s[36:39], s54 offen offset:3072 sc1
s_add_u32 s54, s54, 4096
s_waitcnt vmcnt(36)
buffer_store_dwordx4 a[184:187], v1, s[36:39], s54 offen offset:0 sc1
buffer_store_dwordx4 a[188:191], v1, s[36:39], s54 offen offset:1024 sc1
buffer_store_dwordx4 a[192:195], v1, s[36:39], s54 offen offset:2048 sc1
buffer_store_dwordx4 a[196:199], v1, s[36:39], s54 offen offset:3072 sc1
s_add_u32 s54, s54, 4096
s_waitcnt vmcnt(36)
buffer_store_dwordx4 a[200:203], v1, s[36:39], s54 offen offset:0 sc1
buffer_store_dwordx4 a[204:207], v1, s[36:39], s54 offen offset:1024 sc1
buffer_store_dwordx4 a[208:211], v1, s[36:39], s54 offen offset:2048 sc1
buffer_store_dwordx4 a[212:215], v1, s[36:39], s54 offen offset:3072 sc1
s_add_u32 s54, s54, 4096
s_waitcnt vmcnt(36)
buffer_store_dwordx4 a[216:219], v1, s[36:39], s54 offen offset:0 sc1
buffer_store_dwordx4 a[220:223], v1, s[36:39], s54 offen offset:1024 sc1
buffer_store_dwordx4 a[224:227], v1, s[36:39], s54 offen offset:2048 sc1
buffer_store_dwordx4 a[228:231], v1, s[36:39], s54 offen offset:3072 sc1
s_add_u32 s54, s54, 4096
s_waitcnt vmcnt(36)
buffer_store_dwordx4 a[232:235], v1, s[36:39], s54 offen offset:0 sc1
buffer_store_dwordx4 a[236:239], v1, s[36:39], s54 offen offset:1024 sc1
buffer_store_dwordx4 a[240:243], v1, s[36:39], s54 offen offset:2048 sc1
buffer_store_dwordx4 a[244:247], v1, s[36:39], s54 offen offset:3072 sc1
s_add_u32 s54, s54, 4096
s_waitcnt vmcnt(36)
buffer_store_dwordx4 a[248:251], v1, s[36:39], s54 offen offset:0 sc1
buffer_store_dwordx4 a[252:255], v1, s[36:39], s54 offen offset:1024 sc1
s_waitcnt vmcnt(0)
s_branch L_side4
L_side3:
s_mov_b32 s40, s20
s_and_b32 s41, s21, 0xffff
s_mov_b32 s42, 0x158000
s_mov_b32 s43, 0x20000
s_mov_b32 s44, s22
s_and_b32 s45, s23, 0xffff
s_mov_b32 s46, 0x158000
s_mov_b32 s47, 0x20000
s_lshl_b32 s54, s34, 8
v_lshrrev_b32 v3, 4, v0
v_and_b32 v4, 15, v0
v_mul_u32_u24 v5, 2752, v3
v_lshlrev_b32 v2, 4, v4
s_mul_i32 s55, s32, 44032
s_add_u32 s54, s54, s55
v_add3_u32 v1, v5, v2, s54
v_xor_b32 v2, 64, v2
v_add3_u32 v2, v5, v2, s54
v_lshlrev_b32 v4, 2, v4
s_lshl_b32 s54, s32, 6
v_add_u32 v4, s54, v4
v_and_b32 v5, 1, v3
v_lshlrev_b32 v5, 6, v5
v_xor_b32 v4, v4, v5
v_lshlrev_b32 v3, 11, v3
v_add_u32 v3, v3, v4
v_add_u32 v4, 0x10000, v3
s_lshl_b32 s56, s32, 12
s_barrier
s_add_u32 m0, s56, 0
s_mov_b32 s54, 0
buffer_load_dwordx4 v1, s[40:43], s54 offen offset:0 lds
s_mov_b32 s54, 9984
buffer_load_dwordx4 v1, s[40:43], s54 offen offset:1024 lds
s_mov_b32 s54, 19968
buffer_load_dwordx4 v2, s[40:43], s54 offen offset:2048 lds
s_mov_b32 s54, 29952
buffer_load_dwordx4 v2, s[40:43], s54 offen offset:3072 lds
s_add_u32 m0, s56, 16384
s_mov_b32 s54, 176128
buffer_load_dwordx4 v1, s[40:43], s54 offen offset:0 lds
s_mov_b32 s54, 186112
buffer_load_dwordx4 v1, s[40:43], s54 offen offset:1024 lds
s_mov_b32 s54, 196096
buffer_load_dwordx4 v2, s[40:43], s54 offen offset:2048 lds
s_mov_b32 s54, 206080
buffer_load_dwordx4 v2, s[40:43], s54 offen offset:3072 lds
s_add_u32 m0, s56, 32768
s_mov_b32 s54, 352256
buffer_load_dwordx4 v1, s[40:43], s54 offen offset:0 lds
s_mov_b32 s54, 362240
buffer_load_dwordx4 v1, s[40:43], s54 offen offset:1024 lds
s_mov_b32 s54, 372224
buffer_load_dwordx4 v2, s[40:43], s54 offen offset:2048 lds
s_mov_b32 s54, 382208
buffer_load_dwordx4 v2, s[40:43], s54 offen offset:3072 lds
s_add_u32 m0, s56, 49152
s_mov_b32 s54, 528384
buffer_load_dwordx4 v1, s[40:43], s54 offen offset:0 lds
s_mov_b32 s54, 538368
buffer_load_dwordx4 v1, s[40:43], s54 offen offset:1024 lds
s_mov_b32 s54, 548352
buffer_load_dwordx4 v2, s[40:43], s54 offen offset:2048 lds
s_mov_b32 s54, 558336
buffer_load_dwordx4 v2, s[40:43], s54 offen offset:3072 lds
s_add_u32 m0, s56, 65536
s_mov_b32 s54, 704512
buffer_load_dwordx4 v1, s[40:43], s54 offen offset:0 lds
s_mov_b32 s54, 714496
buffer_load_dwordx4 v1, s[40:43], s54 offen offset:1024 lds
s_mov_b32 s54, 724480
buffer_load_dwordx4 v2, s[40:43], s54 offen offset:2048 lds
s_mov_b32 s54, 734464
buffer_load_dwordx4 v2, s[40:43], s54 offen offset:3072 lds
s_add_u32 m0, s56, 81920
s_mov_b32 s54, 880640
buffer_load_dwordx4 v1, s[40:43], s54 offen offset:0 lds
s_mov_b32 s54, 890624
buffer_load_dwordx4 v1, s[40:43], s54 offen offset:1024 lds
s_mov_b32 s54, 900608
buffer_load_dwordx4 v2, s[40:43], s54 offen offset:2048 lds
s_mov_b32 s54, 910592
buffer_load_dwordx4 v2, s[40:43], s54 offen offset:3072 lds
s_add_u32 m0, s56, 98304
s_mov_b32 s54, 1056768
buffer_load_dwordx4 v1, s[40:43], s54 offen offset:0 lds
s_mov_b32 s54, 1066752
buffer_load_dwordx4 v1, s[40:43], s54 offen offset:1024 lds
s_mov_b32 s54, 1076736
buffer_load_dwordx4 v2, s[40:43], s54 offen offset:2048 lds
s_mov_b32 s54, 1086720
buffer_load_dwordx4 v2, s[40:43], s54 offen offset:3072 lds
s_waitcnt vmcnt(24)
s_barrier
s_add_u32 m0, s56, 114688
s_mov_b32 s54, 1232896
buffer_load_dwordx4 v1, s[40:43], s54 offen offset:0 lds
s_mov_b32 s54, 1242880
buffer_load_dwordx4 v1, s[40:43], s54 offen offset:1024 lds
s_mov_b32 s54, 1252864
buffer_load_dwordx4 v2, s[40:43], s54 offen offset:2048 lds
s_mov_b32 s54, 1262848
buffer_load_dwordx4 v2, s[40:43], s54 offen offset:3072 lds
ds_read2st64_b32 v[16:17], v3 offset0:0 offset1:1
ds_read2st64_b32 v[18:19], v3 offset0:2 offset1:3
ds_read2st64_b32 v[20:21], v3 offset0:4 offset1:5
ds_read2st64_b32 v[22:23], v3 offset0:6 offset1:7
ds_read2st64_b32 v[24:25], v3 offset0:32 offset1:33
ds_read2st64_b32 v[26:27], v3 offset0:34 offset1:35
ds_read2st64_b32 v[28:29], v3 offset0:36 offset1:37
ds_read2st64_b32 v[30:31], v3 offset0:38 offset1:39
s_waitcnt lgkmcnt(7)
v_perm_b32 v48, v17, v16, s52
v_accvgpr_write_b32 a0, v48
v_perm_b32 v49, v17, v16, s53
v_accvgpr_write_b32 a4, v49
s_waitcnt lgkmcnt(6)
v_perm_b32 v48, v19, v18, s52
v_accvgpr_write_b32 a1, v48
v_perm_b32 v49, v19, v18, s53
v_accvgpr_write_b32 a5, v49
s_waitcnt lgkmcnt(5)
v_perm_b32 v48, v21, v20, s52
v_accvgpr_write_b32 a2, v48
v_perm_b32 v49, v21, v20, s53
v_accvgpr_write_b32 a6, v49
s_waitcnt lgkmcnt(4)
v_perm_b32 v48, v23, v22, s52
v_accvgpr_write_b32 a3, v48
v_perm_b32 v49, v23, v22, s53
v_accvgpr_write_b32 a7, v49
s_waitcnt lgkmcnt(3)
v_perm_b32 v48, v25, v24, s52
v_accvgpr_write_b32 a8, v48
v_perm_b32 v49, v25, v24, s53
v_accvgpr_write_b32 a12, v49
s_waitcnt lgkmcnt(2)
v_perm_b32 v48, v27, v26, s52
v_accvgpr_write_b32 a9, v48
v_perm_b32 v49, v27, v26, s53
v_accvgpr_write_b32 a13, v49
s_waitcnt lgkmcnt(1)
v_perm_b32 v48, v29, v28, s52
v_accvgpr_write_b32 a10, v48
v_perm_b32 v49, v29, v28, s53
v_accvgpr_write_b32 a14, v49
s_waitcnt lgkmcnt(0)
v_perm_b32 v48, v31, v30, s52
v_accvgpr_write_b32 a11, v48
v_perm_b32 v49, v31, v30, s53
v_accvgpr_write_b32 a15, v49
s_waitcnt vmcnt(24)
s_barrier
s_add_u32 m0, s56, 0
s_mov_b32 s54, 0
buffer_load_dwordx4 v1, s[44:47], s54 offen offset:0 lds
s_mov_b32 s54, 9984
buffer_load_dwordx4 v1, s[44:47], s54 offen offset:1024 lds
s_mov_b32 s54, 19968
buffer_load_dwordx4 v2, s[44:47], s54 offen offset:2048 lds
s_mov_b32 s54, 29952
buffer_load_dwordx4 v2, s[44:47], s54 offen offset:3072 lds
ds_read2st64_b32 v[32:33], v3 offset0:64 offset1:65
ds_read2st64_b32 v[34:35], v3 offset0:66 offset1:67
ds_read2st64_b32 v[36:37], v3 offset0:68 offset1:69
ds_read2st64_b32 v[38:39], v3 offset0:70 offset1:71
ds_read2st64_b32 v[40:41], v3 offset0:96 offset1:97
ds_read2st64_b32 v[42:43], v3 offset0:98 offset1:99
ds_read2st64_b32 v[44:45], v3 offset0:100 offset1:101
ds_read2st64_b32 v[46:47], v3 offset0:102 offset1:103
s_waitcnt lgkmcnt(7)
v_perm_b32 v48, v33, v32, s52
v_accvgpr_write_b32 a16, v48
v_perm_b32 v49, v33, v32, s53
v_accvgpr_write_b32 a20, v49
s_waitcnt lgkmcnt(6)
v_perm_b32 v48, v35, v34, s52
v_accvgpr_write_b32 a17, v48
v_perm_b32 v49, v35, v34, s53
v_accvgpr_write_b32 a21, v49
s_waitcnt lgkmcnt(5)
v_perm_b32 v48, v37, v36, s52
v_accvgpr_write_b32 a18, v48
v_perm_b32 v49, v37, v36, s53
v_accvgpr_write_b32 a22, v49
s_waitcnt lgkmcnt(4)
v_perm_b32 v48, v39, v38, s52
v_accvgpr_write_b32 a19, v48
v_perm_b32 v49, v39, v38, s53
v_accvgpr_write_b32 a23, v49
s_waitcnt lgkmcnt(3)
v_perm_b32 v48, v41, v40, s52
v_accvgpr_write_b32 a24, v48
v_perm_b32 v49, v41, v40, s53
v_accvgpr_write_b32 a28, v49
s_waitcnt lgkmcnt(2)
v_perm_b32 v48, v43, v42, s52
v_accvgpr_write_b32 a25, v48
v_perm_b32 v49, v43, v42, s53
v_accvgpr_write_b32 a29, v49
s_waitcnt lgkmcnt(1)
v_perm_b32 v48, v45, v44, s52
v_accvgpr_write_b32 a26, v48
v_perm_b32 v49, v45, v44, s53
v_accvgpr_write_b32 a30, v49
s_waitcnt lgkmcnt(0)
v_perm_b32 v48, v47, v46, s52
v_accvgpr_write_b32 a27, v48
v_perm_b32 v49, v47, v46, s53
v_accvgpr_write_b32 a31, v49
s_waitcnt vmcnt(24)
s_barrier
s_add_u32 m0, s56, 16384
s_mov_b32 s54, 176128
buffer_load_dwordx4 v1, s[44:47], s54 offen offset:0 lds
s_mov_b32 s54, 186112
buffer_load_dwordx4 v1, s[44:47], s54 offen offset:1024 lds
s_mov_b32 s54, 196096
buffer_load_dwordx4 v2, s[44:47], s54 offen offset:2048 lds
s_mov_b32 s54, 206080
buffer_load_dwordx4 v2, s[44:47], s54 offen offset:3072 lds
ds_read2st64_b32 v[16:17], v3 offset0:128 offset1:129
ds_read2st64_b32 v[18:19], v3 offset0:130 offset1:131
ds_read2st64_b32 v[20:21], v3 offset0:132 offset1:133
ds_read2st64_b32 v[22:23], v3 offset0:134 offset1:135
ds_read2st64_b32 v[24:25], v3 offset0:160 offset1:161
ds_read2st64_b32 v[26:27], v3 offset0:162 offset1:163
ds_read2st64_b32 v[28:29], v3 offset0:164 offset1:165
ds_read2st64_b32 v[30:31], v3 offset0:166 offset1:167
s_waitcnt lgkmcnt(7)
v_perm_b32 v48, v17, v16, s52
v_accvgpr_write_b32 a32, v48
v_perm_b32 v49, v17, v16, s53
v_accvgpr_write_b32 a36, v49
s_waitcnt lgkmcnt(6)
v_perm_b32 v48, v19, v18, s52
v_accvgpr_write_b32 a33, v48
v_perm_b32 v49, v19, v18, s53
v_accvgpr_write_b32 a37, v49
s_waitcnt lgkmcnt(5)
v_perm_b32 v48, v21, v20, s52
v_accvgpr_write_b32 a34, v48
v_perm_b32 v49, v21, v20, s53
v_accvgpr_write_b32 a38, v49
s_waitcnt lgkmcnt(4)
v_perm_b32 v48, v23, v22, s52
v_accvgpr_write_b32 a35, v48
v_perm_b32 v49, v23, v22, s53
v_accvgpr_write_b32 a39, v49
s_waitcnt lgkmcnt(3)
v_perm_b32 v48, v25, v24, s52
v_accvgpr_write_b32 a40, v48
v_perm_b32 v49, v25, v24, s53
v_accvgpr_write_b32 a44, v49
s_waitcnt lgkmcnt(2)
v_perm_b32 v48, v27, v26, s52
v_accvgpr_write_b32 a41, v48
v_perm_b32 v49, v27, v26, s53
v_accvgpr_write_b32 a45, v49
s_waitcnt lgkmcnt(1)
v_perm_b32 v48, v29, v28, s52
v_accvgpr_write_b32 a42, v48
v_perm_b32 v49, v29, v28, s53
v_accvgpr_write_b32 a46, v49
s_waitcnt lgkmcnt(0)
v_perm_b32 v48, v31, v30, s52
v_accvgpr_write_b32 a43, v48
v_perm_b32 v49, v31, v30, s53
v_accvgpr_write_b32 a47, v49
s_waitcnt vmcnt(24)
s_barrier
s_add_u32 m0, s56, 32768
s_mov_b32 s54, 352256
buffer_load_dwordx4 v1, s[44:47], s54 offen offset:0 lds
s_mov_b32 s54, 362240
buffer_load_dwordx4 v1, s[44:47], s54 offen offset:1024 lds
s_mov_b32 s54, 372224
buffer_load_dwordx4 v2, s[44:47], s54 offen offset:2048 lds
s_mov_b32 s54, 382208
buffer_load_dwordx4 v2, s[44:47], s54 offen offset:3072 lds
ds_read2st64_b32 v[32:33], v3 offset0:192 offset1:193
ds_read2st64_b32 v[34:35], v3 offset0:194 offset1:195
ds_read2st64_b32 v[36:37], v3 offset0:196 offset1:197
ds_read2st64_b32 v[38:39], v3 offset0:198 offset1:199
ds_read2st64_b32 v[40:41], v3 offset0:224 offset1:225
ds_read2st64_b32 v[42:43], v3 offset0:226 offset1:227
ds_read2st64_b32 v[44:45], v3 offset0:228 offset1:229
ds_read2st64_b32 v[46:47], v3 offset0:230 offset1:231
s_waitcnt lgkmcnt(7)
v_perm_b32 v48, v33, v32, s52
v_accvgpr_write_b32 a48, v48
v_perm_b32 v49, v33, v32, s53
v_accvgpr_write_b32 a52, v49
s_waitcnt lgkmcnt(6)
v_perm_b32 v48, v35, v34, s52
v_accvgpr_write_b32 a49, v48
v_perm_b32 v49, v35, v34, s53
v_accvgpr_write_b32 a53, v49
s_waitcnt lgkmcnt(5)
v_perm_b32 v48, v37, v36, s52
v_accvgpr_write_b32 a50, v48
v_perm_b32 v49, v37, v36, s53
v_accvgpr_write_b32 a54, v49
s_waitcnt lgkmcnt(4)
v_perm_b32 v48, v39, v38, s52
v_accvgpr_write_b32 a51, v48
v_perm_b32 v49, v39, v38, s53
v_accvgpr_write_b32 a55, v49
s_waitcnt lgkmcnt(3)
v_perm_b32 v48, v41, v40, s52
v_accvgpr_write_b32 a56, v48
v_perm_b32 v49, v41, v40, s53
v_accvgpr_write_b32 a60, v49
s_waitcnt lgkmcnt(2)
v_perm_b32 v48, v43, v42, s52
v_accvgpr_write_b32 a57, v48
v_perm_b32 v49, v43, v42, s53
v_accvgpr_write_b32 a61, v49
s_waitcnt lgkmcnt(1)
v_perm_b32 v48, v45, v44, s52
v_accvgpr_write_b32 a58, v48
v_perm_b32 v49, v45, v44, s53
v_accvgpr_write_b32 a62, v49
s_waitcnt lgkmcnt(0)
v_perm_b32 v48, v47, v46, s52
v_accvgpr_write_b32 a59, v48
v_perm_b32 v49, v47, v46, s53
v_accvgpr_write_b32 a63, v49
s_waitcnt vmcnt(24)
s_barrier
s_add_u32 m0, s56, 49152
s_mov_b32 s54, 528384
buffer_load_dwordx4 v1, s[44:47], s54 offen offset:0 lds
s_mov_b32 s54, 538368
buffer_load_dwordx4 v1, s[44:47], s54 offen offset:1024 lds
s_mov_b32 s54, 548352
buffer_load_dwordx4 v2, s[44:47], s54 offen offset:2048 lds
s_mov_b32 s54, 558336
buffer_load_dwordx4 v2, s[44:47], s54 offen offset:3072 lds
ds_read2st64_b32 v[16:17], v4 offset0:0 offset1:1
ds_read2st64_b32 v[18:19], v4 offset0:2 offset1:3
ds_read2st64_b32 v[20:21], v4 offset0:4 offset1:5
ds_read2st64_b32 v[22:23], v4 offset0:6 offset1:7
ds_read2st64_b32 v[24:25], v4 offset0:32 offset1:33
ds_read2st64_b32 v[26:27], v4 offset0:34 offset1:35
ds_read2st64_b32 v[28:29], v4 offset0:36 offset1:37
ds_read2st64_b32 v[30:31], v4 offset0:38 offset1:39
s_waitcnt lgkmcnt(7)
v_perm_b32 v48, v17, v16, s52
v_accvgpr_write_b32 a64, v48
v_perm_b32 v49, v17, v16, s53
v_accvgpr_write_b32 a68, v49
s_waitcnt lgkmcnt(6)
v_perm_b32 v48, v19, v18, s52
v_accvgpr_write_b32 a65, v48
v_perm_b32 v49, v19, v18, s53
v_accvgpr_write_b32 a69, v49
s_waitcnt lgkmcnt(5)
v_perm_b32 v48, v21, v20, s52
v_accvgpr_write_b32 a66, v48
v_perm_b32 v49, v21, v20, s53
v_accvgpr_write_b32 a70, v49
s_waitcnt lgkmcnt(4)
v_perm_b32 v48, v23, v22, s52
v_accvgpr_write_b32 a67, v48
v_perm_b32 v49, v23, v22, s53
v_accvgpr_write_b32 a71, v49
s_waitcnt lgkmcnt(3)
v_perm_b32 v48, v25, v24, s52
v_accvgpr_write_b32 a72, v48
v_perm_b32 v49, v25, v24, s53
v_accvgpr_write_b32 a76, v49
s_waitcnt lgkmcnt(2)
v_perm_b32 v48, v27, v26, s52
v_accvgpr_write_b32 a73, v48
v_perm_b32 v49, v27, v26, s53
v_accvgpr_write_b32 a77, v49
s_waitcnt lgkmcnt(1)
v_perm_b32 v48, v29, v28, s52
v_accvgpr_write_b32 a74, v48
v_perm_b32 v49, v29, v28, s53
v_accvgpr_write_b32 a78, v49
s_waitcnt lgkmcnt(0)
v_perm_b32 v48, v31, v30, s52
v_accvgpr_write_b32 a75, v48
v_perm_b32 v49, v31, v30, s53
v_accvgpr_write_b32 a79, v49
s_waitcnt vmcnt(24)
s_barrier
s_add_u32 m0, s56, 65536
s_mov_b32 s54, 704512
buffer_load_dwordx4 v1, s[44:47], s54 offen offset:0 lds
s_mov_b32 s54, 714496
buffer_load_dwordx4 v1, s[44:47], s54 offen offset:1024 lds
s_mov_b32 s54, 724480
buffer_load_dwordx4 v2, s[44:47], s54 offen offset:2048 lds
s_mov_b32 s54, 734464
buffer_load_dwordx4 v2, s[44:47], s54 offen offset:3072 lds
ds_read2st64_b32 v[32:33], v4 offset0:64 offset1:65
ds_read2st64_b32 v[34:35], v4 offset0:66 offset1:67
ds_read2st64_b32 v[36:37], v4 offset0:68 offset1:69
ds_read2st64_b32 v[38:39], v4 offset0:70 offset1:71
ds_read2st64_b32 v[40:41], v4 offset0:96 offset1:97
ds_read2st64_b32 v[42:43], v4 offset0:98 offset1:99
ds_read2st64_b32 v[44:45], v4 offset0:100 offset1:101
ds_read2st64_b32 v[46:47], v4 offset0:102 offset1:103
s_waitcnt lgkmcnt(7)
v_perm_b32 v48, v33, v32, s52
v_accvgpr_write_b32 a80, v48
v_perm_b32 v49, v33, v32, s53
v_accvgpr_write_b32 a84, v49
s_waitcnt lgkmcnt(6)
v_perm_b32 v48, v35, v34, s52
v_accvgpr_write_b32 a81, v48
v_perm_b32 v49, v35, v34, s53
v_accvgpr_write_b32 a85, v49
s_waitcnt lgkmcnt(5)
v_perm_b32 v48, v37, v36, s52
v_accvgpr_write_b32 a82, v48
v_perm_b32 v49, v37, v36, s53
v_accvgpr_write_b32 a86, v49
s_waitcnt lgkmcnt(4)
v_perm_b32 v48, v39, v38, s52
v_accvgpr_write_b32 a83, v48
v_perm_b32 v49, v39, v38, s53
v_accvgpr_write_b32 a87, v49
s_waitcnt lgkmcnt(3)
v_perm_b32 v48, v41, v40, s52
v_accvgpr_write_b32 a88, v48
v_perm_b32 v49, v41, v40, s53
v_accvgpr_write_b32 a92, v49
s_waitcnt lgkmcnt(2)
v_perm_b32 v48, v43, v42, s52
v_accvgpr_write_b32 a89, v48
v_perm_b32 v49, v43, v42, s53
v_accvgpr_write_b32 a93, v49
s_waitcnt lgkmcnt(1)
v_perm_b32 v48, v45, v44, s52
v_accvgpr_write_b32 a90, v48
v_perm_b32 v49, v45, v44, s53
v_accvgpr_write_b32 a94, v49
s_waitcnt lgkmcnt(0)
v_perm_b32 v48, v47, v46, s52
v_accvgpr_write_b32 a91, v48
v_perm_b32 v49, v47, v46, s53
v_accvgpr_write_b32 a95, v49
s_waitcnt vmcnt(24)
s_barrier
s_add_u32 m0, s56, 81920
s_mov_b32 s54, 880640
buffer_load_dwordx4 v1, s[44:47], s54 offen offset:0 lds
s_mov_b32 s54, 890624
buffer_load_dwordx4 v1, s[44:47], s54 offen offset:1024 lds
s_mov_b32 s54, 900608
buffer_load_dwordx4 v2, s[44:47], s54 offen offset:2048 lds
s_mov_b32 s54, 910592
buffer_load_dwordx4 v2, s[44:47], s54 offen offset:3072 lds
ds_read2st64_b32 v[16:17], v4 offset0:128 offset1:129
ds_read2st64_b32 v[18:19], v4 offset0:130 offset1:131
ds_read2st64_b32 v[20:21], v4 offset0:132 offset1:133
ds_read2st64_b32 v[22:23], v4 offset0:134 offset1:135
ds_read2st64_b32 v[24:25], v4 offset0:160 offset1:161
ds_read2st64_b32 v[26:27], v4 offset0:162 offset1:163
ds_read2st64_b32 v[28:29], v4 offset0:164 offset1:165
ds_read2st64_b32 v[30:31], v4 offset0:166 offset1:167
s_waitcnt lgkmcnt(7)
v_perm_b32 v48, v17, v16, s52
v_accvgpr_write_b32 a96, v48
v_perm_b32 v49, v17, v16, s53
v_accvgpr_write_b32 a100, v49
s_waitcnt lgkmcnt(6)
v_perm_b32 v48, v19, v18, s52
v_accvgpr_write_b32 a97, v48
v_perm_b32 v49, v19, v18, s53
v_accvgpr_write_b32 a101, v49
s_waitcnt lgkmcnt(5)
v_perm_b32 v48, v21, v20, s52
v_accvgpr_write_b32 a98, v48
v_perm_b32 v49, v21, v20, s53
v_accvgpr_write_b32 a102, v49
s_waitcnt lgkmcnt(4)
v_perm_b32 v48, v23, v22, s52
v_accvgpr_write_b32 a99, v48
v_perm_b32 v49, v23, v22, s53
v_accvgpr_write_b32 a103, v49
s_waitcnt lgkmcnt(3)
v_perm_b32 v48, v25, v24, s52
v_accvgpr_write_b32 a104, v48
v_perm_b32 v49, v25, v24, s53
v_accvgpr_write_b32 a108, v49
s_waitcnt lgkmcnt(2)
v_perm_b32 v48, v27, v26, s52
v_accvgpr_write_b32 a105, v48
v_perm_b32 v49, v27, v26, s53
v_accvgpr_write_b32 a109, v49
s_waitcnt lgkmcnt(1)
v_perm_b32 v48, v29, v28, s52
v_accvgpr_write_b32 a106, v48
v_perm_b32 v49, v29, v28, s53
v_accvgpr_write_b32 a110, v49
s_waitcnt lgkmcnt(0)
v_perm_b32 v48, v31, v30, s52
v_accvgpr_write_b32 a107, v48
v_perm_b32 v49, v31, v30, s53
v_accvgpr_write_b32 a111, v49
s_waitcnt vmcnt(24)
s_barrier
s_add_u32 m0, s56, 98304
s_mov_b32 s54, 1056768
buffer_load_dwordx4 v1, s[44:47], s54 offen offset:0 lds
s_mov_b32 s54, 1066752
buffer_load_dwordx4 v1, s[44:47], s54 offen offset:1024 lds
s_mov_b32 s54, 1076736
buffer_load_dwordx4 v2, s[44:47], s54 offen offset:2048 lds
s_mov_b32 s54, 1086720
buffer_load_dwordx4 v2, s[44:47], s54 offen offset:3072 lds
ds_read2st64_b32 v[32:33], v4 offset0:192 offset1:193
ds_read2st64_b32 v[34:35], v4 offset0:194 offset1:195
ds_read2st64_b32 v[36:37], v4 offset0:196 offset1:197
ds_read2st64_b32 v[38:39], v4 offset0:198 offset1:199
ds_read2st64_b32 v[40:41], v4 offset0:224 offset1:225
ds_read2st64_b32 v[42:43], v4 offset0:226 offset1:227
ds_read2st64_b32 v[44:45], v4 offset0:228 offset1:229
ds_read2st64_b32 v[46:47], v4 offset0:230 offset1:231
s_waitcnt lgkmcnt(7)
v_perm_b32 v48, v33, v32, s52
v_accvgpr_write_b32 a112, v48
v_perm_b32 v49, v33, v32, s53
v_accvgpr_write_b32 a116, v49
s_waitcnt lgkmcnt(6)
v_perm_b32 v48, v35, v34, s52
v_accvgpr_write_b32 a113, v48
v_perm_b32 v49, v35, v34, s53
v_accvgpr_write_b32 a117, v49
s_waitcnt lgkmcnt(5)
v_perm_b32 v48, v37, v36, s52
v_accvgpr_write_b32 a114, v48
v_perm_b32 v49, v37, v36, s53
v_accvgpr_write_b32 a118, v49
s_waitcnt lgkmcnt(4)
v_perm_b32 v48, v39, v38, s52
v_accvgpr_write_b32 a115, v48
v_perm_b32 v49, v39, v38, s53
v_accvgpr_write_b32 a119, v49
s_waitcnt lgkmcnt(3)
v_perm_b32 v48, v41, v40, s52
v_accvgpr_write_b32 a120, v48
v_perm_b32 v49, v41, v40, s53
v_accvgpr_write_b32 a124, v49
s_waitcnt lgkmcnt(2)
v_perm_b32 v48, v43, v42, s52
v_accvgpr_write_b32 a121, v48
v_perm_b32 v49, v43, v42, s53
v_accvgpr_write_b32 a125, v49
s_waitcnt lgkmcnt(1)
v_perm_b32 v48, v45, v44, s52
v_accvgpr_write_b32 a122, v48
v_perm_b32 v49, v45, v44, s53
v_accvgpr_write_b32 a126, v49
s_waitcnt lgkmcnt(0)
v_perm_b32 v48, v47, v46, s52
v_accvgpr_write_b32 a123, v48
v_perm_b32 v49, v47, v46, s53
v_accvgpr_write_b32 a127, v49
s_waitcnt vmcnt(24)
s_barrier
s_add_u32 m0, s56, 114688
s_mov_b32 s54, 1232896
buffer_load_dwordx4 v1, s[44:47], s54 offen offset:0 lds
s_mov_b32 s54, 1242880
buffer_load_dwordx4 v1, s[44:47], s54 offen offset:1024 lds
s_mov_b32 s54, 1252864
buffer_load_dwordx4 v2, s[44:47], s54 offen offset:2048 lds
s_mov_b32 s54, 1262848
buffer_load_dwordx4 v2, s[44:47], s54 offen offset:3072 lds
ds_read2st64_b32 v[16:17], v3 offset0:0 offset1:1
ds_read2st64_b32 v[18:19], v3 offset0:2 offset1:3
ds_read2st64_b32 v[20:21], v3 offset0:4 offset1:5
ds_read2st64_b32 v[22:23], v3 offset0:6 offset1:7
ds_read2st64_b32 v[24:25], v3 offset0:32 offset1:33
ds_read2st64_b32 v[26:27], v3 offset0:34 offset1:35
ds_read2st64_b32 v[28:29], v3 offset0:36 offset1:37
ds_read2st64_b32 v[30:31], v3 offset0:38 offset1:39
s_waitcnt lgkmcnt(7)
v_perm_b32 v48, v17, v16, s52
v_accvgpr_write_b32 a128, v48
v_perm_b32 v49, v17, v16, s53
v_accvgpr_write_b32 a132, v49
s_waitcnt lgkmcnt(6)
v_perm_b32 v48, v19, v18, s52
v_accvgpr_write_b32 a129, v48
v_perm_b32 v49, v19, v18, s53
v_accvgpr_write_b32 a133, v49
s_waitcnt lgkmcnt(5)
v_perm_b32 v48, v21, v20, s52
v_accvgpr_write_b32 a130, v48
v_perm_b32 v49, v21, v20, s53
v_accvgpr_write_b32 a134, v49
s_waitcnt lgkmcnt(4)
v_perm_b32 v48, v23, v22, s52
v_accvgpr_write_b32 a131, v48
v_perm_b32 v49, v23, v22, s53
v_accvgpr_write_b32 a135, v49
s_waitcnt lgkmcnt(3)
v_perm_b32 v48, v25, v24, s52
v_accvgpr_write_b32 a136, v48
v_perm_b32 v49, v25, v24, s53
v_accvgpr_write_b32 a140, v49
s_waitcnt lgkmcnt(2)
v_perm_b32 v48, v27, v26, s52
v_accvgpr_write_b32 a137, v48
v_perm_b32 v49, v27, v26, s53
v_accvgpr_write_b32 a141, v49
s_waitcnt lgkmcnt(1)
v_perm_b32 v48, v29, v28, s52
v_accvgpr_write_b32 a138, v48
v_perm_b32 v49, v29, v28, s53
v_accvgpr_write_b32 a142, v49
s_waitcnt lgkmcnt(0)
v_perm_b32 v48, v31, v30, s52
v_accvgpr_write_b32 a139, v48
v_perm_b32 v49, v31, v30, s53
v_accvgpr_write_b32 a143, v49
s_waitcnt vmcnt(24)
s_barrier
ds_read2st64_b32 v[32:33], v3 offset0:64 offset1:65
ds_read2st64_b32 v[34:35], v3 offset0:66 offset1:67
ds_read2st64_b32 v[36:37], v3 offset0:68 offset1:69
ds_read2st64_b32 v[38:39], v3 offset0:70 offset1:71
ds_read2st64_b32 v[40:41], v3 offset0:96 offset1:97
ds_read2st64_b32 v[42:43], v3 offset0:98 offset1:99
ds_read2st64_b32 v[44:45], v3 offset0:100 offset1:101
ds_read2st64_b32 v[46:47], v3 offset0:102 offset1:103
s_waitcnt lgkmcnt(7)
v_perm_b32 v48, v33, v32, s52
v_accvgpr_write_b32 a144, v48
v_perm_b32 v49, v33, v32, s53
v_accvgpr_write_b32 a148, v49
s_waitcnt lgkmcnt(6)
v_perm_b32 v48, v35, v34, s52
v_accvgpr_write_b32 a145, v48
v_perm_b32 v49, v35, v34, s53
v_accvgpr_write_b32 a149, v49
s_waitcnt lgkmcnt(5)
v_perm_b32 v48, v37, v36, s52
v_accvgpr_write_b32 a146, v48
v_perm_b32 v49, v37, v36, s53
v_accvgpr_write_b32 a150, v49
s_waitcnt lgkmcnt(4)
v_perm_b32 v48, v39, v38, s52
v_accvgpr_write_b32 a147, v48
v_perm_b32 v49, v39, v38, s53
v_accvgpr_write_b32 a151, v49
s_waitcnt lgkmcnt(3)
v_perm_b32 v48, v41, v40, s52
v_accvgpr_write_b32 a152, v48
v_perm_b32 v49, v41, v40, s53
v_accvgpr_write_b32 a156, v49
s_waitcnt lgkmcnt(2)
v_perm_b32 v48, v43, v42, s52
v_accvgpr_write_b32 a153, v48
v_perm_b32 v49, v43, v42, s53
v_accvgpr_write_b32 a157, v49
s_waitcnt lgkmcnt(1)
v_perm_b32 v48, v45, v44, s52
v_accvgpr_write_b32 a154, v48
v_perm_b32 v49, v45, v44, s53
v_accvgpr_write_b32 a158, v49
s_waitcnt lgkmcnt(0)
v_perm_b32 v48, v47, v46, s52
v_accvgpr_write_b32 a155, v48
v_perm_b32 v49, v47, v46, s53
v_accvgpr_write_b32 a159, v49
s_waitcnt vmcnt(20)
s_barrier
ds_read2st64_b32 v[16:17], v3 offset0:128 offset1:129
ds_read2st64_b32 v[18:19], v3 offset0:130 offset1:131
ds_read2st64_b32 v[20:21], v3 offset0:132 offset1:133
ds_read2st64_b32 v[22:23], v3 offset0:134 offset1:135
ds_read2st64_b32 v[24:25], v3 offset0:160 offset1:161
ds_read2st64_b32 v[26:27], v3 offset0:162 offset1:163
ds_read2st64_b32 v[28:29], v3 offset0:164 offset1:165
ds_read2st64_b32 v[30:31], v3 offset0:166 offset1:167
s_waitcnt lgkmcnt(7)
v_perm_b32 v48, v17, v16, s52
v_accvgpr_write_b32 a160, v48
v_perm_b32 v49, v17, v16, s53
v_accvgpr_write_b32 a164, v49
s_waitcnt lgkmcnt(6)
v_perm_b32 v48, v19, v18, s52
v_accvgpr_write_b32 a161, v48
v_perm_b32 v49, v19, v18, s53
v_accvgpr_write_b32 a165, v49
s_waitcnt lgkmcnt(5)
v_perm_b32 v48, v21, v20, s52
v_accvgpr_write_b32 a162, v48
v_perm_b32 v49, v21, v20, s53
v_accvgpr_write_b32 a166, v49
s_waitcnt lgkmcnt(4)
v_perm_b32 v48, v23, v22, s52
v_accvgpr_write_b32 a163, v48
v_perm_b32 v49, v23, v22, s53
v_accvgpr_write_b32 a167, v49
s_waitcnt lgkmcnt(3)
v_perm_b32 v48, v25, v24, s52
v_accvgpr_write_b32 a168, v48
v_perm_b32 v49, v25, v24, s53
v_accvgpr_write_b32 a172, v49
s_waitcnt lgkmcnt(2)
v_perm_b32 v48, v27, v26, s52
v_accvgpr_write_b32 a169, v48
v_perm_b32 v49, v27, v26, s53
v_accvgpr_write_b32 a173, v49
s_waitcnt lgkmcnt(1)
v_perm_b32 v48, v29, v28, s52
v_accvgpr_write_b32 a170, v48
v_perm_b32 v49, v29, v28, s53
v_accvgpr_write_b32 a174, v49
s_waitcnt lgkmcnt(0)
v_perm_b32 v48, v31, v30, s52
v_accvgpr_write_b32 a171, v48
v_perm_b32 v49, v31, v30, s53
v_accvgpr_write_b32 a175, v49
s_waitcnt vmcnt(16)
s_barrier
ds_read2st64_b32 v[32:33], v3 offset0:192 offset1:193
ds_read2st64_b32 v[34:35], v3 offset0:194 offset1:195
ds_read2st64_b32 v[36:37], v3 offset0:196 offset1:197
ds_read2st64_b32 v[38:39], v3 offset0:198 offset1:199
ds_read2st64_b32 v[40:41], v3 offset0:224 offset1:225
ds_read2st64_b32 v[42:43], v3 offset0:226 offset1:227
ds_read2st64_b32 v[44:45], v3 offset0:228 offset1:229
ds_read2st64_b32 v[46:47], v3 offset0:230 offset1:231
s_waitcnt lgkmcnt(7)
v_perm_b32 v48, v33, v32, s52
v_accvgpr_write_b32 a176, v48
v_perm_b32 v49, v33, v32, s53
v_accvgpr_write_b32 a180, v49
s_waitcnt lgkmcnt(6)
v_perm_b32 v48, v35, v34, s52
v_accvgpr_write_b32 a177, v48
v_perm_b32 v49, v35, v34, s53
v_accvgpr_write_b32 a181, v49
s_waitcnt lgkmcnt(5)
v_perm_b32 v48, v37, v36, s52
v_accvgpr_write_b32 a178, v48
v_perm_b32 v49, v37, v36, s53
v_accvgpr_write_b32 a182, v49
s_waitcnt lgkmcnt(4)
v_perm_b32 v48, v39, v38, s52
v_accvgpr_write_b32 a179, v48
v_perm_b32 v49, v39, v38, s53
v_accvgpr_write_b32 a183, v49
s_waitcnt lgkmcnt(3)
v_perm_b32 v48, v41, v40, s52
v_accvgpr_write_b32 a184, v48
v_perm_b32 v49, v41, v40, s53
v_accvgpr_write_b32 a188, v49
s_waitcnt lgkmcnt(2)
v_perm_b32 v48, v43, v42, s52
v_accvgpr_write_b32 a185, v48
v_perm_b32 v49, v43, v42, s53
v_accvgpr_write_b32 a189, v49
s_waitcnt lgkmcnt(1)
v_perm_b32 v48, v45, v44, s52
v_accvgpr_write_b32 a186, v48
v_perm_b32 v49, v45, v44, s53
v_accvgpr_write_b32 a190, v49
s_waitcnt lgkmcnt(0)
v_perm_b32 v48, v47, v46, s52
v_accvgpr_write_b32 a187, v48
v_perm_b32 v49, v47, v46, s53
v_accvgpr_write_b32 a191, v49
s_waitcnt vmcnt(12)
s_barrier
ds_read2st64_b32 v[16:17], v4 offset0:0 offset1:1
ds_read2st64_b32 v[18:19], v4 offset0:2 offset1:3
ds_read2st64_b32 v[20:21], v4 offset0:4 offset1:5
ds_read2st64_b32 v[22:23], v4 offset0:6 offset1:7
ds_read2st64_b32 v[24:25], v4 offset0:32 offset1:33
ds_read2st64_b32 v[26:27], v4 offset0:34 offset1:35
ds_read2st64_b32 v[28:29], v4 offset0:36 offset1:37
ds_read2st64_b32 v[30:31], v4 offset0:38 offset1:39
s_waitcnt lgkmcnt(7)
v_perm_b32 v48, v17, v16, s52
v_accvgpr_write_b32 a192, v48
v_perm_b32 v49, v17, v16, s53
v_accvgpr_write_b32 a196, v49
s_waitcnt lgkmcnt(6)
v_perm_b32 v48, v19, v18, s52
v_accvgpr_write_b32 a193, v48
v_perm_b32 v49, v19, v18, s53
v_accvgpr_write_b32 a197, v49
s_waitcnt lgkmcnt(5)
v_perm_b32 v48, v21, v20, s52
v_accvgpr_write_b32 a194, v48
v_perm_b32 v49, v21, v20, s53
v_accvgpr_write_b32 a198, v49
s_waitcnt lgkmcnt(4)
v_perm_b32 v48, v23, v22, s52
v_accvgpr_write_b32 a195, v48
v_perm_b32 v49, v23, v22, s53
v_accvgpr_write_b32 a199, v49
s_waitcnt lgkmcnt(3)
v_perm_b32 v48, v25, v24, s52
v_accvgpr_write_b32 a200, v48
v_perm_b32 v49, v25, v24, s53
v_accvgpr_write_b32 a204, v49
s_waitcnt lgkmcnt(2)
v_perm_b32 v48, v27, v26, s52
v_accvgpr_write_b32 a201, v48
v_perm_b32 v49, v27, v26, s53
v_accvgpr_write_b32 a205, v49
s_waitcnt lgkmcnt(1)
v_perm_b32 v48, v29, v28, s52
v_accvgpr_write_b32 a202, v48
v_perm_b32 v49, v29, v28, s53
v_accvgpr_write_b32 a206, v49
s_waitcnt lgkmcnt(0)
v_perm_b32 v48, v31, v30, s52
v_accvgpr_write_b32 a203, v48
v_perm_b32 v49, v31, v30, s53
v_accvgpr_write_b32 a207, v49
s_waitcnt vmcnt(8)
s_barrier
ds_read2st64_b32 v[32:33], v4 offset0:64 offset1:65
ds_read2st64_b32 v[34:35], v4 offset0:66 offset1:67
ds_read2st64_b32 v[36:37], v4 offset0:68 offset1:69
ds_read2st64_b32 v[38:39], v4 offset0:70 offset1:71
ds_read2st64_b32 v[40:41], v4 offset0:96 offset1:97
ds_read2st64_b32 v[42:43], v4 offset0:98 offset1:99
ds_read2st64_b32 v[44:45], v4 offset0:100 offset1:101
ds_read2st64_b32 v[46:47], v4 offset0:102 offset1:103
s_waitcnt lgkmcnt(7)
v_perm_b32 v48, v33, v32, s52
v_accvgpr_write_b32 a208, v48
v_perm_b32 v49, v33, v32, s53
v_accvgpr_write_b32 a212, v49
s_waitcnt lgkmcnt(6)
v_perm_b32 v48, v35, v34, s52
v_accvgpr_write_b32 a209, v48
v_perm_b32 v49, v35, v34, s53
v_accvgpr_write_b32 a213, v49
s_waitcnt lgkmcnt(5)
v_perm_b32 v48, v37, v36, s52
v_accvgpr_write_b32 a210, v48
v_perm_b32 v49, v37, v36, s53
v_accvgpr_write_b32 a214, v49
s_waitcnt lgkmcnt(4)
v_perm_b32 v48, v39, v38, s52
v_accvgpr_write_b32 a211, v48
v_perm_b32 v49, v39, v38, s53
v_accvgpr_write_b32 a215, v49
s_waitcnt lgkmcnt(3)
v_perm_b32 v48, v41, v40, s52
v_accvgpr_write_b32 a216, v48
v_perm_b32 v49, v41, v40, s53
v_accvgpr_write_b32 a220, v49
s_waitcnt lgkmcnt(2)
v_perm_b32 v48, v43, v42, s52
v_accvgpr_write_b32 a217, v48
v_perm_b32 v49, v43, v42, s53
v_accvgpr_write_b32 a221, v49
s_waitcnt lgkmcnt(1)
v_perm_b32 v48, v45, v44, s52
v_accvgpr_write_b32 a218, v48
v_perm_b32 v49, v45, v44, s53
v_accvgpr_write_b32 a222, v49
s_waitcnt lgkmcnt(0)
v_perm_b32 v48, v47, v46, s52
v_accvgpr_write_b32 a219, v48
v_perm_b32 v49, v47, v46, s53
v_accvgpr_write_b32 a223, v49
s_waitcnt vmcnt(4)
s_barrier
ds_read2st64_b32 v[16:17], v4 offset0:128 offset1:129
ds_read2st64_b32 v[18:19], v4 offset0:130 offset1:131
ds_read2st64_b32 v[20:21], v4 offset0:132 offset1:133
ds_read2st64_b32 v[22:23], v4 offset0:134 offset1:135
ds_read2st64_b32 v[24:25], v4 offset0:160 offset1:161
ds_read2st64_b32 v[26:27], v4 offset0:162 offset1:163
ds_read2st64_b32 v[28:29], v4 offset0:164 offset1:165
ds_read2st64_b32 v[30:31], v4 offset0:166 offset1:167
s_waitcnt lgkmcnt(7)
v_perm_b32 v48, v17, v16, s52
v_accvgpr_write_b32 a224, v48
v_perm_b32 v49, v17, v16, s53
v_accvgpr_write_b32 a228, v49
s_waitcnt lgkmcnt(6)
v_perm_b32 v48, v19, v18, s52
v_accvgpr_write_b32 a225, v48
v_perm_b32 v49, v19, v18, s53
v_accvgpr_write_b32 a229, v49
s_waitcnt lgkmcnt(5)
v_perm_b32 v48, v21, v20, s52
v_accvgpr_write_b32 a226, v48
v_perm_b32 v49, v21, v20, s53
v_accvgpr_write_b32 a230, v49
s_waitcnt lgkmcnt(4)
v_perm_b32 v48, v23, v22, s52
v_accvgpr_write_b32 a227, v48
v_perm_b32 v49, v23, v22, s53
v_accvgpr_write_b32 a231, v49
s_waitcnt lgkmcnt(3)
v_perm_b32 v48, v25, v24, s52
v_accvgpr_write_b32 a232, v48
v_perm_b32 v49, v25, v24, s53
v_accvgpr_write_b32 a236, v49
s_waitcnt lgkmcnt(2)
v_perm_b32 v48, v27, v26, s52
v_accvgpr_write_b32 a233, v48
v_perm_b32 v49, v27, v26, s53
v_accvgpr_write_b32 a237, v49
s_waitcnt lgkmcnt(1)
v_perm_b32 v48, v29, v28, s52
v_accvgpr_write_b32 a234, v48
v_perm_b32 v49, v29, v28, s53
v_accvgpr_write_b32 a238, v49
s_waitcnt lgkmcnt(0)
v_perm_b32 v48, v31, v30, s52
v_accvgpr_write_b32 a235, v48
v_perm_b32 v49, v31, v30, s53
v_accvgpr_write_b32 a239, v49
s_waitcnt vmcnt(0)
s_barrier
ds_read2st64_b32 v[32:33], v4 offset0:192 offset1:193
ds_read2st64_b32 v[34:35], v4 offset0:194 offset1:195
ds_read2st64_b32 v[36:37], v4 offset0:196 offset1:197
ds_read2st64_b32 v[38:39], v4 offset0:198 offset1:199
ds_read2st64_b32 v[40:41], v4 offset0:224 offset1:225
ds_read2st64_b32 v[42:43], v4 offset0:226 offset1:227
ds_read2st64_b32 v[44:45], v4 offset0:228 offset1:229
ds_read2st64_b32 v[46:47], v4 offset0:230 offset1:231
s_waitcnt lgkmcnt(7)
v_perm_b32 v48, v33, v32, s52
v_accvgpr_write_b32 a240, v48
v_perm_b32 v49, v33, v32, s53
v_accvgpr_write_b32 a244, v49
s_waitcnt lgkmcnt(6)
v_perm_b32 v48, v35, v34, s52
v_accvgpr_write_b32 a241, v48
v_perm_b32 v49, v35, v34, s53
v_accvgpr_write_b32 a245, v49
s_waitcnt lgkmcnt(5)
v_perm_b32 v48, v37, v36, s52
v_accvgpr_write_b32 a242, v48
v_perm_b32 v49, v37, v36, s53
v_accvgpr_write_b32 a246, v49
s_waitcnt lgkmcnt(4)
v_perm_b32 v48, v39, v38, s52
v_accvgpr_write_b32 a243, v48
v_perm_b32 v49, v39, v38, s53
v_accvgpr_write_b32 a247, v49
s_waitcnt lgkmcnt(3)
v_perm_b32 v48, v41, v40, s52
v_accvgpr_write_b32 a248, v48
v_perm_b32 v49, v41, v40, s53
v_accvgpr_write_b32 a252, v49
s_waitcnt lgkmcnt(2)
v_perm_b32 v48, v43, v42, s52
v_accvgpr_write_b32 a249, v48
v_perm_b32 v49, v43, v42, s53
v_accvgpr_write_b32 a253, v49
s_waitcnt lgkmcnt(1)
v_perm_b32 v48, v45, v44, s52
v_accvgpr_write_b32 a250, v48
v_perm_b32 v49, v45, v44, s53
v_accvgpr_write_b32 a254, v49
s_waitcnt lgkmcnt(0)
v_perm_b32 v48, v47, v46, s52
v_accvgpr_write_b32 a251, v48
v_perm_b32 v49, v47, v46, s53
v_accvgpr_write_b32 a255, v49
s_lshl_b32 s54, s34, 2
s_add_u32 s54, s54, s32
s_lshl_b32 s54, s54, 16
s_add_u32 s54, s54, 100663296
v_lshlrev_b32 v1, 4, v0
buffer_store_dwordx4 a[0:3], v1, s[36:39], s54 offen offset:0 sc1
buffer_store_dwordx4 a[4:7], v1, s[36:39], s54 offen offset:1024 sc1
buffer_store_dwordx4 a[8:11], v1, s[36:39], s54 offen offset:2048 sc1
buffer_store_dwordx4 a[12:15], v1, s[36:39], s54 offen offset:3072 sc1
s_add_u32 s54, s54, 4096
buffer_store_dwordx4 a[16:19], v1, s[36:39], s54 offen offset:0 sc1
buffer_store_dwordx4 a[20:23], v1, s[36:39], s54 offen offset:1024 sc1
buffer_store_dwordx4 a[24:27], v1, s[36:39], s54 offen offset:2048 sc1
buffer_store_dwordx4 a[28:31], v1, s[36:39], s54 offen offset:3072 sc1
s_add_u32 s54, s54, 4096
buffer_store_dwordx4 a[32:35], v1, s[36:39], s54 offen offset:0 sc1
buffer_store_dwordx4 a[36:39], v1, s[36:39], s54 offen offset:1024 sc1
buffer_store_dwordx4 a[40:43], v1, s[36:39], s54 offen offset:2048 sc1
buffer_store_dwordx4 a[44:47], v1, s[36:39], s54 offen offset:3072 sc1
s_add_u32 s54, s54, 4096
buffer_store_dwordx4 a[48:51], v1, s[36:39], s54 offen offset:0 sc1
buffer_store_dwordx4 a[52:55], v1, s[36:39], s54 offen offset:1024 sc1
buffer_store_dwordx4 a[56:59], v1, s[36:39], s54 offen offset:2048 sc1
buffer_store_dwordx4 a[60:63], v1, s[36:39], s54 offen offset:3072 sc1
s_add_u32 s54, s54, 4096
buffer_store_dwordx4 a[64:67], v1, s[36:39], s54 offen offset:0 sc1
buffer_store_dwordx4 a[68:71], v1, s[36:39], s54 offen offset:1024 sc1
buffer_store_dwordx4 a[72:75], v1, s[36:39], s54 offen offset:2048 sc1
buffer_store_dwordx4 a[76:79], v1, s[36:39], s54 offen offset:3072 sc1
s_add_u32 s54, s54, 4096
buffer_store_dwordx4 a[80:83], v1, s[36:39], s54 offen offset:0 sc1
buffer_store_dwordx4 a[84:87], v1, s[36:39], s54 offen offset:1024 sc1
buffer_store_dwordx4 a[88:91], v1, s[36:39], s54 offen offset:2048 sc1
buffer_store_dwordx4 a[92:95], v1, s[36:39], s54 offen offset:3072 sc1
s_add_u32 s54, s54, 4096
buffer_store_dwordx4 a[96:99], v1, s[36:39], s54 offen offset:0 sc1
buffer_store_dwordx4 a[100:103], v1, s[36:39], s54 offen offset:1024 sc1
buffer_store_dwordx4 a[104:107], v1, s[36:39], s54 offen offset:2048 sc1
buffer_store_dwordx4 a[108:111], v1, s[36:39], s54 offen offset:3072 sc1
s_add_u32 s54, s54, 4096
buffer_store_dwordx4 a[112:115], v1, s[36:39], s54 offen offset:0 sc1
buffer_store_dwordx4 a[116:119], v1, s[36:39], s54 offen offset:1024 sc1
buffer_store_dwordx4 a[120:123], v1, s[36:39], s54 offen offset:2048 sc1
buffer_store_dwordx4 a[124:127], v1, s[36:39], s54 offen offset:3072 sc1
s_add_u32 s54, s54, 4096
buffer_store_dwordx4 a[128:131], v1, s[36:39], s54 offen offset:0 sc1
buffer_store_dwordx4 a[132:135], v1, s[36:39], s54 offen offset:1024 sc1
buffer_store_dwordx4 a[136:139], v1, s[36:39], s54 offen offset:2048 sc1
buffer_store_dwordx4 a[140:143], v1, s[36:39], s54 offen offset:3072 sc1
s_add_u32 s54, s54, 4096
buffer_store_dwordx4 a[144:147], v1, s[36:39], s54 offen offset:0 sc1
buffer_store_dwordx4 a[148:151], v1, s[36:39], s54 offen offset:1024 sc1
buffer_store_dwordx4 a[152:155], v1, s[36:39], s54 offen offset:2048 sc1
buffer_store_dwordx4 a[156:159], v1, s[36:39], s54 offen offset:3072 sc1
s_add_u32 s54, s54, 4096
s_waitcnt vmcnt(36)
buffer_store_dwordx4 a[160:163], v1, s[36:39], s54 offen offset:0 sc1
buffer_store_dwordx4 a[164:167], v1, s[36:39], s54 offen offset:1024 sc1
buffer_store_dwordx4 a[168:171], v1, s[36:39], s54 offen offset:2048 sc1
buffer_store_dwordx4 a[172:175], v1, s[36:39], s54 offen offset:3072 sc1
s_add_u32 s54, s54, 4096
s_waitcnt vmcnt(36)
buffer_store_dwordx4 a[176:179], v1, s[36:39], s54 offen offset:0 sc1
buffer_store_dwordx4 a[180:183], v1, s[36:39], s54 offen offset:1024 sc1
buffer_store_dwordx4 a[184:187], v1, s[36:39], s54 offen offset:2048 sc1
buffer_store_dwordx4 a[188:191], v1, s[36:39], s54 offen offset:3072 sc1
s_add_u32 s54, s54, 4096
s_waitcnt vmcnt(36)
buffer_store_dwordx4 a[192:195], v1, s[36:39], s54 offen offset:0 sc1
buffer_store_dwordx4 a[196:199], v1, s[36:39], s54 offen offset:1024 sc1
buffer_store_dwordx4 a[200:203], v1, s[36:39], s54 offen offset:2048 sc1
buffer_store_dwordx4 a[204:207], v1, s[36:39], s54 offen offset:3072 sc1
s_add_u32 s54, s54, 4096
s_waitcnt vmcnt(36)
buffer_store_dwordx4 a[208:211], v1, s[36:39], s54 offen offset:0 sc1
buffer_store_dwordx4 a[212:215], v1, s[36:39], s54 offen offset:1024 sc1
buffer_store_dwordx4 a[216:219], v1, s[36:39], s54 offen offset:2048 sc1
buffer_store_dwordx4 a[220:223], v1, s[36:39], s54 offen offset:3072 sc1
s_add_u32 s54, s54, 4096
s_waitcnt vmcnt(36)
buffer_store_dwordx4 a[224:227], v1, s[36:39], s54 offen offset:0 sc1
buffer_store_dwordx4 a[228:231], v1, s[36:39], s54 offen offset:1024 sc1
buffer_store_dwordx4 a[232:235], v1, s[36:39], s54 offen offset:2048 sc1
buffer_store_dwordx4 a[236:239], v1, s[36:39], s54 offen offset:3072 sc1
s_add_u32 s54, s54, 4096
s_waitcnt vmcnt(36)
buffer_store_dwordx4 a[240:243], v1, s[36:39], s54 offen offset:0 sc1
buffer_store_dwordx4 a[244:247], v1, s[36:39], s54 offen offset:1024 sc1
buffer_store_dwordx4 a[248:251], v1, s[36:39], s54 offen offset:2048 sc1
buffer_store_dwordx4 a[252:255], v1, s[36:39], s54 offen offset:3072 sc1
s_waitcnt vmcnt(0)
L_side4:
s_barrier
s_cmp_lg_u32 s32, 0
s_cbranch_scc1 L_END
s_cmp_lt_u32 s34, 11
s_cselect_b32 s54, 64, 0x44
v_mov_b32 v2, s54
v_mov_b32 v3, 1
s_mov_b64 exec, 1
global_atomic_add v2, v3, s[28:29]
s_branch L_END
L_CHAIN:
v_mov_b32 v111, v0
v_lshrrev_b32 v110, 4, v0
v_and_b32 v109, 15, v0
v_lshlrev_b32 v1, 3, v111
v_lshlrev_b32 v0, 4, v111
s_lshl_b32 s54, s32, 15
v_add_u32 v9, s54, v0
s_mov_b32 s68, 0xffbfffbf
s_mov_b32 s69, 0x3e0293ee
s_mov_b32 s58, 0
s_lshl_b32 s54, s34, 2
s_add_u32 s54, s54, s32
s_lshl_b32 s62, s54, 11
s_add_u32 s62, s62, 3145728
s_mov_b32 s60, 3145728
s_mov_b32 s61, 3149824
v_mov_b32 v104, s68
v_mov_b32 v105, s68
v_mov_b32 v106, s68
v_mov_b32 v107, s68
s_xor_b32 s55, s62, 0x40000
buffer_store_dwordx4 v[104:107], v0, s[36:39], s62 offen offset:0
buffer_store_dwordx4 v[104:107], v0, s[36:39], s62 offen offset:1024
buffer_store_dwordx4 v[104:107], v0, s[36:39], s55 offen offset:0
buffer_store_dwordx4 v[104:107], v0, s[36:39], s55 offen offset:1024
s_lshr_b32 s54, s34, 3
s_bfe_u32 s55, s34, 0x20001
s_and_b32 s56, s34, 1
s_lshr_b32 s59, s55, 1
s_and_b32 s55, s55, 1
s_lshl_b32 s57, s32, 1
s_add_u32 s57, s57, s56
s_lshl_b32 s57, s57, 10
s_lshl_b32 s58, s54, 8
s_add_u32 s57, s57, s58
s_lshl_b32 s58, s55, 7
s_add_u32 s57, s57, s58
s_lshl_b32 s58, s59, 5
s_add_u32 s57, s57, s58
v_lshrrev_b32 v100, 1, v110
v_lshlrev_b32 v100, 6, v100
v_and_b32 v102, 1, v110
v_lshlrev_b32 v102, 4, v102
v_add_u32 v100, v100, v102
v_and_b32 v103, 3, v109
v_lshlrev_b32 v101, 2, v103
v_add3_u32 v4, v100, v101, s57
v_lshrrev_b32 v101, 2, v109
v_mul_u32_u24 v101, 8192, v101
v_add_u32 v4, v4, v101
s_mov_b32 s63, 2883584
s_lshl_b32 s64, s32, 11
s_add_u32 s64, s64, 2883584
s_and_b32 s58, s34, 0
s_mul_i32 s58, s58, 8192
s_add_u32 s64, s64, s58
s_mov_b32 s40, s6
s_and_b32 s41, s7, 0xffff
s_mov_b32 s42, 0x2000
s_mov_b32 s43, 0x20000
s_lshl_b32 s57, s55, 12
s_lshl_b32 s58, s54, 8
s_add_u32 s57, s57, s58
s_lshl_b32 s58, s56, 7
s_add_u32 s57, s57, s58
s_lshl_b32 s58, s32, 2
s_add_u32 s57, s57, s58
s_lshl_b32 s58, s59, 1
s_add_u32 s57, s57, s58
v_lshlrev_b32 v100, 10, v110
v_lshlrev_b32 v101, 5, v103
v_add_u32 v100, v100, v101
s_mov_b32 s72, 0xf000f
s_mov_b32 s73, 0xf000f
s_mov_b32 s74, 0x00ff00ff
s_mov_b32 s75, 0x00ff00ff
s_mov_b64 exec, s[72:73]
buffer_load_ushort v20, v100, s[40:43], s57 offen
buffer_load_ushort v21, v100, s[40:43], s57 offen offset:16
s_xor_b32 s55, s63, 0x10000
buffer_store_dword v104, v4, s[36:39], s55 offen
s_mov_b64 exec, -1
s_mov_b32 s40, s14
s_and_b32 s41, s15, 0xffff
s_mov_b32 s42, 0x400000
s_mov_b32 s43, 0x20000
v_lshlrev_b32 v100, 12, v110
v_lshlrev_b32 v101, 4, v109
s_lshl_b32 s54, s34, 17
s_lshl_b32 s55, s32, 8
s_add_u32 s54, s54, s55
v_add3_u32 v100, v100, v101, s54
s_lshl_b32 s54, s32, 3
s_add_u32 s54, s54, 0
s_lshr_b32 s56, 0x93d2e1e4, s54
s_and_b32 s56, s56, 3
s_lshl_b32 s80, s56, 14
s_lshl_b32 s56, s56, 15
s_lshl_b32 s54, s32, 3
s_add_u32 s54, s54, 2
s_lshr_b32 s57, 0x93d2e1e4, s54
s_and_b32 s57, s57, 3
s_lshl_b32 s81, s57, 14
s_lshl_b32 s57, s57, 15
s_lshl_b32 s54, s32, 3
s_add_u32 s54, s54, 4
s_lshr_b32 s58, 0x93d2e1e4, s54
s_and_b32 s58, s58, 3
s_lshl_b32 s82, s58, 14
s_lshl_b32 s58, s58, 15
s_lshl_b32 s54, s32, 3
s_add_u32 s54, s54, 6
s_lshr_b32 s59, 0x93d2e1e4, s54
s_and_b32 s59, s59, 3
s_lshl_b32 s83, s59, 14
s_lshl_b32 s59, s59, 15
s_mov_b32 s84, s10
s_and_b32 s85, s11, 0xffff
s_mov_b32 s86, 0x400000
s_mov_b32 s87, 0x20000
s_mov_b32 s44, s8
s_and_b32 s45, s9, 0xffff
s_mov_b32 s46, 0x400000
s_mov_b32 s47, 0x20000
s_mov_b32 s48, s12
s_and_b32 s49, s13, 0xffff
s_mov_b32 s50, 0x400000
s_mov_b32 s51, 0x20000
s_lshr_b32 s54, s32, 1
s_lshl_b32 s54, s54, 20
s_and_b32 s55, s32, 1
s_lshl_b32 s89, s55, 18
s_add_u32 s54, s54, s89
s_lshl_b32 s89, s34, 8
s_add_u32 s54, s54, s89
v_lshlrev_b32 v102, 13, v110
v_lshlrev_b32 v103, 4, v109
v_add3_u32 v101, v102, v103, s54
s_lshl_b32 s55, s55, 6
v_xor_b32 v102, s55, v0
s_lshl_b32 s54, s32, 12
s_add_u32 s54, s54, 131072
v_add_u32 v104, s54, v102
v_lshlrev_b32 v102, 2, v109
s_lshl_b32 s54, s32, 6
v_add_u32 v102, s54, v102
v_and_b32 v103, 1, v110
v_lshlrev_b32 v103, 6, v103
v_xor_b32 v102, v102, v103
v_lshlrev_b32 v103, 12, v110
v_add_u32 v102, v102, v103
s_lshr_b32 s54, s80, 5
s_add_u32 s54, s54, 131072
v_add_u32 v105, s54, v102
s_lshr_b32 s54, s81, 5
s_add_u32 s54, s54, 131072
v_add_u32 v106, s54, v102
s_lshr_b32 s54, s82, 5
s_add_u32 s54, s54, 131072
v_add_u32 v107, s54, v102
s_lshr_b32 s54, s83, 5
s_add_u32 s54, s54, 131072
v_add_u32 v108, s54, v102
s_movk_i32 s88, 0x80
s_lshl_b32 s54, s34, 10
s_lshl_b32 s55, s32, 8
s_add_u32 s71, s54, s55
s_add_u32 s71, s71, 2097152
s_mov_b32 s54, 0
buffer_load_dwordx4 v[32:35], v101, s[84:87], s54 offen
s_mov_b32 s54, 32768
buffer_load_dwordx4 v[36:39], v101, s[84:87], s54 offen
s_mov_b32 s54, 65536
buffer_load_dwordx4 v[40:43], v101, s[84:87], s54 offen
s_mov_b32 s54, 98304
buffer_load_dwordx4 v[44:47], v101, s[84:87], s54 offen
s_mov_b32 s54, 131072
buffer_load_dwordx4 v[48:51], v101, s[84:87], s54 offen
s_mov_b32 s54, 163840
buffer_load_dwordx4 v[52:55], v101, s[84:87], s54 offen
s_mov_b32 s54, 196608
buffer_load_dwordx4 v[56:59], v101, s[84:87], s54 offen
s_mov_b32 s54, 229376
buffer_load_dwordx4 v[60:63], v101, s[84:87], s54 offen
s_mov_b32 s54, 2097152
buffer_load_dwordx4 v[64:67], v101, s[84:87], s54 offen
s_mov_b32 s54, 2129920
buffer_load_dwordx4 v[68:71], v101, s[84:87], s54 offen
s_mov_b32 s54, 2162688
buffer_load_dwordx4 v[72:75], v101, s[84:87], s54 offen
s_mov_b32 s54, 2195456
buffer_load_dwordx4 v[76:79], v101, s[84:87], s54 offen
s_mov_b32 s54, 2228224
buffer_load_dwordx4 v[80:83], v101, s[84:87], s54 offen
s_mov_b32 s54, 2260992
buffer_load_dwordx4 v[84:87], v101, s[84:87], s54 offen
s_mov_b32 s54, 2293760
buffer_load_dwordx4 v[88:91], v101, s[84:87], s54 offen
s_mov_b32 s54, 2326528
buffer_load_dwordx4 v[92:95], v101, s[84:87], s54 offen
s_mov_b32 s54, 524288
buffer_load_dwordx4 v[192:195], v101, s[84:87], s54 offen
s_mov_b32 s54, 557056
buffer_load_dwordx4 v[196:199], v101, s[84:87], s54 offen
s_mov_b32 s54, 589824
buffer_load_dwordx4 v[200:203], v101, s[84:87], s54 offen
s_mov_b32 s54, 622592
buffer_load_dwordx4 v[204:207], v101, s[84:87], s54 offen
v_bfe_u32 v113, v109, 1, 1
v_mov_b32 v114, 0x4444
v_mov_b32 v115, 0xeeee
v_cmp_eq_u32 vcc, 1, v113
s_nop 1
v_cndmask_b32 v2, v114, v115, vcc
v_cmp_lt_u32 vcc, 7, v109
s_nop 1
v_cndmask_b32 v114, v114, v115, vcc
v_lshl_or_b32 v2, v114, 16, v2
v_lshlrev_b32 v114, 1, v110
v_lshrrev_b32 v115, 3, v109
v_add_u32 v114, v114, v115
v_lshlrev_b32 v114, 13, v114
v_and_b32 v116, 7, v109
v_lshlrev_b32 v117, 3, v116
s_lshl_b32 s54, s32, 16
s_lshl_b32 s55, s34, 6
s_add_u32 s54, s54, s55
v_add3_u32 v3, v114, v117, s54
s_lshl_b32 s54, s32, 11
s_add_u32 s54, s54, 131072
v_add_u32 v5, s54, v0
s_lshr_b32 s54, s81, 3
s_add_u32 s54, s54, 131072
v_add_u32 v6, s54, v0
s_lshr_b32 s54, s82, 3
s_add_u32 s54, s54, 131072
v_add_u32 v7, s54, v0
s_lshr_b32 s54, s83, 3
s_add_u32 s54, s54, 131072
v_add_u32 v8, s54, v0
s_mul_i32 s90, s32, 1280
s_add_u32 s90, s90, 139264
v_lshrrev_b32 v114, 2, v109
v_mul_u32_u24 v114, 144, v114
v_lshlrev_b32 v117, 5, v110
v_and_b32 v118, 3, v109
v_lshlrev_b32 v118, 2, v118
v_add3_u32 v114, v114, v117, v118
v_add_u32 v10, s90, v114
v_lshrrev_b32 v114, 2, v109
v_lshlrev_b32 v114, 1, v114
v_and_b32 v117, 1, v109
v_add_u32 v119, v114, v117
v_mul_u32_u24 v120, 144, v110
v_lshlrev_b32 v114, 7, v110
v_lshlrev_b32 v117, 2, v109
v_add_u32 v11, v114, v117
v_lshlrev_b32 v114, 4, v116
s_add_u32 s91, s90, 640
v_add3_u32 v14, v120, v114, s91
v_mov_b32 v114, 144384
v_cmp_eq_u32 vcc, 0, v115
s_nop 1
v_cndmask_b32 v12, v114, v14, vcc
v_cndmask_b32 v13, v14, v114, vcc
v_mul_u32_u24 v114, 1280, v115
v_lshlrev_b32 v117, 4, v116
v_add3_u32 v114, v114, v117, v120
v_add_u32 v14, 139904, v114
v_mul_u32_u24 v114, 1280, v113
v_lshlrev_b32 v117, 4, v119
v_add3_u32 v114, v114, v117, v120
v_add_u32 v15, 139264, v114
v_lshlrev_b32 v114, 3, v110
v_add_u32 v114, v114, v116
v_lshlrev_b32 v19, 7, v111
v_mov_b32 v114, 0x10000000
v_cmp_lt_u32 vcc, 31, v111
s_nop 1
v_cndmask_b32 v19, v19, v114, vcc
v_mov_b32 v114, 0x3f80
v_mov_b32 v117, 0x3f800000
v_mov_b32 v118, 0
v_cmp_eq_u32 vcc, 0, v109
s_nop 1
v_cndmask_b32 v24, v118, v114, vcc
v_cmp_eq_u32 vcc, 4, v109
s_nop 1
v_cndmask_b32 v24, v24, v117, vcc
v_cmp_eq_u32 vcc, 8, v109
s_nop 1
v_cndmask_b32 v25, v118, v114, vcc
v_cmp_eq_u32 vcc, 12, v109
s_nop 1
v_cndmask_b32 v25, v25, v117, vcc
v_cmp_eq_u32 vcc, 1, v109
s_nop 1
v_cndmask_b32 v26, v118, v114, vcc
v_cmp_eq_u32 vcc, 5, v109
s_nop 1
v_cndmask_b32 v26, v26, v117, vcc
v_cmp_eq_u32 vcc, 9, v109
s_nop 1
v_cndmask_b32 v27, v118, v114, vcc
v_cmp_eq_u32 vcc, 13, v109
s_nop 1
v_cndmask_b32 v27, v27, v117, vcc
v_mov_b32 v28, 0x3f803f80
v_mov_b32 v29, 0x3f803f80
v_mov_b32 v30, 0x3f803f80
v_mov_b32 v31, 0x3f803f80
s_lshl_b32 s54, s34, 14
s_lshl_b32 s55, s32, 12
s_add_u32 s65, s54, s55
s_add_u32 s65, s65, 16777216
s_lshl_b32 s54, s34, 13
s_lshl_b32 s55, s32, 11
s_add_u32 s66, s54, s55
s_add_u32 s66, s66, 50331648
s_lshl_b32 s54, s34, 7
s_lshl_b32 s55, s32, 2
s_add_u32 s70, s54, s55
s_add_u32 s70, s70, 2179072
s_mov_b32 s67, 0
s_waitcnt vmcnt(21)
v_lshl_or_b32 v20, v21, 16, v20
v_mov_b32 v21, -1
v_cmp_eq_u32 vcc, s68, v20
s_nop 1
v_cndmask_b32 v20, v20, v21, vcc
s_mov_b64 exec, s[72:73]
buffer_store_dword v20, v4, s[36:39], s63 offen
s_mov_b64 exec, -1
s_waitcnt vmcnt(20)
ds_write_b128 v104, v[32:35] offset:0
s_waitcnt vmcnt(19)
ds_write_b128 v104, v[36:39] offset:1024
s_waitcnt vmcnt(18)
ds_write_b128 v104, v[40:43] offset:2048
s_waitcnt vmcnt(17)
ds_write_b128 v104, v[44:47] offset:3072
s_waitcnt lgkmcnt(0)
s_barrier
ds_read2st64_b32 v[176:177], v105 offset0:0 offset1:8
ds_read2st64_b32 v[178:179], v105 offset0:1 offset1:9
ds_read2st64_b32 v[180:181], v106 offset0:0 offset1:8
ds_read2st64_b32 v[182:183], v106 offset0:1 offset1:9
ds_read2st64_b32 v[184:185], v107 offset0:0 offset1:8
ds_read2st64_b32 v[186:187], v107 offset0:1 offset1:9
ds_read2st64_b32 v[188:189], v108 offset0:0 offset1:8
ds_read2st64_b32 v[190:191], v108 offset0:1 offset1:9
s_waitcnt lgkmcnt(7)
v_perm_b32 v112, v177, v176, s52
s_waitcnt lgkmcnt(6)
v_perm_b32 v113, v179, v178, s52
ds_write_b64 v9, v[112:113] offset:6144
v_perm_b32 v114, v177, v176, s53
v_perm_b32 v115, v179, v178, s53
ds_write_b64 v9, v[114:115] offset:8192
s_waitcnt lgkmcnt(7)
v_perm_b32 v102, v181, v180, s52
v_accvgpr_write_b32 a0, v102
s_waitcnt lgkmcnt(6)
v_perm_b32 v103, v183, v182, s52
v_accvgpr_write_b32 a1, v103
v_perm_b32 v102, v181, v180, s53
v_accvgpr_write_b32 a8, v102
v_perm_b32 v103, v183, v182, s53
v_accvgpr_write_b32 a9, v103
s_waitcnt lgkmcnt(5)
v_perm_b32 v102, v185, v184, s52
v_accvgpr_write_b32 a16, v102
s_waitcnt lgkmcnt(4)
v_perm_b32 v103, v187, v186, s52
v_accvgpr_write_b32 a17, v103
v_perm_b32 v102, v185, v184, s53
v_accvgpr_write_b32 a24, v102
v_perm_b32 v103, v187, v186, s53
v_accvgpr_write_b32 a25, v103
s_waitcnt lgkmcnt(3)
v_perm_b32 v102, v189, v188, s52
v_accvgpr_write_b32 a32, v102
s_waitcnt lgkmcnt(2)
v_perm_b32 v103, v191, v190, s52
v_accvgpr_write_b32 a33, v103
v_perm_b32 v102, v189, v188, s53
v_accvgpr_write_b32 a40, v102
v_perm_b32 v103, v191, v190, s53
v_accvgpr_write_b32 a41, v103
s_waitcnt vmcnt(16)
ds_write_b128 v104, v[48:51] offset:16384
s_waitcnt vmcnt(15)
ds_write_b128 v104, v[52:55] offset:17408
s_waitcnt vmcnt(14)
ds_write_b128 v104, v[56:59] offset:18432
s_waitcnt vmcnt(13)
ds_write_b128 v104, v[60:63] offset:19456
s_waitcnt lgkmcnt(0)
s_barrier
ds_read2st64_b32 v[176:177], v105 offset0:64 offset1:72
ds_read2st64_b32 v[178:179], v105 offset0:65 offset1:73
ds_read2st64_b32 v[180:181], v106 offset0:64 offset1:72
ds_read2st64_b32 v[182:183], v106 offset0:65 offset1:73
ds_read2st64_b32 v[184:185], v107 offset0:64 offset1:72
ds_read2st64_b32 v[186:187], v107 offset0:65 offset1:73
ds_read2st64_b32 v[188:189], v108 offset0:64 offset1:72
ds_read2st64_b32 v[190:191], v108 offset0:65 offset1:73
s_waitcnt lgkmcnt(7)
v_perm_b32 v112, v177, v176, s52
s_waitcnt lgkmcnt(6)
v_perm_b32 v113, v179, v178, s52
ds_write_b64 v9, v[112:113] offset:6152
v_perm_b32 v114, v177, v176, s53
v_perm_b32 v115, v179, v178, s53
ds_write_b64 v9, v[114:115] offset:8200
s_waitcnt lgkmcnt(7)
v_perm_b32 v102, v181, v180, s52
v_accvgpr_write_b32 a2, v102
s_waitcnt lgkmcnt(6)
v_perm_b32 v103, v183, v182, s52
v_accvgpr_write_b32 a3, v103
v_perm_b32 v102, v181, v180, s53
v_accvgpr_write_b32 a10, v102
v_perm_b32 v103, v183, v182, s53
v_accvgpr_write_b32 a11, v103
s_waitcnt lgkmcnt(5)
v_perm_b32 v102, v185, v184, s52
v_accvgpr_write_b32 a18, v102
s_waitcnt lgkmcnt(4)
v_perm_b32 v103, v187, v186, s52
v_accvgpr_write_b32 a19, v103
v_perm_b32 v102, v185, v184, s53
v_accvgpr_write_b32 a26, v102
v_perm_b32 v103, v187, v186, s53
v_accvgpr_write_b32 a27, v103
s_waitcnt lgkmcnt(3)
v_perm_b32 v102, v189, v188, s52
v_accvgpr_write_b32 a34, v102
s_waitcnt lgkmcnt(2)
v_perm_b32 v103, v191, v190, s52
v_accvgpr_write_b32 a35, v103
v_perm_b32 v102, v189, v188, s53
v_accvgpr_write_b32 a42, v102
v_perm_b32 v103, v191, v190, s53
v_accvgpr_write_b32 a43, v103
s_mov_b32 s54, 655360
buffer_load_dwordx4 v[32:35], v101, s[84:87], s54 offen
s_mov_b32 s54, 688128
buffer_load_dwordx4 v[36:39], v101, s[84:87], s54 offen
s_mov_b32 s54, 720896
buffer_load_dwordx4 v[40:43], v101, s[84:87], s54 offen
s_mov_b32 s54, 753664
buffer_load_dwordx4 v[44:47], v101, s[84:87], s54 offen
s_waitcnt vmcnt(16)
ds_write_b128 v104, v[64:67] offset:0
s_waitcnt vmcnt(15)
ds_write_b128 v104, v[68:71] offset:1024
s_waitcnt vmcnt(14)
ds_write_b128 v104, v[72:75] offset:2048
s_waitcnt vmcnt(13)
ds_write_b128 v104, v[76:79] offset:3072
s_waitcnt lgkmcnt(0)
s_barrier
ds_read2st64_b32 v[176:177], v105 offset0:0 offset1:8
ds_read2st64_b32 v[178:179], v105 offset0:1 offset1:9
ds_read2st64_b32 v[180:181], v106 offset0:0 offset1:8
ds_read2st64_b32 v[182:183], v106 offset0:1 offset1:9
ds_read2st64_b32 v[184:185], v107 offset0:0 offset1:8
ds_read2st64_b32 v[186:187], v107 offset0:1 offset1:9
ds_read2st64_b32 v[188:189], v108 offset0:0 offset1:8
ds_read2st64_b32 v[190:191], v108 offset0:1 offset1:9
s_waitcnt lgkmcnt(7)
v_perm_b32 v112, v177, v176, s52
s_waitcnt lgkmcnt(6)
v_perm_b32 v113, v179, v178, s52
ds_write_b64 v9, v[112:113] offset:7168
v_perm_b32 v114, v177, v176, s53
v_perm_b32 v115, v179, v178, s53
ds_write_b64 v9, v[114:115] offset:9216
s_waitcnt lgkmcnt(7)
v_perm_b32 v102, v181, v180, s52
v_accvgpr_write_b32 a4, v102
s_waitcnt lgkmcnt(6)
v_perm_b32 v103, v183, v182, s52
v_accvgpr_write_b32 a5, v103
v_perm_b32 v102, v181, v180, s53
v_accvgpr_write_b32 a12, v102
v_perm_b32 v103, v183, v182, s53
v_accvgpr_write_b32 a13, v103
s_waitcnt lgkmcnt(5)
v_perm_b32 v102, v185, v184, s52
v_accvgpr_write_b32 a20, v102
s_waitcnt lgkmcnt(4)
v_perm_b32 v103, v187, v186, s52
v_accvgpr_write_b32 a21, v103
v_perm_b32 v102, v185, v184, s53
v_accvgpr_write_b32 a28, v102
v_perm_b32 v103, v187, v186, s53
v_accvgpr_write_b32 a29, v103
s_waitcnt lgkmcnt(3)
v_perm_b32 v102, v189, v188, s52
v_accvgpr_write_b32 a36, v102
s_waitcnt lgkmcnt(2)
v_perm_b32 v103, v191, v190, s52
v_accvgpr_write_b32 a37, v103
v_perm_b32 v102, v189, v188, s53
v_accvgpr_write_b32 a44, v102
v_perm_b32 v103, v191, v190, s53
v_accvgpr_write_b32 a45, v103
s_mov_b32 s54, 2621440
buffer_load_dwordx4 v[48:51], v101, s[84:87], s54 offen
s_mov_b32 s54, 2654208
buffer_load_dwordx4 v[52:55], v101, s[84:87], s54 offen
s_mov_b32 s54, 2686976
buffer_load_dwordx4 v[56:59], v101, s[84:87], s54 offen
s_mov_b32 s54, 2719744
buffer_load_dwordx4 v[60:63], v101, s[84:87], s54 offen
s_waitcnt vmcnt(16)
ds_write_b128 v104, v[80:83] offset:16384
s_waitcnt vmcnt(15)
ds_write_b128 v104, v[84:87] offset:17408
s_waitcnt vmcnt(14)
ds_write_b128 v104, v[88:91] offset:18432
s_waitcnt vmcnt(13)
ds_write_b128 v104, v[92:95] offset:19456
s_waitcnt lgkmcnt(0)
s_barrier
ds_read2st64_b32 v[176:177], v105 offset0:64 offset1:72
ds_read2st64_b32 v[178:179], v105 offset0:65 offset1:73
ds_read2st64_b32 v[180:181], v106 offset0:64 offset1:72
ds_read2st64_b32 v[182:183], v106 offset0:65 offset1:73
ds_read2st64_b32 v[184:185], v107 offset0:64 offset1:72
ds_read2st64_b32 v[186:187], v107 offset0:65 offset1:73
ds_read2st64_b32 v[188:189], v108 offset0:64 offset1:72
ds_read2st64_b32 v[190:191], v108 offset0:65 offset1:73
s_waitcnt lgkmcnt(7)
v_perm_b32 v112, v177, v176, s52
s_waitcnt lgkmcnt(6)
v_perm_b32 v113, v179, v178, s52
ds_write_b64 v9, v[112:113] offset:7176
v_perm_b32 v114, v177, v176, s53
v_perm_b32 v115, v179, v178, s53
ds_write_b64 v9, v[114:115] offset:9224
s_waitcnt lgkmcnt(7)
v_perm_b32 v102, v181, v180, s52
v_accvgpr_write_b32 a6, v102
s_waitcnt lgkmcnt(6)
v_perm_b32 v103, v183, v182, s52
v_accvgpr_write_b32 a7, v103
v_perm_b32 v102, v181, v180, s53
v_accvgpr_write_b32 a14, v102
v_perm_b32 v103, v183, v182, s53
v_accvgpr_write_b32 a15, v103
s_waitcnt lgkmcnt(5)
v_perm_b32 v102, v185, v184, s52
v_accvgpr_write_b32 a22, v102
s_waitcnt lgkmcnt(4)
v_perm_b32 v103, v187, v186, s52
v_accvgpr_write_b32 a23, v103
v_perm_b32 v102, v185, v184, s53
v_accvgpr_write_b32 a30, v102
v_perm_b32 v103, v187, v186, s53
v_accvgpr_write_b32 a31, v103
s_waitcnt lgkmcnt(3)
v_perm_b32 v102, v189, v188, s52
v_accvgpr_write_b32 a38, v102
s_waitcnt lgkmcnt(2)
v_perm_b32 v103, v191, v190, s52
v_accvgpr_write_b32 a39, v103
v_perm_b32 v102, v189, v188, s53
v_accvgpr_write_b32 a46, v102
v_perm_b32 v103, v191, v190, s53
v_accvgpr_write_b32 a47, v103
s_mov_b32 s54, 2752512
buffer_load_dwordx4 v[64:67], v101, s[84:87], s54 offen
s_mov_b32 s54, 2785280
buffer_load_dwordx4 v[68:71], v101, s[84:87], s54 offen
s_mov_b32 s54, 2818048
buffer_load_dwordx4 v[72:75], v101, s[84:87], s54 offen
s_mov_b32 s54, 2850816
buffer_load_dwordx4 v[76:79], v101, s[84:87], s54 offen
s_waitcnt vmcnt(16)
ds_write_b128 v104, v[192:195] offset:0
s_waitcnt vmcnt(15)
ds_write_b128 v104, v[196:199] offset:1024
s_waitcnt vmcnt(14)
ds_write_b128 v104, v[200:203] offset:2048
s_waitcnt vmcnt(13)
ds_write_b128 v104, v[204:207] offset:3072
s_waitcnt lgkmcnt(0)
s_barrier
ds_read2st64_b32 v[176:177], v105 offset0:0 offset1:8
ds_read2st64_b32 v[178:179], v105 offset0:1 offset1:9
ds_read2st64_b32 v[180:181], v106 offset0:0 offset1:8
ds_read2st64_b32 v[182:183], v106 offset0:1 offset1:9
ds_read2st64_b32 v[184:185], v107 offset0:0 offset1:8
ds_read2st64_b32 v[186:187], v107 offset0:1 offset1:9
ds_read2st64_b32 v[188:189], v108 offset0:0 offset1:8
ds_read2st64_b32 v[190:191], v108 offset0:1 offset1:9
s_waitcnt lgkmcnt(7)
v_perm_b32 v112, v177, v176, s52
s_waitcnt lgkmcnt(6)
v_perm_b32 v113, v179, v178, s52
ds_write_b64 v9, v[112:113] offset:10240
v_perm_b32 v114, v177, v176, s53
v_perm_b32 v115, v179, v178, s53
ds_write_b64 v9, v[114:115] offset:12288
s_waitcnt lgkmcnt(7)
v_perm_b32 v102, v181, v180, s52
v_accvgpr_write_b32 a48, v102
s_waitcnt lgkmcnt(6)
v_perm_b32 v103, v183, v182, s52
v_accvgpr_write_b32 a49, v103
v_perm_b32 v102, v181, v180, s53
v_accvgpr_write_b32 a56, v102
v_perm_b32 v103, v183, v182, s53
v_accvgpr_write_b32 a57, v103
s_waitcnt lgkmcnt(5)
v_perm_b32 v102, v185, v184, s52
v_accvgpr_write_b32 a64, v102
s_waitcnt lgkmcnt(4)
v_perm_b32 v103, v187, v186, s52
v_accvgpr_write_b32 a65, v103
v_perm_b32 v102, v185, v184, s53
v_accvgpr_write_b32 a72, v102
v_perm_b32 v103, v187, v186, s53
v_accvgpr_write_b32 a73, v103
s_waitcnt lgkmcnt(3)
v_perm_b32 v102, v189, v188, s52
v_accvgpr_write_b32 a80, v102
s_waitcnt lgkmcnt(2)
v_perm_b32 v103, v191, v190, s52
v_accvgpr_write_b32 a81, v103
v_perm_b32 v102, v189, v188, s53
v_accvgpr_write_b32 a88, v102
v_perm_b32 v103, v191, v190, s53
v_accvgpr_write_b32 a89, v103
s_waitcnt vmcnt(11)
ds_write_b128 v104, v[32:35] offset:16384
s_waitcnt vmcnt(10)
ds_write_b128 v104, v[36:39] offset:17408
s_waitcnt vmcnt(9)
ds_write_b128 v104, v[40:43] offset:18432
s_waitcnt vmcnt(8)
ds_write_b128 v104, v[44:47] offset:19456
s_waitcnt lgkmcnt(0)
s_barrier
ds_read2st64_b32 v[176:177], v105 offset0:64 offset1:72
ds_read2st64_b32 v[178:179], v105 offset0:65 offset1:73
ds_read2st64_b32 v[180:181], v106 offset0:64 offset1:72
ds_read2st64_b32 v[182:183], v106 offset0:65 offset1:73
ds_read2st64_b32 v[184:185], v107 offset0:64 offset1:72
ds_read2st64_b32 v[186:187], v107 offset0:65 offset1:73
ds_read2st64_b32 v[188:189], v108 offset0:64 offset1:72
ds_read2st64_b32 v[190:191], v108 offset0:65 offset1:73
s_waitcnt lgkmcnt(7)
v_perm_b32 v112, v177, v176, s52
s_waitcnt lgkmcnt(6)
v_perm_b32 v113, v179, v178, s52
ds_write_b64 v9, v[112:113] offset:10248
v_perm_b32 v114, v177, v176, s53
v_perm_b32 v115, v179, v178, s53
ds_write_b64 v9, v[114:115] offset:12296
s_waitcnt lgkmcnt(7)
v_perm_b32 v102, v181, v180, s52
v_accvgpr_write_b32 a50, v102
s_waitcnt lgkmcnt(6)
v_perm_b32 v103, v183, v182, s52
v_accvgpr_write_b32 a51, v103
v_perm_b32 v102, v181, v180, s53
v_accvgpr_write_b32 a58, v102
v_perm_b32 v103, v183, v182, s53
v_accvgpr_write_b32 a59, v103
s_waitcnt lgkmcnt(5)
v_perm_b32 v102, v185, v184, s52
v_accvgpr_write_b32 a66, v102
s_waitcnt lgkmcnt(4)
v_perm_b32 v103, v187, v186, s52
v_accvgpr_write_b32 a67, v103
v_perm_b32 v102, v185, v184, s53
v_accvgpr_write_b32 a74, v102
v_perm_b32 v103, v187, v186, s53
v_accvgpr_write_b32 a75, v103
s_waitcnt lgkmcnt(3)
v_perm_b32 v102, v189, v188, s52
v_accvgpr_write_b32 a82, v102
s_waitcnt lgkmcnt(2)
v_perm_b32 v103, v191, v190, s52
v_accvgpr_write_b32 a83, v103
v_perm_b32 v102, v189, v188, s53
v_accvgpr_write_b32 a90, v102
v_perm_b32 v103, v191, v190, s53
v_accvgpr_write_b32 a91, v103
s_mov_b32 s54, 0
buffer_load_dwordx4 v[80:83], v101, s[48:51], s54 offen
s_mov_b32 s54, 32768
buffer_load_dwordx4 v[84:87], v101, s[48:51], s54 offen
s_mov_b32 s54, 65536
buffer_load_dwordx4 v[88:91], v101, s[48:51], s54 offen
s_mov_b32 s54, 98304
buffer_load_dwordx4 v[92:95], v101, s[48:51], s54 offen
s_waitcnt vmcnt(11)
ds_write_b128 v104, v[48:51] offset:0
s_waitcnt vmcnt(10)
ds_write_b128 v104, v[52:55] offset:1024
s_waitcnt vmcnt(9)
ds_write_b128 v104, v[56:59] offset:2048
s_waitcnt vmcnt(8)
ds_write_b128 v104, v[60:63] offset:3072
s_waitcnt lgkmcnt(0)
s_barrier
ds_read2st64_b32 v[176:177], v105 offset0:0 offset1:8
ds_read2st64_b32 v[178:179], v105 offset0:1 offset1:9
ds_read2st64_b32 v[180:181], v106 offset0:0 offset1:8
ds_read2st64_b32 v[182:183], v106 offset0:1 offset1:9
ds_read2st64_b32 v[184:185], v107 offset0:0 offset1:8
ds_read2st64_b32 v[186:187], v107 offset0:1 offset1:9
ds_read2st64_b32 v[188:189], v108 offset0:0 offset1:8
ds_read2st64_b32 v[190:191], v108 offset0:1 offset1:9
s_waitcnt lgkmcnt(7)
v_perm_b32 v112, v177, v176, s52
s_waitcnt lgkmcnt(6)
v_perm_b32 v113, v179, v178, s52
ds_write_b64 v9, v[112:113] offset:11264
v_perm_b32 v114, v177, v176, s53
v_perm_b32 v115, v179, v178, s53
ds_write_b64 v9, v[114:115] offset:13312
s_waitcnt lgkmcnt(7)
v_perm_b32 v102, v181, v180, s52
v_accvgpr_write_b32 a52, v102
s_waitcnt lgkmcnt(6)
v_perm_b32 v103, v183, v182, s52
v_accvgpr_write_b32 a53, v103
v_perm_b32 v102, v181, v180, s53
v_accvgpr_write_b32 a60, v102
v_perm_b32 v103, v183, v182, s53
v_accvgpr_write_b32 a61, v103
s_waitcnt lgkmcnt(5)
v_perm_b32 v102, v185, v184, s52
v_accvgpr_write_b32 a68, v102
s_waitcnt lgkmcnt(4)
v_perm_b32 v103, v187, v186, s52
v_accvgpr_write_b32 a69, v103
v_perm_b32 v102, v185, v184, s53
v_accvgpr_write_b32 a76, v102
v_perm_b32 v103, v187, v186, s53
v_accvgpr_write_b32 a77, v103
s_waitcnt lgkmcnt(3)
v_perm_b32 v102, v189, v188, s52
v_accvgpr_write_b32 a84, v102
s_waitcnt lgkmcnt(2)
v_perm_b32 v103, v191, v190, s52
v_accvgpr_write_b32 a85, v103
v_perm_b32 v102, v189, v188, s53
v_accvgpr_write_b32 a92, v102
v_perm_b32 v103, v191, v190, s53
v_accvgpr_write_b32 a93, v103
s_mov_b32 s54, 131072
buffer_load_dwordx4 v[32:35], v101, s[48:51], s54 offen
s_mov_b32 s54, 163840
buffer_load_dwordx4 v[36:39], v101, s[48:51], s54 offen
s_mov_b32 s54, 196608
buffer_load_dwordx4 v[40:43], v101, s[48:51], s54 offen
s_mov_b32 s54, 229376
buffer_load_dwordx4 v[44:47], v101, s[48:51], s54 offen
s_waitcnt vmcnt(11)
ds_write_b128 v104, v[64:67] offset:16384
s_waitcnt vmcnt(10)
ds_write_b128 v104, v[68:71] offset:17408
s_waitcnt vmcnt(9)
ds_write_b128 v104, v[72:75] offset:18432
s_waitcnt vmcnt(8)
ds_write_b128 v104, v[76:79] offset:19456
s_waitcnt lgkmcnt(0)
s_barrier
ds_read2st64_b32 v[176:177], v105 offset0:64 offset1:72
ds_read2st64_b32 v[178:179], v105 offset0:65 offset1:73
ds_read2st64_b32 v[180:181], v106 offset0:64 offset1:72
ds_read2st64_b32 v[182:183], v106 offset0:65 offset1:73
ds_read2st64_b32 v[184:185], v107 offset0:64 offset1:72
ds_read2st64_b32 v[186:187], v107 offset0:65 offset1:73
ds_read2st64_b32 v[188:189], v108 offset0:64 offset1:72
ds_read2st64_b32 v[190:191], v108 offset0:65 offset1:73
s_waitcnt lgkmcnt(7)
v_perm_b32 v112, v177, v176, s52
s_waitcnt lgkmcnt(6)
v_perm_b32 v113, v179, v178, s52
ds_write_b64 v9, v[112:113] offset:11272
v_perm_b32 v114, v177, v176, s53
v_perm_b32 v115, v179, v178, s53
ds_write_b64 v9, v[114:115] offset:13320
s_waitcnt lgkmcnt(7)
v_perm_b32 v102, v181, v180, s52
v_accvgpr_write_b32 a54, v102
s_waitcnt lgkmcnt(6)
v_perm_b32 v103, v183, v182, s52
v_accvgpr_write_b32 a55, v103
v_perm_b32 v102, v181, v180, s53
v_accvgpr_write_b32 a62, v102
v_perm_b32 v103, v183, v182, s53
v_accvgpr_write_b32 a63, v103
s_waitcnt lgkmcnt(5)
v_perm_b32 v102, v185, v184, s52
v_accvgpr_write_b32 a70, v102
s_waitcnt lgkmcnt(4)
v_perm_b32 v103, v187, v186, s52
v_accvgpr_write_b32 a71, v103
v_perm_b32 v102, v185, v184, s53
v_accvgpr_write_b32 a78, v102
v_perm_b32 v103, v187, v186, s53
v_accvgpr_write_b32 a79, v103
s_waitcnt lgkmcnt(3)
v_perm_b32 v102, v189, v188, s52
v_accvgpr_write_b32 a86, v102
s_waitcnt lgkmcnt(2)
v_perm_b32 v103, v191, v190, s52
v_accvgpr_write_b32 a87, v103
v_perm_b32 v102, v189, v188, s53
v_accvgpr_write_b32 a94, v102
v_perm_b32 v103, v191, v190, s53
v_accvgpr_write_b32 a95, v103
s_mov_b32 s54, 2097152
buffer_load_dwordx4 v[48:51], v101, s[48:51], s54 offen
s_mov_b32 s54, 2129920
buffer_load_dwordx4 v[52:55], v101, s[48:51], s54 offen
s_mov_b32 s54, 2162688
buffer_load_dwordx4 v[56:59], v101, s[48:51], s54 offen
s_mov_b32 s54, 2195456
buffer_load_dwordx4 v[60:63], v101, s[48:51], s54 offen
s_waitcnt vmcnt(11)
ds_write_b128 v104, v[80:83] offset:0
s_waitcnt vmcnt(10)
ds_write_b128 v104, v[84:87] offset:1024
s_waitcnt vmcnt(9)
ds_write_b128 v104, v[88:91] offset:2048
s_waitcnt vmcnt(8)
ds_write_b128 v104, v[92:95] offset:3072
s_waitcnt lgkmcnt(0)
s_barrier
ds_read2st64_b32 v[176:177], v105 offset0:0 offset1:8
ds_read2st64_b32 v[178:179], v105 offset0:1 offset1:9
ds_read2st64_b32 v[180:181], v106 offset0:0 offset1:8
ds_read2st64_b32 v[182:183], v106 offset0:1 offset1:9
ds_read2st64_b32 v[184:185], v107 offset0:0 offset1:8
ds_read2st64_b32 v[186:187], v107 offset0:1 offset1:9
ds_read2st64_b32 v[188:189], v108 offset0:0 offset1:8
ds_read2st64_b32 v[190:191], v108 offset0:1 offset1:9
s_waitcnt lgkmcnt(7)
v_perm_b32 v102, v177, v176, s52
v_accvgpr_write_b32 a96, v102
s_waitcnt lgkmcnt(6)
v_perm_b32 v103, v179, v178, s52
v_accvgpr_write_b32 a97, v103
v_perm_b32 v102, v177, v176, s53
v_accvgpr_write_b32 a104, v102
v_perm_b32 v103, v179, v178, s53
v_accvgpr_write_b32 a105, v103
s_waitcnt lgkmcnt(5)
v_perm_b32 v102, v181, v180, s52
v_accvgpr_write_b32 a112, v102
s_waitcnt lgkmcnt(4)
v_perm_b32 v103, v183, v182, s52
v_accvgpr_write_b32 a113, v103
v_perm_b32 v102, v181, v180, s53
v_accvgpr_write_b32 a120, v102
v_perm_b32 v103, v183, v182, s53
v_accvgpr_write_b32 a121, v103
s_waitcnt lgkmcnt(3)
v_perm_b32 v102, v185, v184, s52
v_accvgpr_write_b32 a128, v102
s_waitcnt lgkmcnt(2)
v_perm_b32 v103, v187, v186, s52
v_accvgpr_write_b32 a129, v103
v_perm_b32 v102, v185, v184, s53
v_accvgpr_write_b32 a136, v102
v_perm_b32 v103, v187, v186, s53
v_accvgpr_write_b32 a137, v103
s_waitcnt lgkmcnt(1)
v_perm_b32 v102, v189, v188, s52
v_accvgpr_write_b32 a144, v102
s_waitcnt lgkmcnt(0)
v_perm_b32 v103, v191, v190, s52
v_accvgpr_write_b32 a145, v103
v_perm_b32 v102, v189, v188, s53
v_accvgpr_write_b32 a152, v102
v_perm_b32 v103, v191, v190, s53
v_accvgpr_write_b32 a153, v103
s_mov_b32 s54, 2228224
buffer_load_dwordx4 v[64:67], v101, s[48:51], s54 offen
s_mov_b32 s54, 2260992
buffer_load_dwordx4 v[68:71], v101, s[48:51], s54 offen
s_mov_b32 s54, 2293760
buffer_load_dwordx4 v[72:75], v101, s[48:51], s54 offen
s_mov_b32 s54, 2326528
buffer_load_dwordx4 v[76:79], v101, s[48:51], s54 offen
s_waitcnt vmcnt(11)
ds_write_b128 v104, v[32:35] offset:16384
s_waitcnt vmcnt(10)
ds_write_b128 v104, v[36:39] offset:17408
s_waitcnt vmcnt(9)
ds_write_b128 v104, v[40:43] offset:18432
s_waitcnt vmcnt(8)
ds_write_b128 v104, v[44:47] offset:19456
s_waitcnt lgkmcnt(0)
s_barrier
ds_read2st64_b32 v[176:177], v105 offset0:64 offset1:72
ds_read2st64_b32 v[178:179], v105 offset0:65 offset1:73
ds_read2st64_b32 v[180:181], v106 offset0:64 offset1:72
ds_read2st64_b32 v[182:183], v106 offset0:65 offset1:73
ds_read2st64_b32 v[184:185], v107 offset0:64 offset1:72
ds_read2st64_b32 v[186:187], v107 offset0:65 offset1:73
ds_read2st64_b32 v[188:189], v108 offset0:64 offset1:72
ds_read2st64_b32 v[190:191], v108 offset0:65 offset1:73
s_waitcnt lgkmcnt(7)
v_perm_b32 v102, v177, v176, s52
v_accvgpr_write_b32 a98, v102
s_waitcnt lgkmcnt(6)
v_perm_b32 v103, v179, v178, s52
v_accvgpr_write_b32 a99, v103
v_perm_b32 v102, v177, v176, s53
v_accvgpr_write_b32 a106, v102
v_perm_b32 v103, v179, v178, s53
v_accvgpr_write_b32 a107, v103
s_waitcnt lgkmcnt(5)
v_perm_b32 v102, v181, v180, s52
v_accvgpr_write_b32 a114, v102
s_waitcnt lgkmcnt(4)
v_perm_b32 v103, v183, v182, s52
v_accvgpr_write_b32 a115, v103
v_perm_b32 v102, v181, v180, s53
v_accvgpr_write_b32 a122, v102
v_perm_b32 v103, v183, v182, s53
v_accvgpr_write_b32 a123, v103
s_waitcnt lgkmcnt(3)
v_perm_b32 v102, v185, v184, s52
v_accvgpr_write_b32 a130, v102
s_waitcnt lgkmcnt(2)
v_perm_b32 v103, v187, v186, s52
v_accvgpr_write_b32 a131, v103
v_perm_b32 v102, v185, v184, s53
v_accvgpr_write_b32 a138, v102
v_perm_b32 v103, v187, v186, s53
v_accvgpr_write_b32 a139, v103
s_waitcnt lgkmcnt(1)
v_perm_b32 v102, v189, v188, s52
v_accvgpr_write_b32 a146, v102
s_waitcnt lgkmcnt(0)
v_perm_b32 v103, v191, v190, s52
v_accvgpr_write_b32 a147, v103
v_perm_b32 v102, v189, v188, s53
v_accvgpr_write_b32 a154, v102
v_perm_b32 v103, v191, v190, s53
v_accvgpr_write_b32 a155, v103
s_mov_b32 s54, 524288
buffer_load_dwordx4 v[80:83], v101, s[48:51], s54 offen
s_mov_b32 s54, 557056
buffer_load_dwordx4 v[84:87], v101, s[48:51], s54 offen
s_mov_b32 s54, 589824
buffer_load_dwordx4 v[88:91], v101, s[48:51], s54 offen
s_mov_b32 s54, 622592
buffer_load_dwordx4 v[92:95], v101, s[48:51], s54 offen
s_waitcnt vmcnt(11)
ds_write_b128 v104, v[48:51] offset:0
s_waitcnt vmcnt(10)
ds_write_b128 v104, v[52:55] offset:1024
s_waitcnt vmcnt(9)
ds_write_b128 v104, v[56:59] offset:2048
s_waitcnt vmcnt(8)
ds_write_b128 v104, v[60:63] offset:3072
s_waitcnt lgkmcnt(0)
s_barrier
ds_read2st64_b32 v[176:177], v105 offset0:0 offset1:8
ds_read2st64_b32 v[178:179], v105 offset0:1 offset1:9
ds_read2st64_b32 v[180:181], v106 offset0:0 offset1:8
ds_read2st64_b32 v[182:183], v106 offset0:1 offset1:9
ds_read2st64_b32 v[184:185], v107 offset0:0 offset1:8
ds_read2st64_b32 v[186:187], v107 offset0:1 offset1:9
ds_read2st64_b32 v[188:189], v108 offset0:0 offset1:8
ds_read2st64_b32 v[190:191], v108 offset0:1 offset1:9
s_waitcnt lgkmcnt(7)
v_perm_b32 v102, v177, v176, s52
v_accvgpr_write_b32 a100, v102
s_waitcnt lgkmcnt(6)
v_perm_b32 v103, v179, v178, s52
v_accvgpr_write_b32 a101, v103
v_perm_b32 v102, v177, v176, s53
v_accvgpr_write_b32 a108, v102
v_perm_b32 v103, v179, v178, s53
v_accvgpr_write_b32 a109, v103
s_waitcnt lgkmcnt(5)
v_perm_b32 v102, v181, v180, s52
v_accvgpr_write_b32 a116, v102
s_waitcnt lgkmcnt(4)
v_perm_b32 v103, v183, v182, s52
v_accvgpr_write_b32 a117, v103
v_perm_b32 v102, v181, v180, s53
v_accvgpr_write_b32 a124, v102
v_perm_b32 v103, v183, v182, s53
v_accvgpr_write_b32 a125, v103
s_waitcnt lgkmcnt(3)
v_perm_b32 v102, v185, v184, s52
v_accvgpr_write_b32 a132, v102
s_waitcnt lgkmcnt(2)
v_perm_b32 v103, v187, v186, s52
v_accvgpr_write_b32 a133, v103
v_perm_b32 v102, v185, v184, s53
v_accvgpr_write_b32 a140, v102
v_perm_b32 v103, v187, v186, s53
v_accvgpr_write_b32 a141, v103
s_waitcnt lgkmcnt(1)
v_perm_b32 v102, v189, v188, s52
v_accvgpr_write_b32 a148, v102
s_waitcnt lgkmcnt(0)
v_perm_b32 v103, v191, v190, s52
v_accvgpr_write_b32 a149, v103
v_perm_b32 v102, v189, v188, s53
v_accvgpr_write_b32 a156, v102
v_perm_b32 v103, v191, v190, s53
v_accvgpr_write_b32 a157, v103
s_mov_b32 s54, 655360
buffer_load_dwordx4 v[32:35], v101, s[48:51], s54 offen
s_mov_b32 s54, 688128
buffer_load_dwordx4 v[36:39], v101, s[48:51], s54 offen
s_mov_b32 s54, 720896
buffer_load_dwordx4 v[40:43], v101, s[48:51], s54 offen
s_mov_b32 s54, 753664
buffer_load_dwordx4 v[44:47], v101, s[48:51], s54 offen
s_barrier
s_cmp_lg_u32 s32, 0
s_cbranch_scc1 L_arr_10
v_mov_b32 v102, 4
v_mov_b32 v103, 1
s_mov_b64 exec, 1
global_atomic_add v102, v103, s[28:29]
s_mov_b64 exec, -1
L_arr_10:
s_waitcnt vmcnt(11)
ds_write_b128 v104, v[64:67] offset:16384
s_waitcnt vmcnt(10)
ds_write_b128 v104, v[68:71] offset:17408
s_waitcnt vmcnt(9)
ds_write_b128 v104, v[72:75] offset:18432
s_waitcnt vmcnt(8)
ds_write_b128 v104, v[76:79] offset:19456
s_waitcnt lgkmcnt(0)
s_barrier
ds_read2st64_b32 v[176:177], v105 offset0:64 offset1:72
ds_read2st64_b32 v[178:179], v105 offset0:65 offset1:73
ds_read2st64_b32 v[180:181], v106 offset0:64 offset1:72
ds_read2st64_b32 v[182:183], v106 offset0:65 offset1:73
ds_read2st64_b32 v[184:185], v107 offset0:64 offset1:72
ds_read2st64_b32 v[186:187], v107 offset0:65 offset1:73
ds_read2st64_b32 v[188:189], v108 offset0:64 offset1:72
ds_read2st64_b32 v[190:191], v108 offset0:65 offset1:73
s_waitcnt lgkmcnt(7)
v_perm_b32 v102, v177, v176, s52
v_accvgpr_write_b32 a102, v102
s_waitcnt lgkmcnt(6)
v_perm_b32 v103, v179, v178, s52
v_accvgpr_write_b32 a103, v103
v_perm_b32 v102, v177, v176, s53
v_accvgpr_write_b32 a110, v102
v_perm_b32 v103, v179, v178, s53
v_accvgpr_write_b32 a111, v103
s_waitcnt lgkmcnt(5)
v_perm_b32 v102, v181, v180, s52
v_accvgpr_write_b32 a118, v102
s_waitcnt lgkmcnt(4)
v_perm_b32 v103, v183, v182, s52
v_accvgpr_write_b32 a119, v103
v_perm_b32 v102, v181, v180, s53
v_accvgpr_write_b32 a126, v102
v_perm_b32 v103, v183, v182, s53
v_accvgpr_write_b32 a127, v103
s_waitcnt lgkmcnt(3)
v_perm_b32 v102, v185, v184, s52
v_accvgpr_write_b32 a134, v102
s_waitcnt lgkmcnt(2)
v_perm_b32 v103, v187, v186, s52
v_accvgpr_write_b32 a135, v103
v_perm_b32 v102, v185, v184, s53
v_accvgpr_write_b32 a142, v102
v_perm_b32 v103, v187, v186, s53
v_accvgpr_write_b32 a143, v103
s_waitcnt lgkmcnt(1)
v_perm_b32 v102, v189, v188, s52
v_accvgpr_write_b32 a150, v102
s_waitcnt lgkmcnt(0)
v_perm_b32 v103, v191, v190, s52
v_accvgpr_write_b32 a151, v103
v_perm_b32 v102, v189, v188, s53
v_accvgpr_write_b32 a158, v102
v_perm_b32 v103, v191, v190, s53
v_accvgpr_write_b32 a159, v103
s_mov_b32 s54, 2621440
buffer_load_dwordx4 v[48:51], v101, s[48:51], s54 offen
s_mov_b32 s54, 2654208
buffer_load_dwordx4 v[52:55], v101, s[48:51], s54 offen
s_mov_b32 s54, 2686976
buffer_load_dwordx4 v[56:59], v101, s[48:51], s54 offen
s_mov_b32 s54, 2719744
buffer_load_dwordx4 v[60:63], v101, s[48:51], s54 offen
s_waitcnt vmcnt(11)
ds_write_b128 v104, v[80:83] offset:0
s_waitcnt vmcnt(10)
ds_write_b128 v104, v[84:87] offset:1024
s_waitcnt vmcnt(9)
ds_write_b128 v104, v[88:91] offset:2048
s_waitcnt vmcnt(8)
ds_write_b128 v104, v[92:95] offset:3072
s_waitcnt lgkmcnt(0)
s_barrier
ds_read2st64_b32 v[176:177], v105 offset0:0 offset1:8
ds_read2st64_b32 v[178:179], v105 offset0:1 offset1:9
ds_read2st64_b32 v[180:181], v106 offset0:0 offset1:8
ds_read2st64_b32 v[182:183], v106 offset0:1 offset1:9
ds_read2st64_b32 v[184:185], v107 offset0:0 offset1:8
ds_read2st64_b32 v[186:187], v107 offset0:1 offset1:9
ds_read2st64_b32 v[188:189], v108 offset0:0 offset1:8
ds_read2st64_b32 v[190:191], v108 offset0:1 offset1:9
s_waitcnt lgkmcnt(7)
v_perm_b32 v102, v177, v176, s52
v_accvgpr_write_b32 a160, v102
s_waitcnt lgkmcnt(6)
v_perm_b32 v103, v179, v178, s52
v_accvgpr_write_b32 a161, v103
v_perm_b32 v102, v177, v176, s53
v_accvgpr_write_b32 a168, v102
v_perm_b32 v103, v179, v178, s53
v_accvgpr_write_b32 a169, v103
s_waitcnt lgkmcnt(5)
v_perm_b32 v116, v181, v180, s52
s_waitcnt lgkmcnt(4)
v_perm_b32 v117, v183, v182, s52
ds_write_b64 v9, v[116:117] offset:18432
v_perm_b32 v118, v181, v180, s53
v_perm_b32 v119, v183, v182, s53
ds_write_b64 v9, v[118:119] offset:20480
s_waitcnt lgkmcnt(5)
v_perm_b32 v102, v185, v184, s52
v_accvgpr_write_b32 a176, v102
s_waitcnt lgkmcnt(4)
v_perm_b32 v103, v187, v186, s52
v_accvgpr_write_b32 a177, v103
v_perm_b32 v102, v185, v184, s53
v_accvgpr_write_b32 a184, v102
v_perm_b32 v103, v187, v186, s53
v_accvgpr_write_b32 a185, v103
s_waitcnt lgkmcnt(3)
v_perm_b32 v102, v189, v188, s52
v_accvgpr_write_b32 a192, v102
s_waitcnt lgkmcnt(2)
v_perm_b32 v103, v191, v190, s52
v_accvgpr_write_b32 a193, v103
v_perm_b32 v102, v189, v188, s53
v_accvgpr_write_b32 a200, v102
v_perm_b32 v103, v191, v190, s53
v_accvgpr_write_b32 a201, v103
s_mov_b32 s54, 2752512
buffer_load_dwordx4 v[64:67], v101, s[48:51], s54 offen
s_mov_b32 s54, 2785280
buffer_load_dwordx4 v[68:71], v101, s[48:51], s54 offen
s_mov_b32 s54, 2818048
buffer_load_dwordx4 v[72:75], v101, s[48:51], s54 offen
s_mov_b32 s54, 2850816
buffer_load_dwordx4 v[76:79], v101, s[48:51], s54 offen
s_waitcnt vmcnt(11)
ds_write_b128 v104, v[32:35] offset:16384
s_waitcnt vmcnt(10)
ds_write_b128 v104, v[36:39] offset:17408
s_waitcnt vmcnt(9)
ds_write_b128 v104, v[40:43] offset:18432
s_waitcnt vmcnt(8)
ds_write_b128 v104, v[44:47] offset:19456
s_waitcnt lgkmcnt(0)
s_barrier
ds_read2st64_b32 v[176:177], v105 offset0:64 offset1:72
ds_read2st64_b32 v[178:179], v105 offset0:65 offset1:73
ds_read2st64_b32 v[180:181], v106 offset0:64 offset1:72
ds_read2st64_b32 v[182:183], v106 offset0:65 offset1:73
ds_read2st64_b32 v[184:185], v107 offset0:64 offset1:72
ds_read2st64_b32 v[186:187], v107 offset0:65 offset1:73
ds_read2st64_b32 v[188:189], v108 offset0:64 offset1:72
ds_read2st64_b32 v[190:191], v108 offset0:65 offset1:73
s_waitcnt lgkmcnt(7)
v_perm_b32 v102, v177, v176, s52
v_accvgpr_write_b32 a162, v102
s_waitcnt lgkmcnt(6)
v_perm_b32 v103, v179, v178, s52
v_accvgpr_write_b32 a163, v103
v_perm_b32 v102, v177, v176, s53
v_accvgpr_write_b32 a170, v102
v_perm_b32 v103, v179, v178, s53
v_accvgpr_write_b32 a171, v103
s_waitcnt lgkmcnt(5)
v_perm_b32 v116, v181, v180, s52
s_waitcnt lgkmcnt(4)
v_perm_b32 v117, v183, v182, s52
ds_write_b64 v9, v[116:117] offset:18440
v_perm_b32 v118, v181, v180, s53
v_perm_b32 v119, v183, v182, s53
ds_write_b64 v9, v[118:119] offset:20488
s_waitcnt lgkmcnt(5)
v_perm_b32 v102, v185, v184, s52
v_accvgpr_write_b32 a178, v102
s_waitcnt lgkmcnt(4)
v_perm_b32 v103, v187, v186, s52
v_accvgpr_write_b32 a179, v103
v_perm_b32 v102, v185, v184, s53
v_accvgpr_write_b32 a186, v102
v_perm_b32 v103, v187, v186, s53
v_accvgpr_write_b32 a187, v103
s_waitcnt lgkmcnt(3)
v_perm_b32 v102, v189, v188, s52
v_accvgpr_write_b32 a194, v102
s_waitcnt lgkmcnt(2)
v_perm_b32 v103, v191, v190, s52
v_accvgpr_write_b32 a195, v103
v_perm_b32 v102, v189, v188, s53
v_accvgpr_write_b32 a202, v102
v_perm_b32 v103, v191, v190, s53
v_accvgpr_write_b32 a203, v103
s_mov_b32 s54, 0
buffer_load_dwordx4 v[80:83], v101, s[44:47], s54 offen
s_mov_b32 s54, 32768
buffer_load_dwordx4 v[84:87], v101, s[44:47], s54 offen
s_mov_b32 s54, 65536
buffer_load_dwordx4 v[88:91], v101, s[44:47], s54 offen
s_mov_b32 s54, 98304
buffer_load_dwordx4 v[92:95], v101, s[44:47], s54 offen
s_waitcnt vmcnt(11)
ds_write_b128 v104, v[48:51] offset:0
s_waitcnt vmcnt(10)
ds_write_b128 v104, v[52:55] offset:1024
s_waitcnt vmcnt(9)
ds_write_b128 v104, v[56:59] offset:2048
s_waitcnt vmcnt(8)
ds_write_b128 v104, v[60:63] offset:3072
s_waitcnt lgkmcnt(0)
s_barrier
ds_read2st64_b32 v[176:177], v105 offset0:0 offset1:8
ds_read2st64_b32 v[178:179], v105 offset0:1 offset1:9
ds_read2st64_b32 v[180:181], v106 offset0:0 offset1:8
ds_read2st64_b32 v[182:183], v106 offset0:1 offset1:9
ds_read2st64_b32 v[184:185], v107 offset0:0 offset1:8
ds_read2st64_b32 v[186:187], v107 offset0:1 offset1:9
ds_read2st64_b32 v[188:189], v108 offset0:0 offset1:8
ds_read2st64_b32 v[190:191], v108 offset0:1 offset1:9
s_waitcnt lgkmcnt(7)
v_perm_b32 v102, v177, v176, s52
v_accvgpr_write_b32 a164, v102
s_waitcnt lgkmcnt(6)
v_perm_b32 v103, v179, v178, s52
v_accvgpr_write_b32 a165, v103
v_perm_b32 v102, v177, v176, s53
v_accvgpr_write_b32 a172, v102
v_perm_b32 v103, v179, v178, s53
v_accvgpr_write_b32 a173, v103
s_waitcnt lgkmcnt(5)
v_perm_b32 v116, v181, v180, s52
s_waitcnt lgkmcnt(4)
v_perm_b32 v117, v183, v182, s52
ds_write_b64 v9, v[116:117] offset:19456
v_perm_b32 v118, v181, v180, s53
v_perm_b32 v119, v183, v182, s53
ds_write_b64 v9, v[118:119] offset:21504
s_waitcnt lgkmcnt(5)
v_perm_b32 v102, v185, v184, s52
v_accvgpr_write_b32 a180, v102
s_waitcnt lgkmcnt(4)
v_perm_b32 v103, v187, v186, s52
v_accvgpr_write_b32 a181, v103
v_perm_b32 v102, v185, v184, s53
v_accvgpr_write_b32 a188, v102
v_perm_b32 v103, v187, v186, s53
v_accvgpr_write_b32 a189, v103
s_waitcnt lgkmcnt(3)
v_perm_b32 v102, v189, v188, s52
v_accvgpr_write_b32 a196, v102
s_waitcnt lgkmcnt(2)
v_perm_b32 v103, v191, v190, s52
v_accvgpr_write_b32 a197, v103
v_perm_b32 v102, v189, v188, s53
v_accvgpr_write_b32 a204, v102
v_perm_b32 v103, v191, v190, s53
v_accvgpr_write_b32 a205, v103
s_mov_b32 s54, 131072
buffer_load_dwordx4 v[208:211], v101, s[44:47], s54 offen
s_mov_b32 s54, 163840
buffer_load_dwordx4 v[212:215], v101, s[44:47], s54 offen
s_mov_b32 s54, 196608
buffer_load_dwordx4 v[216:219], v101, s[44:47], s54 offen
s_mov_b32 s54, 229376
buffer_load_dwordx4 v[220:223], v101, s[44:47], s54 offen
s_waitcnt vmcnt(11)
ds_write_b128 v104, v[64:67] offset:16384
s_waitcnt vmcnt(10)
ds_write_b128 v104, v[68:71] offset:17408
s_waitcnt vmcnt(9)
ds_write_b128 v104, v[72:75] offset:18432
s_waitcnt vmcnt(8)
ds_write_b128 v104, v[76:79] offset:19456
s_waitcnt lgkmcnt(0)
s_barrier
ds_read2st64_b32 v[176:177], v105 offset0:64 offset1:72
ds_read2st64_b32 v[178:179], v105 offset0:65 offset1:73
ds_read2st64_b32 v[180:181], v106 offset0:64 offset1:72
ds_read2st64_b32 v[182:183], v106 offset0:65 offset1:73
ds_read2st64_b32 v[184:185], v107 offset0:64 offset1:72
ds_read2st64_b32 v[186:187], v107 offset0:65 offset1:73
ds_read2st64_b32 v[188:189], v108 offset0:64 offset1:72
ds_read2st64_b32 v[190:191], v108 offset0:65 offset1:73
s_waitcnt lgkmcnt(7)
v_perm_b32 v102, v177, v176, s52
v_accvgpr_write_b32 a166, v102
s_waitcnt lgkmcnt(6)
v_perm_b32 v103, v179, v178, s52
v_accvgpr_write_b32 a167, v103
v_perm_b32 v102, v177, v176, s53
v_accvgpr_write_b32 a174, v102
v_perm_b32 v103, v179, v178, s53
v_accvgpr_write_b32 a175, v103
s_waitcnt lgkmcnt(5)
v_perm_b32 v116, v181, v180, s52
s_waitcnt lgkmcnt(4)
v_perm_b32 v117, v183, v182, s52
ds_write_b64 v9, v[116:117] offset:19464
v_perm_b32 v118, v181, v180, s53
v_perm_b32 v119, v183, v182, s53
ds_write_b64 v9, v[118:119] offset:21512
s_waitcnt lgkmcnt(5)
v_perm_b32 v102, v185, v184, s52
v_accvgpr_write_b32 a182, v102
s_waitcnt lgkmcnt(4)
v_perm_b32 v103, v187, v186, s52
v_accvgpr_write_b32 a183, v103
v_perm_b32 v102, v185, v184, s53
v_accvgpr_write_b32 a190, v102
v_perm_b32 v103, v187, v186, s53
v_accvgpr_write_b32 a191, v103
s_waitcnt lgkmcnt(3)
v_perm_b32 v102, v189, v188, s52
v_accvgpr_write_b32 a198, v102
s_waitcnt lgkmcnt(2)
v_perm_b32 v103, v191, v190, s52
v_accvgpr_write_b32 a199, v103
v_perm_b32 v102, v189, v188, s53
v_accvgpr_write_b32 a206, v102
v_perm_b32 v103, v191, v190, s53
v_accvgpr_write_b32 a207, v103
s_mov_b32 s54, 2097152
buffer_load_dwordx4 v[224:227], v101, s[44:47], s54 offen
s_mov_b32 s54, 2129920
buffer_load_dwordx4 v[228:231], v101, s[44:47], s54 offen
s_mov_b32 s54, 2162688
buffer_load_dwordx4 v[232:235], v101, s[44:47], s54 offen
s_mov_b32 s54, 2195456
buffer_load_dwordx4 v[236:239], v101, s[44:47], s54 offen
s_waitcnt vmcnt(11)
ds_write_b128 v104, v[80:83] offset:0
s_waitcnt vmcnt(10)
ds_write_b128 v104, v[84:87] offset:1024
s_waitcnt vmcnt(9)
ds_write_b128 v104, v[88:91] offset:2048
s_waitcnt vmcnt(8)
ds_write_b128 v104, v[92:95] offset:3072
s_waitcnt lgkmcnt(0)
s_barrier
ds_read2st64_b32 v[176:177], v105 offset0:0 offset1:8
ds_read2st64_b32 v[178:179], v105 offset0:1 offset1:9
ds_read2st64_b32 v[180:181], v106 offset0:0 offset1:8
ds_read2st64_b32 v[182:183], v106 offset0:1 offset1:9
ds_read2st64_b32 v[184:185], v107 offset0:0 offset1:8
ds_read2st64_b32 v[186:187], v107 offset0:1 offset1:9
ds_read2st64_b32 v[188:189], v108 offset0:0 offset1:8
ds_read2st64_b32 v[190:191], v108 offset0:1 offset1:9
s_waitcnt lgkmcnt(7)
v_perm_b32 v102, v177, v176, s52
v_accvgpr_write_b32 a208, v102
s_waitcnt lgkmcnt(6)
v_perm_b32 v103, v179, v178, s52
v_accvgpr_write_b32 a209, v103
v_perm_b32 v114, v177, v176, s53
v_perm_b32 v115, v179, v178, s53
ds_write_b64 v9, v[114:115] offset:0
s_waitcnt lgkmcnt(6)
v_perm_b32 v102, v181, v180, s52
v_accvgpr_write_b32 a216, v102
s_waitcnt lgkmcnt(5)
v_perm_b32 v103, v183, v182, s52
v_accvgpr_write_b32 a217, v103
v_perm_b32 v118, v181, v180, s53
v_perm_b32 v119, v183, v182, s53
ds_write_b64 v9, v[118:119] offset:14336
s_waitcnt lgkmcnt(5)
v_perm_b32 v102, v185, v184, s52
v_accvgpr_write_b32 a224, v102
s_waitcnt lgkmcnt(4)
v_perm_b32 v103, v187, v186, s52
v_accvgpr_write_b32 a225, v103
v_perm_b32 v102, v185, v184, s53
v_accvgpr_write_b32 a232, v102
v_perm_b32 v103, v187, v186, s53
v_accvgpr_write_b32 a233, v103
s_waitcnt lgkmcnt(3)
v_perm_b32 v102, v189, v188, s52
v_accvgpr_write_b32 a240, v102
s_waitcnt lgkmcnt(2)
v_perm_b32 v103, v191, v190, s52
v_accvgpr_write_b32 a241, v103
v_perm_b32 v102, v189, v188, s53
v_accvgpr_write_b32 a248, v102
v_perm_b32 v103, v191, v190, s53
v_accvgpr_write_b32 a249, v103
s_mov_b32 s54, 2228224
buffer_load_dwordx4 v[240:243], v101, s[44:47], s54 offen
s_mov_b32 s54, 2260992
buffer_load_dwordx4 v[244:247], v101, s[44:47], s54 offen
s_mov_b32 s54, 2293760
buffer_load_dwordx4 v[248:251], v101, s[44:47], s54 offen
s_mov_b32 s54, 2326528
buffer_load_dwordx4 v[252:255], v101, s[44:47], s54 offen
s_waitcnt vmcnt(11)
ds_write_b128 v104, v[208:211] offset:16384
s_waitcnt vmcnt(10)
ds_write_b128 v104, v[212:215] offset:17408
s_waitcnt vmcnt(9)
ds_write_b128 v104, v[216:219] offset:18432
s_waitcnt vmcnt(8)
ds_write_b128 v104, v[220:223] offset:19456
s_waitcnt lgkmcnt(0)
s_barrier
ds_read2st64_b32 v[176:177], v105 offset0:64 offset1:72
ds_read2st64_b32 v[178:179], v105 offset0:65 offset1:73
ds_read2st64_b32 v[180:181], v106 offset0:64 offset1:72
ds_read2st64_b32 v[182:183], v106 offset0:65 offset1:73
ds_read2st64_b32 v[184:185], v107 offset0:64 offset1:72
ds_read2st64_b32 v[186:187], v107 offset0:65 offset1:73
ds_read2st64_b32 v[188:189], v108 offset0:64 offset1:72
ds_read2st64_b32 v[190:191], v108 offset0:65 offset1:73
s_waitcnt lgkmcnt(7)
v_perm_b32 v102, v177, v176, s52
v_accvgpr_write_b32 a210, v102
s_waitcnt lgkmcnt(6)
v_perm_b32 v103, v179, v178, s52
v_accvgpr_write_b32 a211, v103
v_perm_b32 v114, v177, v176, s53
v_perm_b32 v115, v179, v178, s53
ds_write_b64 v9, v[114:115] offset:8
s_waitcnt lgkmcnt(6)
v_perm_b32 v102, v181, v180, s52
v_accvgpr_write_b32 a218, v102
s_waitcnt lgkmcnt(5)
v_perm_b32 v103, v183, v182, s52
v_accvgpr_write_b32 a219, v103
v_perm_b32 v118, v181, v180, s53
v_perm_b32 v119, v183, v182, s53
ds_write_b64 v9, v[118:119] offset:14344
s_waitcnt lgkmcnt(5)
v_perm_b32 v102, v185, v184, s52
v_accvgpr_write_b32 a226, v102
s_waitcnt lgkmcnt(4)
v_perm_b32 v103, v187, v186, s52
v_accvgpr_write_b32 a227, v103
v_perm_b32 v102, v185, v184, s53
v_accvgpr_write_b32 a234, v102
v_perm_b32 v103, v187, v186, s53
v_accvgpr_write_b32 a235, v103
s_waitcnt lgkmcnt(3)
v_perm_b32 v102, v189, v188, s52
v_accvgpr_write_b32 a242, v102
s_waitcnt lgkmcnt(2)
v_perm_b32 v103, v191, v190, s52
v_accvgpr_write_b32 a243, v103
v_perm_b32 v102, v189, v188, s53
v_accvgpr_write_b32 a250, v102
v_perm_b32 v103, v191, v190, s53
v_accvgpr_write_b32 a251, v103
s_mov_b32 s54, 524288
buffer_load_dwordx4 v[192:195], v101, s[44:47], s54 offen
s_mov_b32 s54, 557056
buffer_load_dwordx4 v[196:199], v101, s[44:47], s54 offen
s_mov_b32 s54, 589824
buffer_load_dwordx4 v[200:203], v101, s[44:47], s54 offen
s_mov_b32 s54, 622592
buffer_load_dwordx4 v[204:207], v101, s[44:47], s54 offen
s_waitcnt vmcnt(11)
ds_write_b128 v104, v[224:227] offset:0
s_waitcnt vmcnt(10)
ds_write_b128 v104, v[228:231] offset:1024
s_waitcnt vmcnt(9)
ds_write_b128 v104, v[232:235] offset:2048
s_waitcnt vmcnt(8)
ds_write_b128 v104, v[236:239] offset:3072
s_waitcnt lgkmcnt(0)
s_barrier
ds_read2st64_b32 v[176:177], v105 offset0:0 offset1:8
ds_read2st64_b32 v[178:179], v105 offset0:1 offset1:9
ds_read2st64_b32 v[180:181], v106 offset0:0 offset1:8
ds_read2st64_b32 v[182:183], v106 offset0:1 offset1:9
ds_read2st64_b32 v[184:185], v107 offset0:0 offset1:8
ds_read2st64_b32 v[186:187], v107 offset0:1 offset1:9
ds_read2st64_b32 v[188:189], v108 offset0:0 offset1:8
ds_read2st64_b32 v[190:191], v108 offset0:1 offset1:9
s_waitcnt lgkmcnt(7)
v_perm_b32 v102, v177, v176, s52
v_accvgpr_write_b32 a212, v102
s_waitcnt lgkmcnt(6)
v_perm_b32 v103, v179, v178, s52
v_accvgpr_write_b32 a213, v103
v_perm_b32 v114, v177, v176, s53
v_perm_b32 v115, v179, v178, s53
ds_write_b64 v9, v[114:115] offset:1024
s_waitcnt lgkmcnt(6)
v_perm_b32 v102, v181, v180, s52
v_accvgpr_write_b32 a220, v102
s_waitcnt lgkmcnt(5)
v_perm_b32 v103, v183, v182, s52
v_accvgpr_write_b32 a221, v103
v_perm_b32 v118, v181, v180, s53
v_perm_b32 v119, v183, v182, s53
ds_write_b64 v9, v[118:119] offset:15360
s_waitcnt lgkmcnt(5)
v_perm_b32 v102, v185, v184, s52
v_accvgpr_write_b32 a228, v102
s_waitcnt lgkmcnt(4)
v_perm_b32 v103, v187, v186, s52
v_accvgpr_write_b32 a229, v103
v_perm_b32 v102, v185, v184, s53
v_accvgpr_write_b32 a236, v102
v_perm_b32 v103, v187, v186, s53
v_accvgpr_write_b32 a237, v103
s_waitcnt lgkmcnt(3)
v_perm_b32 v102, v189, v188, s52
v_accvgpr_write_b32 a244, v102
s_waitcnt lgkmcnt(2)
v_perm_b32 v103, v191, v190, s52
v_accvgpr_write_b32 a245, v103
v_perm_b32 v102, v189, v188, s53
v_accvgpr_write_b32 a252, v102
v_perm_b32 v103, v191, v190, s53
v_accvgpr_write_b32 a253, v103
s_mov_b32 s54, 655360
buffer_load_dwordx4 v[208:211], v101, s[44:47], s54 offen
s_mov_b32 s54, 688128
buffer_load_dwordx4 v[212:215], v101, s[44:47], s54 offen
s_mov_b32 s54, 720896
buffer_load_dwordx4 v[216:219], v101, s[44:47], s54 offen
s_mov_b32 s54, 753664
buffer_load_dwordx4 v[220:223], v101, s[44:47], s54 offen
s_waitcnt vmcnt(11)
ds_write_b128 v104, v[240:243] offset:16384
s_waitcnt vmcnt(10)
ds_write_b128 v104, v[244:247] offset:17408
s_waitcnt vmcnt(9)
ds_write_b128 v104, v[248:251] offset:18432
s_waitcnt vmcnt(8)
ds_write_b128 v104, v[252:255] offset:19456
s_waitcnt lgkmcnt(0)
s_barrier
ds_read2st64_b32 v[176:177], v105 offset0:64 offset1:72
ds_read2st64_b32 v[178:179], v105 offset0:65 offset1:73
ds_read2st64_b32 v[180:181], v106 offset0:64 offset1:72
ds_read2st64_b32 v[182:183], v106 offset0:65 offset1:73
ds_read2st64_b32 v[184:185], v107 offset0:64 offset1:72
ds_read2st64_b32 v[186:187], v107 offset0:65 offset1:73
ds_read2st64_b32 v[188:189], v108 offset0:64 offset1:72
ds_read2st64_b32 v[190:191], v108 offset0:65 offset1:73
s_waitcnt lgkmcnt(7)
v_perm_b32 v102, v177, v176, s52
v_accvgpr_write_b32 a214, v102
s_waitcnt lgkmcnt(6)
v_perm_b32 v103, v179, v178, s52
v_accvgpr_write_b32 a215, v103
v_perm_b32 v114, v177, v176, s53
v_perm_b32 v115, v179, v178, s53
ds_write_b64 v9, v[114:115] offset:1032
s_waitcnt lgkmcnt(6)
v_perm_b32 v102, v181, v180, s52
v_accvgpr_write_b32 a222, v102
s_waitcnt lgkmcnt(5)
v_perm_b32 v103, v183, v182, s52
v_accvgpr_write_b32 a223, v103
v_perm_b32 v118, v181, v180, s53
v_perm_b32 v119, v183, v182, s53
ds_write_b64 v9, v[118:119] offset:15368
s_waitcnt lgkmcnt(5)
v_perm_b32 v102, v185, v184, s52
v_accvgpr_write_b32 a230, v102
s_waitcnt lgkmcnt(4)
v_perm_b32 v103, v187, v186, s52
v_accvgpr_write_b32 a231, v103
v_perm_b32 v102, v185, v184, s53
v_accvgpr_write_b32 a238, v102
v_perm_b32 v103, v187, v186, s53
v_accvgpr_write_b32 a239, v103
s_waitcnt lgkmcnt(3)
v_perm_b32 v102, v189, v188, s52
v_accvgpr_write_b32 a246, v102
s_waitcnt lgkmcnt(2)
v_perm_b32 v103, v191, v190, s52
v_accvgpr_write_b32 a247, v103
v_perm_b32 v102, v189, v188, s53
v_accvgpr_write_b32 a254, v102
v_perm_b32 v103, v191, v190, s53
v_accvgpr_write_b32 a255, v103
s_mov_b32 s54, 2621440
buffer_load_dwordx4 v[224:227], v101, s[44:47], s54 offen
s_mov_b32 s54, 2654208
buffer_load_dwordx4 v[228:231], v101, s[44:47], s54 offen
s_mov_b32 s54, 2686976
buffer_load_dwordx4 v[232:235], v101, s[44:47], s54 offen
s_mov_b32 s54, 2719744
buffer_load_dwordx4 v[236:239], v101, s[44:47], s54 offen
s_waitcnt vmcnt(11)
ds_write_b128 v104, v[192:195] offset:0
s_waitcnt vmcnt(10)
ds_write_b128 v104, v[196:199] offset:1024
s_waitcnt vmcnt(9)
ds_write_b128 v104, v[200:203] offset:2048
s_waitcnt vmcnt(8)
ds_write_b128 v104, v[204:207] offset:3072
s_waitcnt lgkmcnt(0)
s_barrier
ds_read2st64_b32 v[176:177], v105 offset0:0 offset1:8
ds_read2st64_b32 v[178:179], v105 offset0:1 offset1:9
ds_read2st64_b32 v[180:181], v106 offset0:0 offset1:8
ds_read2st64_b32 v[182:183], v106 offset0:1 offset1:9
ds_read2st64_b32 v[184:185], v107 offset0:0 offset1:8
ds_read2st64_b32 v[186:187], v107 offset0:1 offset1:9
ds_read2st64_b32 v[188:189], v108 offset0:0 offset1:8
ds_read2st64_b32 v[190:191], v108 offset0:1 offset1:9
s_waitcnt lgkmcnt(7)
v_perm_b32 v112, v177, v176, s52
s_waitcnt lgkmcnt(6)
v_perm_b32 v113, v179, v178, s52
ds_write_b64 v9, v[112:113] offset:2048
v_perm_b32 v114, v177, v176, s53
v_perm_b32 v115, v179, v178, s53
ds_write_b64 v9, v[114:115] offset:4096
s_waitcnt lgkmcnt(7)
v_perm_b32 v128, v181, v180, s52
s_waitcnt lgkmcnt(6)
v_perm_b32 v129, v183, v182, s52
v_perm_b32 v118, v181, v180, s53
v_perm_b32 v119, v183, v182, s53
ds_write_b64 v9, v[118:119] offset:16384
s_waitcnt lgkmcnt(6)
v_perm_b32 v136, v185, v184, s52
s_waitcnt lgkmcnt(5)
v_perm_b32 v137, v187, v186, s52
v_perm_b32 v144, v185, v184, s53
v_perm_b32 v145, v187, v186, s53
s_waitcnt lgkmcnt(4)
v_perm_b32 v152, v189, v188, s52
s_waitcnt lgkmcnt(3)
v_perm_b32 v153, v191, v190, s52
v_perm_b32 v160, v189, v188, s53
v_perm_b32 v161, v191, v190, s53
s_mov_b32 s54, 2752512
buffer_load_dwordx4 v[240:243], v101, s[44:47], s54 offen
s_mov_b32 s54, 2785280
buffer_load_dwordx4 v[244:247], v101, s[44:47], s54 offen
s_mov_b32 s54, 2818048
buffer_load_dwordx4 v[248:251], v101, s[44:47], s54 offen
s_mov_b32 s54, 2850816
buffer_load_dwordx4 v[252:255], v101, s[44:47], s54 offen
s_waitcnt vmcnt(11)
ds_write_b128 v104, v[208:211] offset:16384
s_waitcnt vmcnt(10)
ds_write_b128 v104, v[212:215] offset:17408
s_waitcnt vmcnt(9)
ds_write_b128 v104, v[216:219] offset:18432
s_waitcnt vmcnt(8)
ds_write_b128 v104, v[220:223] offset:19456
s_waitcnt lgkmcnt(0)
s_barrier
ds_read2st64_b32 v[176:177], v105 offset0:64 offset1:72
ds_read2st64_b32 v[178:179], v105 offset0:65 offset1:73
ds_read2st64_b32 v[180:181], v106 offset0:64 offset1:72
ds_read2st64_b32 v[182:183], v106 offset0:65 offset1:73
ds_read2st64_b32 v[184:185], v107 offset0:64 offset1:72
ds_read2st64_b32 v[186:187], v107 offset0:65 offset1:73
ds_read2st64_b32 v[188:189], v108 offset0:64 offset1:72
ds_read2st64_b32 v[190:191], v108 offset0:65 offset1:73
s_waitcnt lgkmcnt(7)
v_perm_b32 v112, v177, v176, s52
s_waitcnt lgkmcnt(6)
v_perm_b32 v113, v179, v178, s52
ds_write_b64 v9, v[112:113] offset:2056
v_perm_b32 v114, v177, v176, s53
v_perm_b32 v115, v179, v178, s53
ds_write_b64 v9, v[114:115] offset:4104
s_waitcnt lgkmcnt(7)
v_perm_b32 v130, v181, v180, s52
s_waitcnt lgkmcnt(6)
v_perm_b32 v131, v183, v182, s52
v_perm_b32 v118, v181, v180, s53
v_perm_b32 v119, v183, v182, s53
ds_write_b64 v9, v[118:119] offset:16392
s_waitcnt lgkmcnt(6)
v_perm_b32 v138, v185, v184, s52
s_waitcnt lgkmcnt(5)
v_perm_b32 v139, v187, v186, s52
v_perm_b32 v146, v185, v184, s53
v_perm_b32 v147, v187, v186, s53
s_waitcnt lgkmcnt(4)
v_perm_b32 v154, v189, v188, s52
s_waitcnt lgkmcnt(3)
v_perm_b32 v155, v191, v190, s52
v_perm_b32 v162, v189, v188, s53
v_perm_b32 v163, v191, v190, s53
s_add_u32 s54, s56, 0
buffer_load_dwordx4 v[32:35], v100, s[40:43], s54 offen
buffer_load_dwordx4 v[36:39], v100, s[40:43], s54 offen offset:1024
s_add_u32 s54, s56, 2048
buffer_load_dwordx4 v[40:43], v100, s[40:43], s54 offen
buffer_load_dwordx4 v[44:47], v100, s[40:43], s54 offen offset:1024
s_add_u32 s54, s56, 16384
buffer_load_dwordx4 v[48:51], v100, s[40:43], s54 offen
buffer_load_dwordx4 v[52:55], v100, s[40:43], s54 offen offset:1024
s_add_u32 s54, s56, 18432
buffer_load_dwordx4 v[56:59], v100, s[40:43], s54 offen
buffer_load_dwordx4 v[60:63], v100, s[40:43], s54 offen offset:1024
s_waitcnt vmcnt(15)
ds_write_b128 v104, v[224:227] offset:0
s_waitcnt vmcnt(14)
ds_write_b128 v104, v[228:231] offset:1024
s_waitcnt vmcnt(13)
ds_write_b128 v104, v[232:235] offset:2048
s_waitcnt vmcnt(12)
ds_write_b128 v104, v[236:239] offset:3072
s_waitcnt lgkmcnt(0)
s_barrier
ds_read2st64_b32 v[176:177], v105 offset0:0 offset1:8
ds_read2st64_b32 v[178:179], v105 offset0:1 offset1:9
ds_read2st64_b32 v[180:181], v106 offset0:0 offset1:8
ds_read2st64_b32 v[182:183], v106 offset0:1 offset1:9
ds_read2st64_b32 v[184:185], v107 offset0:0 offset1:8
ds_read2st64_b32 v[186:187], v107 offset0:1 offset1:9
ds_read2st64_b32 v[188:189], v108 offset0:0 offset1:8
ds_read2st64_b32 v[190:191], v108 offset0:1 offset1:9
s_waitcnt lgkmcnt(7)
v_perm_b32 v112, v177, v176, s52
s_waitcnt lgkmcnt(6)
v_perm_b32 v113, v179, v178, s52
ds_write_b64 v9, v[112:113] offset:3072
v_perm_b32 v114, v177, v176, s53
v_perm_b32 v115, v179, v178, s53
ds_write_b64 v9, v[114:115] offset:5120
s_waitcnt lgkmcnt(7)
v_perm_b32 v132, v181, v180, s52
s_waitcnt lgkmcnt(6)
v_perm_b32 v133, v183, v182, s52
v_perm_b32 v118, v181, v180, s53
v_perm_b32 v119, v183, v182, s53
ds_write_b64 v9, v[118:119] offset:17408
s_waitcnt lgkmcnt(6)
v_perm_b32 v140, v185, v184, s52
s_waitcnt lgkmcnt(5)
v_perm_b32 v141, v187, v186, s52
v_perm_b32 v148, v185, v184, s53
v_perm_b32 v149, v187, v186, s53
s_waitcnt lgkmcnt(4)
v_perm_b32 v156, v189, v188, s52
s_waitcnt lgkmcnt(3)
v_perm_b32 v157, v191, v190, s52
v_perm_b32 v164, v189, v188, s53
v_perm_b32 v165, v191, v190, s53
s_waitcnt vmcnt(11)
ds_write_b128 v104, v[240:243] offset:16384
s_waitcnt vmcnt(10)
ds_write_b128 v104, v[244:247] offset:17408
s_waitcnt vmcnt(9)
ds_write_b128 v104, v[248:251] offset:18432
s_waitcnt vmcnt(8)
ds_write_b128 v104, v[252:255] offset:19456
s_waitcnt lgkmcnt(0)
s_barrier
ds_read2st64_b32 v[176:177], v105 offset0:64 offset1:72
ds_read2st64_b32 v[178:179], v105 offset0:65 offset1:73
ds_read2st64_b32 v[180:181], v106 offset0:64 offset1:72
ds_read2st64_b32 v[182:183], v106 offset0:65 offset1:73
ds_read2st64_b32 v[184:185], v107 offset0:64 offset1:72
ds_read2st64_b32 v[186:187], v107 offset0:65 offset1:73
ds_read2st64_b32 v[188:189], v108 offset0:64 offset1:72
ds_read2st64_b32 v[190:191], v108 offset0:65 offset1:73
s_waitcnt lgkmcnt(7)
v_perm_b32 v112, v177, v176, s52
s_waitcnt lgkmcnt(6)
v_perm_b32 v113, v179, v178, s52
ds_write_b64 v9, v[112:113] offset:3080
v_perm_b32 v114, v177, v176, s53
v_perm_b32 v115, v179, v178, s53
ds_write_b64 v9, v[114:115] offset:5128
s_waitcnt lgkmcnt(7)
v_perm_b32 v134, v181, v180, s52
s_waitcnt lgkmcnt(6)
v_perm_b32 v135, v183, v182, s52
v_perm_b32 v118, v181, v180, s53
v_perm_b32 v119, v183, v182, s53
ds_write_b64 v9, v[118:119] offset:17416
s_waitcnt lgkmcnt(6)
v_perm_b32 v142, v185, v184, s52
s_waitcnt lgkmcnt(5)
v_perm_b32 v143, v187, v186, s52
v_perm_b32 v150, v185, v184, s53
v_perm_b32 v151, v187, v186, s53
s_waitcnt lgkmcnt(4)
v_perm_b32 v158, v189, v188, s52
s_waitcnt lgkmcnt(3)
v_perm_b32 v159, v191, v190, s52
v_perm_b32 v166, v189, v188, s53
v_perm_b32 v167, v191, v190, s53
v_mov_b32 v98, 0
global_load_dword v96, v98, s[28:29] offset:4 sc1
global_load_dword v97, v98, s[28:29] offset:192 sc1
s_add_u32 s54, s57, 0
buffer_load_dwordx4 v[64:67], v100, s[40:43], s54 offen
buffer_load_dwordx4 v[68:71], v100, s[40:43], s54 offen offset:1024
s_add_u32 s54, s57, 2048
buffer_load_dwordx4 v[72:75], v100, s[40:43], s54 offen
buffer_load_dwordx4 v[76:79], v100, s[40:43], s54 offen offset:1024
s_add_u32 s54, s57, 16384
buffer_load_dwordx4 v[80:83], v100, s[40:43], s54 offen
buffer_load_dwordx4 v[84:87], v100, s[40:43], s54 offen offset:1024
s_add_u32 s54, s57, 18432
buffer_load_dwordx4 v[88:91], v100, s[40:43], s54 offen
buffer_load_dwordx4 v[92:95], v100, s[40:43], s54 offen offset:1024
s_waitcnt vmcnt(16)
v_perm_b32 v112, v36, v32, s52
v_perm_b32 v113, v36, v32, s53
s_waitcnt vmcnt(14)
v_perm_b32 v114, v44, v40, s52
v_perm_b32 v115, v44, v40, s53
s_waitcnt vmcnt(12)
v_perm_b32 v116, v52, v48, s52
v_perm_b32 v117, v52, v48, s53
s_waitcnt vmcnt(10)
v_perm_b32 v118, v60, v56, s52
v_perm_b32 v119, v60, v56, s53
ds_write_b128 v9, v[112:115] offset:22528
ds_write_b128 v9, v[116:119] offset:23552
v_perm_b32 v120, v37, v33, s52
v_perm_b32 v121, v37, v33, s53
v_perm_b32 v122, v45, v41, s52
v_perm_b32 v123, v45, v41, s53
v_perm_b32 v124, v53, v49, s52
v_perm_b32 v125, v53, v49, s53
v_perm_b32 v126, v61, v57, s52
v_perm_b32 v127, v61, v57, s53
ds_write_b128 v9, v[120:123] offset:24576
ds_write_b128 v9, v[124:127] offset:25600
v_perm_b32 v168, v38, v34, s52
v_perm_b32 v169, v38, v34, s53
v_perm_b32 v170, v46, v42, s52
v_perm_b32 v171, v46, v42, s53
v_perm_b32 v172, v54, v50, s52
v_perm_b32 v173, v54, v50, s53
v_perm_b32 v174, v62, v58, s52
v_perm_b32 v175, v62, v58, s53
v_perm_b32 v176, v39, v35, s52
v_perm_b32 v177, v39, v35, s53
v_perm_b32 v178, v47, v43, s52
v_perm_b32 v179, v47, v43, s53
v_perm_b32 v180, v55, v51, s52
v_perm_b32 v181, v55, v51, s53
v_perm_b32 v182, v63, v59, s52
v_perm_b32 v183, v63, v59, s53
s_waitcnt lgkmcnt(0)
s_add_u32 s54, s58, 0
buffer_load_dwordx4 v[32:35], v100, s[40:43], s54 offen
buffer_load_dwordx4 v[36:39], v100, s[40:43], s54 offen offset:1024
s_add_u32 s54, s58, 2048
buffer_load_dwordx4 v[40:43], v100, s[40:43], s54 offen
buffer_load_dwordx4 v[44:47], v100, s[40:43], s54 offen offset:1024
s_add_u32 s54, s58, 16384
buffer_load_dwordx4 v[48:51], v100, s[40:43], s54 offen
buffer_load_dwordx4 v[52:55], v100, s[40:43], s54 offen offset:1024
s_add_u32 s54, s58, 18432
buffer_load_dwordx4 v[56:59], v100, s[40:43], s54 offen
buffer_load_dwordx4 v[60:63], v100, s[40:43], s54 offen offset:1024
s_waitcnt vmcnt(14)
v_perm_b32 v184, v68, v64, s52
v_perm_b32 v185, v68, v64, s53
s_waitcnt vmcnt(12)
v_perm_b32 v186, v76, v72, s52
v_perm_b32 v187, v76, v72, s53
s_waitcnt vmcnt(10)
v_perm_b32 v188, v84, v80, s52
v_perm_b32 v189, v84, v80, s53
s_waitcnt vmcnt(8)
v_perm_b32 v190, v92, v88, s52
v_perm_b32 v191, v92, v88, s53
v_perm_b32 v208, v69, v65, s52
v_perm_b32 v209, v69, v65, s53
v_perm_b32 v210, v77, v73, s52
v_perm_b32 v211, v77, v73, s53
v_perm_b32 v212, v85, v81, s52
v_perm_b32 v213, v85, v81, s53
v_perm_b32 v214, v93, v89, s52
v_perm_b32 v215, v93, v89, s53
v_perm_b32 v232, v70, v66, s52
v_perm_b32 v233, v70, v66, s53
v_perm_b32 v234, v78, v74, s52
v_perm_b32 v235, v78, v74, s53
v_perm_b32 v236, v86, v82, s52
v_perm_b32 v237, v86, v82, s53
v_perm_b32 v238, v94, v90, s52
v_perm_b32 v239, v94, v90, s53
v_perm_b32 v120, v71, v67, s52
v_perm_b32 v121, v71, v67, s53
v_perm_b32 v122, v79, v75, s52
v_perm_b32 v123, v79, v75, s53
v_perm_b32 v124, v87, v83, s52
v_perm_b32 v125, v87, v83, s53
v_perm_b32 v126, v95, v91, s52
v_perm_b32 v127, v95, v91, s53
ds_write_b128 v9, v[120:123] offset:26624
ds_write_b128 v9, v[124:127] offset:27648
s_waitcnt lgkmcnt(0)
s_add_u32 s54, s59, 0
buffer_load_dwordx4 v[64:67], v100, s[40:43], s54 offen
buffer_load_dwordx4 v[68:71], v100, s[40:43], s54 offen offset:1024
s_add_u32 s54, s59, 2048
buffer_load_dwordx4 v[72:75], v100, s[40:43], s54 offen
buffer_load_dwordx4 v[76:79], v100, s[40:43], s54 offen offset:1024
s_add_u32 s54, s59, 16384
buffer_load_dwordx4 v[80:83], v100, s[40:43], s54 offen
buffer_load_dwordx4 v[84:87], v100, s[40:43], s54 offen offset:1024
s_add_u32 s54, s59, 18432
buffer_load_dwordx4 v[88:91], v100, s[40:43], s54 offen
buffer_load_dwordx4 v[92:95], v100, s[40:43], s54 offen offset:1024
v_cmp_gt_u32 vcc, 32, v96
v_cmp_gt_u32 s[76:77], s88, v97
s_nop 0
s_or_b64 vcc, vcc, s[76:77]
s_cbranch_vccz L_cok
v_mov_b32 v96, 4
L_wc_11:
global_load_dword v97, v96, s[28:29] sc1
s_waitcnt vmcnt(0)
v_readfirstlane_b32 s54, v97
s_nop 0
s_cmp_ge_u32 s54, 32
s_cbranch_scc1 L_wcd_12
s_add_u32 s35, s35, 1
s_cmp_gt_u32 s35, 131072
s_cbranch_scc1 L_END
s_sleep 2
s_branch L_wc_11
L_wcd_12:
v_mov_b32 v96, 192
L_wc_13:
global_load_dword v97, v96, s[28:29] sc1
s_waitcnt vmcnt(0)
v_readfirstlane_b32 s54, v97
s_nop 0
s_cmp_ge_u32 s54, 128
s_cbranch_scc1 L_wcd_14
s_add_u32 s35, s35, 1
s_cmp_gt_u32 s35, 131072
s_cbranch_scc1 L_END
s_sleep 2
s_branch L_wc_13
L_wcd_14:
L_cok:
s_waitcnt vmcnt(14)
v_perm_b32 v192, v36, v32, s52
v_perm_b32 v193, v36, v32, s53
s_waitcnt vmcnt(12)
v_perm_b32 v194, v44, v40, s52
v_perm_b32 v195, v44, v40, s53
s_waitcnt vmcnt(10)
v_perm_b32 v196, v52, v48, s52
v_perm_b32 v197, v52, v48, s53
s_waitcnt vmcnt(8)
v_perm_b32 v198, v60, v56, s52
v_perm_b32 v199, v60, v56, s53
v_perm_b32 v216, v37, v33, s52
v_perm_b32 v217, v37, v33, s53
v_perm_b32 v218, v45, v41, s52
v_perm_b32 v219, v45, v41, s53
v_perm_b32 v220, v53, v49, s52
v_perm_b32 v221, v53, v49, s53
v_perm_b32 v222, v61, v57, s52
v_perm_b32 v223, v61, v57, s53
v_perm_b32 v240, v38, v34, s52
v_perm_b32 v241, v38, v34, s53
v_perm_b32 v242, v46, v42, s52
v_perm_b32 v243, v46, v42, s53
v_perm_b32 v244, v54, v50, s52
v_perm_b32 v245, v54, v50, s53
v_perm_b32 v246, v62, v58, s52
v_perm_b32 v247, v62, v58, s53
v_perm_b32 v120, v39, v35, s52
v_perm_b32 v121, v39, v35, s53
v_perm_b32 v122, v47, v43, s52
v_perm_b32 v123, v47, v43, s53
v_perm_b32 v124, v55, v51, s52
v_perm_b32 v125, v55, v51, s53
v_perm_b32 v126, v63, v59, s52
v_perm_b32 v127, v63, v59, s53
ds_write_b128 v9, v[120:123] offset:28672
ds_write_b128 v9, v[124:127] offset:29696
s_waitcnt lgkmcnt(0)
buffer_load_dwordx2 v[22:23], off, s[36:39], s71 sc1
s_waitcnt vmcnt(7)
v_perm_b32 v200, v68, v64, s52
v_perm_b32 v201, v68, v64, s53
s_waitcnt vmcnt(5)
v_perm_b32 v202, v76, v72, s52
v_perm_b32 v203, v76, v72, s53
s_waitcnt vmcnt(3)
v_perm_b32 v204, v84, v80, s52
v_perm_b32 v205, v84, v80, s53
s_waitcnt vmcnt(1)
v_perm_b32 v206, v92, v88, s52
v_perm_b32 v207, v92, v88, s53
v_perm_b32 v224, v69, v65, s52
v_perm_b32 v225, v69, v65, s53
v_perm_b32 v226, v77, v73, s52
v_perm_b32 v227, v77, v73, s53
v_perm_b32 v228, v85, v81, s52
v_perm_b32 v229, v85, v81, s53
v_perm_b32 v230, v93, v89, s52
v_perm_b32 v231, v93, v89, s53
v_perm_b32 v248, v70, v66, s52
v_perm_b32 v249, v70, v66, s53
v_perm_b32 v250, v78, v74, s52
v_perm_b32 v251, v78, v74, s53
v_perm_b32 v252, v86, v82, s52
v_perm_b32 v253, v86, v82, s53
v_perm_b32 v254, v94, v90, s52
v_perm_b32 v255, v94, v90, s53
v_perm_b32 v120, v71, v67, s52
v_perm_b32 v121, v71, v67, s53
v_perm_b32 v122, v79, v75, s52
v_perm_b32 v123, v79, v75, s53
v_perm_b32 v124, v87, v83, s52
v_perm_b32 v125, v87, v83, s53
v_perm_b32 v126, v95, v91, s52
v_perm_b32 v127, v95, v91, s53
ds_write_b128 v9, v[120:123] offset:30720
ds_write_b128 v9, v[124:127] offset:31744
s_waitcnt lgkmcnt(0)
L_pre:
s_waitcnt lgkmcnt(0)
s_barrier
ds_write_b128 v5, a[208:211] offset:22528
ds_write_b128 v5, a[212:215] offset:23552
ds_write_b128 v5, v[24:27] offset:15360
s_mov_b32 s50, 0x3f803f80
s_mov_b32 s51, 0x3f803f80
v_mov_b32 v104, 0
v_mov_b32 v105, 0
v_mov_b32 v106, 0
v_mov_b32 v107, 0
v_mov_b32 v101, 144384
ds_write_b128 v101, v[104:107]
s_waitcnt lgkmcnt(0)
s_waitcnt vmcnt(0)
v_min_u32 v22, v22, v23
v_cmp_eq_u32 vcc, 0, v22
s_cbranch_vccz L_f01
L_fs_15:
buffer_load_dword v21, off, s[36:39], s71 offset:0 sc1
s_waitcnt vmcnt(0)
v_cmp_eq_u32 vcc, 0, v21
s_cbranch_vccz L_fsd_16
s_add_u32 s35, s35, 1
s_cmp_gt_u32 s35, 131072
s_cbranch_scc1 L_END
s_sleep 1
s_branch L_fs_15
L_fsd_16:
L_fs_17:
buffer_load_dword v21, off, s[36:39], s71 offset:4 sc1
s_waitcnt vmcnt(0)
v_cmp_eq_u32 vcc, 0, v21
s_cbranch_vccz L_fsd_18
s_add_u32 s35, s35, 1
s_cmp_gt_u32 s35, 131072
s_cbranch_scc1 L_END
s_sleep 1
s_branch L_fs_17
L_fsd_18:
L_f01:
s_add_u32 s71, s71, 8
s_barrier
ds_read_b128 v[88:91], v9 offset:0
ds_read_b128 v[92:95], v9 offset:1024
ds_read_b128 v[96:99], v9 offset:4096
ds_read_b128 v[100:103], v9 offset:5120
ds_read_b128 v[112:115], v9 offset:8192
ds_read_b128 v[116:119], v9 offset:9216
ds_read_b128 v[120:123], v9 offset:12288
ds_read_b128 v[124:127], v9 offset:13312
ds_read_b128 v[40:43], v9 offset:2048
ds_read_b128 v[44:47], v9 offset:3072
ds_read_b128 v[56:59], v9 offset:10240
ds_read_b128 v[60:63], v9 offset:11264
s_waitcnt lgkmcnt(0)
ds_read_b128 v[80:83], v9 offset:14336
ds_read_b128 v[84:87], v9 offset:15360
ds_read_b128 v[24:27], v9 offset:16384
ds_read_b128 v[28:31], v9 offset:17408
v_mov_b64 v[64:65], 0
v_mov_b64 v[66:67], 0
v_mov_b64 v[68:69], 0
v_mov_b64 v[70:71], 0
v_mov_b64 v[72:73], 0
v_mov_b64 v[74:75], 0
v_mov_b64 v[76:77], 0
v_mov_b64 v[78:79], 0
s_mov_b32 s74, 0x10000
s_mov_b32 s75, 0
s_mov_b32 s57, 0
v_mov_b32 v17, s68
v_mov_b32 v18, 0xfffe0000
v_mov_b32 v21, 1
v_mov_b32 v16, 0x10000000
v_mov_b32 v108, v4
v_mov_b32 v4, 0x10000000
v_mov_b64 v[22:23], 0
s_mov_b64 exec, 1
v_mov_b32 v16, 0
s_mov_b64 exec, s[72:73]
v_mov_b32 v4, v108
s_mov_b64 exec, -1
s_mov_b32 s58, 0
s_mov_b32 s48, s69
s_mov_b32 s49, s69
s_waitcnt lgkmcnt(0)
s_xor_b32 s63, s63, 0x10000
s_bfe_u32 s57, s67, 0x10001
s_lshl_b32 s75, 0x8000, s57
s_lshl_b32 s74, 0xffff0000, s57
v_mov_b32 v18, s74
s_add_u32 s55, s65, 0x80000
s_add_u32 s56, s66, 0x40000
.p2align 6
s_cmp_lt_u32 s32, 2
s_cbranch_scc1 L_stepe
L_step:
buffer_load_dwordx4 v[32:35], v0, s[36:39], s64 offen offset:0 sc1
buffer_load_dwordx4 v[36:39], v0, s[36:39], s64 offen offset:1024 sc1
ds_read_b128 v[24:27], v9 offset:16384
ds_read_b128 v[28:31], v9 offset:17408
ds_read_b128 v[80:83], v9 offset:14336
ds_read_b128 v[84:87], v9 offset:15360
ds_read_b128 a[208:211], v5 offset:22528
ds_read_b128 a[212:215], v5 offset:23552
ds_read_b128 v[56:59], v9 offset:10240
ds_read_b128 v[60:63], v9 offset:11264
s_nop 0
s_nop 0
s_nop 0
s_nop 0
s_nop 0
s_nop 10
s_nop 0
s_nop 0
buffer_load_dwordx4 v[32:35], v0, s[36:39], s64 offen offset:0 sc1
buffer_load_dwordx4 v[36:39], v0, s[36:39], s64 offen offset:1024 sc1
s_waitcnt vmcnt(4) lgkmcnt(0)
ds_read_b128 v[48:51], v9 offset:6144
ds_read_b128 v[52:55], v9 offset:7168
s_waitcnt vmcnt(3)
v_max3_u32 v108, v32, v33, v34
v_max_u32 v108, v108, v35
s_waitcnt vmcnt(2)
v_max3_u32 v108, v108, v36, v37
v_max3_u32 v108, v108, v38, v39
v_cmp_le_u32 vcc, s68, v108
s_cbranch_vccnz L_f2
L_ok2:
ds_write_b64 v5, v[32:33] offset:0
v_smfmac_f32_16x16x64_bf16 v[72:75], v[32:35], a[208:215], v2
ds_write_b64 v5, v[34:35] offset:8
v_smfmac_f32_16x16x64_bf16 v[76:79], v[32:35], v[88:95], v2
ds_write_b64 v5, v[36:37] offset:1024
v_smfmac_f32_16x16x64_bf16 v[72:75], v[36:39], v[40:47], v2
ds_write_b64 v5, v[38:39] offset:1032
buffer_store_dword v17, v4, s[36:39], s63 offen
v_smfmac_f32_16x16x64_bf16 v[76:79], v[36:39], v[96:103], v2
buffer_load_dwordx4 v[88:91], v0, s[36:39], s65 offen offset:0 sc1
L_hb:
s_barrier
s_waitcnt lgkmcnt(4)
v_smfmac_f32_16x16x64_bf16 v[64:67], v[32:35], v[48:55], v2
ds_read_b128 v[40:43], v6 offset:0
buffer_load_dwordx4 v[92:95], v0, s[36:39], s65 offen offset:1024 sc1
v_smfmac_f32_16x16x64_bf16 v[68:71], v[32:35], v[112:119], v2
ds_read_b128 v[44:47], v6 offset:1024
buffer_load_dwordx4 v[96:99], v0, s[36:39], s65 offen offset:2048 sc1
v_smfmac_f32_16x16x64_bf16 v[64:67], v[36:39], v[56:63], v2
buffer_load_dwordx4 v[100:103], v0, s[36:39], s65 offen offset:3072 sc1
v_smfmac_f32_16x16x64_bf16 v[68:71], v[36:39], v[120:127], v2
L_join2:
s_waitcnt lgkmcnt(2)
s_barrier
ds_read_b128 v[48:51], v7 offset:0
s_waitcnt lgkmcnt(2)
v_smfmac_f32_16x16x64_bf16 v[72:75], v[40:43], a[216:223], v2
buffer_store_dword v110, v11, s[36:39], s66 offen offset:0 sc1
v_smfmac_f32_16x16x64_bf16 v[76:79], v[40:43], v[80:87], v2
ds_read_b128 v[52:55], v7 offset:1024
v_mov_b32 v104, s58
s_waitcnt lgkmcnt(2)
v_smfmac_f32_16x16x64_bf16 v[72:75], v[44:47], v[128:135], v2
s_cmp_eq_u32 s67, 63
ds_read_b128 v[56:59], v8 offset:0
v_mov_b32 v108, 0xff800000
v_smfmac_f32_16x16x64_bf16 v[76:79], v[44:47], v[24:31], v2
buffer_store_dword v111, v11, s[36:39], s66 offen offset:64 sc1
s_waitcnt lgkmcnt(2)
v_smfmac_f32_16x16x64_bf16 v[72:75], v[48:51], a[224:231], v2
ds_read_b128 v[60:63], v8 offset:1024
v_mov_b32 v109, 0xff800000
v_smfmac_f32_16x16x64_bf16 v[76:79], v[48:51], a[232:239], v2
buffer_store_dwordx2 v[22:23], v1, s[36:39], s66 offen offset:1024 sc1
s_waitcnt lgkmcnt(2)
v_smfmac_f32_16x16x64_bf16 v[72:75], v[52:55], v[136:143], v2
s_nop 0
ds_read_b128 v[112:115], v9 offset:20480
v_mov_b64 v[80:81], 0
v_smfmac_f32_16x16x64_bf16 v[76:79], v[52:55], v[144:151], v2
s_waitcnt lgkmcnt(2)
v_smfmac_f32_16x16x64_bf16 v[72:75], v[56:59], a[240:247], v2
s_nop 0
v_mov_b64_e64 v[82:83], 0
v_smfmac_f32_16x16x64_bf16 v[68:71], v[40:43], a[8:15], v2
s_nop 0
buffer_store_dword v104, v16, s[36:39], s70 offen sc1
v_smfmac_f32_16x16x64_bf16 v[76:79], v[56:59], a[248:255], v2
ds_read_b128 v[120:123], v9 offset:18432
s_waitcnt lgkmcnt(2)
v_smfmac_f32_16x16x64_bf16 v[72:75], v[60:63], v[152:159], v2
v_mov_b64_e64 v[84:85], 0
v_smfmac_f32_16x16x64_bf16 v[76:79], v[60:63], v[160:167], v2
buffer_load_dword v21, off, s[36:39], s71 sc1
v_smfmac_f32_16x16x64_bf16 v[64:67], v[40:43], a[0:7], v2
ds_read_b128 v[124:127], v9 offset:19456
v_mov_b64 v[86:87], 0
v_add_f32 v73, v73, v75
v_add_f32_e64 v72, v72, v74
v_smfmac_f32_16x16x64_bf16 v[68:71], v[44:47], a[56:63], v2
v_add_f32 v76, v76, v78
v_add_f32 v77, v77, v79
v_smfmac_f32_16x16x64_bf16 v[64:67], v[44:47], a[48:55], v2
v_cvt_pk_bf16_f32 v75, v73, v77
v_smfmac_f32_16x16x64_bf16 v[64:67], v[56:59], a[32:39], v2
v_cvt_pk_bf16_f32 v74, v72, v76
v_smfmac_f32_16x16x64_bf16 v[64:67], v[48:51], a[16:23], v2
ds_write2_b32 v10, v74, v75 offset0:160 offset1:164
v_smfmac_f32_16x16x64_bf16 v[68:71], v[48:51], a[24:31], v2
buffer_load_dword v20, v19, s[36:39], s55 offen sc1
v_smfmac_f32_16x16x64_bf16 v[64:67], v[52:55], a[64:71], v2
ds_read_b128 v[76:79], v13
ds_read_b128 v[72:75], v12
v_smfmac_f32_16x16x64_bf16 v[68:71], v[52:55], a[72:79], v2
s_waitcnt vmcnt(6)
v_mov_b64 v[28:29], s[50:51]
v_smfmac_f32_16x16x64_bf16 v[68:71], v[56:59], a[40:47], v2
s_waitcnt lgkmcnt(2)
s_barrier
v_smfmac_f32_16x16x64_bf16 v[64:67], v[60:63], a[80:87], v2
v_smfmac_f32_16x16x64_bf16 v[68:71], v[60:63], a[88:95], v2
ds_read_b128 a[212:215], v14 offset:2560
s_waitcnt lgkmcnt(1)
v_mfma_f32_16x16x32_bf16 v[104:107], v[88:91], v[72:75], 0
ds_read_b128 a[208:211], v14 offset:0
v_add_f32 v64, v64, v66
v_mfma_f32_16x16x32_bf16 v[104:107], v[92:95], v[76:79], v[104:107]
v_add_f32_e64 v69, v69, v71
v_add_f32_e64 v65, v65, v67
v_add_f32_e64 v68, v68, v70
v_cvt_pk_bf16_f32 v111, v65, v69
v_cvt_pk_bf16_f32 v110, v64, v68
v_smfmac_f32_16x16x64_bf16 v[80:83], v[32:35], a[96:103], v2
ds_write2_b32 v10, v110, v111 offset0:0 offset1:4
v_smfmac_f32_16x16x64_bf16 v[84:87], v[32:35], a[104:111], v2
ds_write_b128 v5, v[104:107] offset:14336
v_smfmac_f32_16x16x64_bf16 v[80:83], v[40:43], a[112:119], v2
ds_read_b128 v[116:119], v9 offset:21504
v_smfmac_f32_16x16x64_bf16 v[84:87], v[36:39], a[168:175], v2
s_nop 0
v_smfmac_f32_16x16x64_bf16 v[80:83], v[36:39], a[160:167], v2
s_cbranch_scc1 L_CEND
s_waitcnt lgkmcnt(1)
s_barrier
ds_read_b128 v[64:67], v15 offset:0
v_smfmac_f32_16x16x64_bf16 v[84:87], v[48:51], a[136:143], v2
s_nop 0
ds_read_b128 v[68:71], v15 offset:2560
v_mov_b64 v[34:35], 0
v_smfmac_f32_16x16x64_bf16 v[84:87], v[40:43], a[120:127], v2
ds_read_b128 v[88:91], v6 offset:14336
s_waitcnt lgkmcnt(3)
v_smfmac_f32_16x16x64_bf16 v[84:87], v[44:47], v[112:119], v2
s_waitcnt lgkmcnt(2)
v_mfma_f32_16x16x32_bf16 v[76:79], v[64:67], a[208:211], 0
ds_read_b128 v[72:75], v7 offset:14336
ds_read_b128 v[92:95], v8 offset:14336
v_smfmac_f32_16x16x64_bf16 v[80:83], v[48:51], a[128:135], v2
ds_read_b128 v[116:119], v9 offset:25600
s_waitcnt lgkmcnt(4)
v_mfma_f32_16x16x32_bf16 v[76:79], v[68:71], a[212:215], v[76:79]
ds_read_b128 v[112:115], v9 offset:24576
v_smfmac_f32_16x16x64_bf16 v[80:83], v[52:55], a[176:183], v2
s_waitcnt lgkmcnt(4)
v_add_f32_e64 v104, v104, v88
v_add_f32_e64 v105, v105, v89
v_add_f32_e64 v107, v107, v91
v_add_f32_e64 v106, v106, v90
s_waitcnt lgkmcnt(3)
v_pk_add_f32 v[104:105], v[104:105], v[72:73]
v_add_f32_dpp v108, v78, v76 row_ror:8 row_mask:0xf bank_mask:0x3
v_pk_add_f32 v[106:107], v[106:107], v[74:75]
s_waitcnt lgkmcnt(2)
v_pk_add_f32 v[106:107], v[106:107], v[94:95]
v_add_f32_dpp v109, v79, v77 row_ror:8 row_mask:0xf bank_mask:0x3
v_pk_add_f32 v[104:105], v[104:105], v[92:93]
v_max3_f32 v64, v104, v105, v106
v_max3_f32 v64, v64, v107, v108
v_max_f32 v64, v64, v109
v_smfmac_f32_16x16x64_bf16 v[84:87], v[52:55], a[184:191], v2
s_nop 0
v_max_f32_dpp v65, v64, v64 row_ror:8 row_mask:0xf bank_mask:0xf
v_max_f32_dpp v64, v64, v64 row_ror:8 row_mask:0xf bank_mask:0xf
v_smfmac_f32_16x16x64_bf16 v[80:83], v[56:59], a[144:151], v2
s_nop 0
v_permlane16_swap_b32 v64, v65
v_max_f32 v66, v64, v65
v_max_f32 v64, v64, v65
v_smfmac_f32_16x16x64_bf16 v[84:87], v[56:59], a[152:159], v2
s_nop 0
v_permlane32_swap_b32 v64, v66
v_max_f32 v64, v64, v66
v_mul_f32 v64, s69, v64
v_fma_f32 v104, v104, s69, -v64
v_fma_f32 v105, v105, s69, -v64
v_exp_f32 v104, v104
v_pk_fma_f32 v[106:107], v[106:107], s[48:49], v[64:65] op_sel_hi:[1,1,0] neg_lo:[0,0,1] neg_hi:[0,0,1]
v_exp_f32 v105, v105
v_exp_f32 v106, v106
v_exp_f32 v107, v107
v_cvt_pk_bf16_f32 v92, v104, v105
v_smfmac_f32_16x16x64_bf16 v[80:83], v[44:47], v[120:127], v2
ds_read_b128 v[120:123], v9 offset:22528
v_cvt_pk_bf16_f32 v93, v106, v107
v_fma_f32 v108, v108, s69, -v64
v_mov_b32_dpp v94, v92 row_ror:8 row_mask:0xf bank_mask:0xf
v_mov_b32_dpp v95, v93 row_ror:8 row_mask:0xf bank_mask:0xf
v_mov_b64_e64 v[30:31], s[50:51]
v_smfmac_f32_16x16x64_bf16 v[80:83], v[60:63], a[192:199], v2
ds_read_b128 v[124:127], v9 offset:23552
v_fma_f32 v109, v109, s69, -v64
v_smfmac_f32_16x16x64_bf16 v[84:87], v[60:63], a[200:207], v2
v_mov_b32 v69, 0
v_mfma_f32_16x16x32_bf16 v[88:91], v[28:31], v[92:95], 0
v_exp_f32 v108, v108
v_mfma_f32_16x16x32_bf16 v[72:75], v[96:99], v[92:95], 0
v_exp_f32 v109, v109
v_add_f32 v81, v81, v83
v_mfma_f32_16x16x32_bf16 v[76:79], v[100:103], v[92:95], 0
s_mov_b32 s66, s56
v_cvt_pk_bf16_f32 v68, v108, v109
v_add_f32 v80, v80, v82
v_cvt_pk_bf16_f32 v22, v80, v81
v_mfma_f32_16x16x16_bf16 v[88:91], v[28:29], v[68:69], v[88:91]
v_add_f32 v85, v85, v87
v_mov_b32 v83, 0
v_add_f32_e64 v84, v84, v86
v_mfma_f32_16x16x16_bf16 v[72:75], v[22:23], v[68:69], v[72:75]
v_cvt_pk_bf16_f32 v82, v84, v85
v_mov_b64 v[32:33], 0
s_nop 0
v_mfma_f32_16x16x16_bf16 v[76:79], v[82:83], v[68:69], v[76:79]
v_mov_b64 v[44:45], 0
v_mov_b64 v[38:39], 0
v_mov_b64 v[36:37], 0
v_rcp_f32 v88, v88
s_nop 0
v_pk_mul_f32 v[74:75], v[74:75], v[88:89] op_sel_hi:[1,0]
v_pk_mul_f32 v[72:73], v[72:73], v[88:89] op_sel_hi:[1,0]
s_nop 0
v_pk_mul_f32 v[78:79], v[78:79], v[88:89] op_sel_hi:[1,0]
v_pk_mul_f32 v[76:77], v[76:77], v[88:89] op_sel_hi:[1,0]
v_cvt_pk_bf16_f32 v107, v75, v79
v_cvt_pk_bf16_f32 v106, v74, v78
v_cvt_pk_bf16_f32 v105, v73, v77
v_cvt_pk_bf16_f32 v104, v72, v76
ds_write_b128 v5, v[104:107] offset:1024
s_nop 0
v_mov_b32_dpp v104, v104 row_ror:8 row_mask:0xf bank_mask:0xc
v_and_b32 v67, 0xffffff7f, v7
v_and_b32 v70, 0xffffff7f, v6
v_mov_b32_dpp v107, v107 row_ror:8 row_mask:0xf bank_mask:0xc
v_mov_b32_dpp v105, v105 row_ror:8 row_mask:0xf bank_mask:0xc
v_mov_b32_dpp v106, v106 row_ror:8 row_mask:0xf bank_mask:0xc
v_and_b32 v71, 0xffffff7f, v8
s_waitcnt lgkmcnt(1)
v_smfmac_f32_16x16x64_bf16 v[32:35], v[104:107], v[120:127], v2 abid:1
s_waitcnt lgkmcnt(0)
s_barrier
ds_read_b128 v[72:75], v70 offset:1024
v_mov_b64 v[46:47], 0
v_mov_b64 v[42:43], 0
ds_read_b128 v[64:67], v67 offset:1024
v_mov_b64 v[40:41], 0
v_smfmac_f32_16x16x64_bf16 v[36:39], v[104:107], v[112:119], v2 abid:1
s_nop 0
v_smfmac_f32_16x16x64_bf16 v[40:43], v[104:107], v[168:175], v2 abid:1
ds_read_b128 v[68:71], v71 offset:1024
v_mov_b32 v23, v82
v_smfmac_f32_16x16x64_bf16 v[44:47], v[104:107], v[176:183], v2 abid:1
s_waitcnt lgkmcnt(1)
v_smfmac_f32_16x16x64_bf16 v[32:35], v[64:67], v[192:199], v2 abid:1
v_smfmac_f32_16x16x64_bf16 v[32:35], v[72:75], v[184:191], v2 abid:1
s_nop 0
s_waitcnt lgkmcnt(0)
v_smfmac_f32_16x16x64_bf16 v[32:35], v[68:71], v[200:207], v2 abid:1
v_smfmac_f32_16x16x64_bf16 v[36:39], v[72:75], v[208:215], v2 abid:1
s_nop 0
s_nop 0
s_nop 1
v_cvt_pk_bf16_f32 v81, v34, v35
v_and_or_b32 v32, v32, v18, s75
v_cvt_pk_bf16_f32 v80, v32, v33
v_smfmac_f32_16x16x64_bf16 v[36:39], v[64:67], v[216:223], v2 abid:1
buffer_store_dwordx2 v[80:81], v3, s[36:39], s60 offen offset:0
ds_read_b128 v[96:99], v9 offset:26624
v_smfmac_f32_16x16x64_bf16 v[36:39], v[68:71], v[224:231], v2 abid:1
s_nop 0
ds_read_b128 v[48:51], v9 offset:28672
ds_read_b128 v[100:103], v9 offset:27648
v_smfmac_f32_16x16x64_bf16 v[40:43], v[72:75], v[232:239], v2 abid:1
ds_read_b128 v[52:55], v9 offset:29696
v_smfmac_f32_16x16x64_bf16 v[40:43], v[64:67], v[240:247], v2 abid:1
ds_read_b128 v[60:63], v9 offset:31744
v_cvt_pk_bf16_f32 v83, v38, v39
v_and_or_b32 v36, v36, v18, s75
v_cvt_pk_bf16_f32 v82, v36, v37
v_smfmac_f32_16x16x64_bf16 v[40:43], v[68:71], v[248:255], v2 abid:1
buffer_store_dwordx2 v[82:83], v3, s[36:39], s60 offen offset:2048
ds_read_b128 v[56:59], v9 offset:30720
s_waitcnt lgkmcnt(3)
v_smfmac_f32_16x16x64_bf16 v[44:47], v[72:75], v[96:103], v2 abid:1
s_nop 3
v_and_or_b32 v40, v40, v18, s75
v_cvt_pk_bf16_f32 v85, v42, v43
v_cvt_pk_bf16_f32 v84, v40, v41
s_waitcnt lgkmcnt(0)
v_smfmac_f32_16x16x64_bf16 v[44:47], v[68:71], v[56:63], v2 abid:1
s_nop 0
v_smfmac_f32_16x16x64_bf16 v[44:47], v[64:67], v[48:55], v2 abid:1
buffer_store_dwordx2 v[84:85], v3, s[36:39], s61 offen offset:0
s_mov_b32 s65, s55
s_nop 5
v_and_or_b32 v44, v44, v18, s75
v_cvt_pk_bf16_f32 v87, v46, v47
v_cvt_pk_bf16_f32 v86, v44, v45
buffer_store_dwordx2 v[86:87], v3, s[36:39], s61 offen offset:2048
ds_read_b128 v[104:107], v5 offset:15360
s_nop 0
s_nop 14
s_cmp_lt_u32 s32, 1
s_cbranch_scc1 L_sg1
s_nop 0
s_nop 0
s_nop 0
s_nop 0
s_nop 0
s_nop 3
s_cmp_lt_u32 s32, 2
s_cbranch_scc1 L_sg1
s_nop 0
s_nop 0
s_nop 0
s_nop 0
s_nop 0
s_nop 3
s_cmp_lt_u32 s32, 3
s_cbranch_scc1 L_sg1
s_nop 15
s_nop 0
s_nop 0
s_nop 0
s_nop 0
s_nop 3
L_sg1:
buffer_load_dwordx4 v[48:51], v0, s[36:39], s62 offen offset:0 sc1
buffer_load_dwordx4 v[52:55], v0, s[36:39], s62 offen offset:1024 sc1
ds_read_b128 v[88:91], v9 offset:0
ds_read_b128 v[92:95], v9 offset:1024
ds_read_b128 v[96:99], v9 offset:4096
ds_read_b128 v[100:103], v9 offset:5120
ds_read_b128 v[112:115], v9 offset:8192
ds_read_b128 v[116:119], v9 offset:9216
ds_read_b128 v[120:123], v9 offset:12288
ds_read_b128 v[124:127], v9 offset:13312
s_waitcnt lgkmcnt(8)
s_nop 0
s_nop 0
s_nop 13
s_nop 9
buffer_load_dwordx4 v[48:51], v0, s[36:39], s62 offen offset:0 sc1
buffer_load_dwordx4 v[52:55], v0, s[36:39], s62 offen offset:1024 sc1
v_mov_b64 v[64:65], 0
s_nop 0
v_mov_b64 v[66:67], 0
s_nop 0
v_mov_b64 v[68:69], 0
s_nop 0
v_mov_b64 v[70:71], 0
s_nop 0
v_mov_b64_e64 v[72:73], 0
s_nop 0
v_mov_b64 v[74:75], 0
s_nop 0
s_waitcnt vmcnt(3)
v_bitop3_b32 v108, v48, v50, s57 bitop3:0x7e
v_mfma_f32_16x16x32_bf16 v[56:59], v[104:107], v[48:51], 0
s_waitcnt vmcnt(2)
v_bitop3_b32 v109, v52, v54, s57 bitop3:0x7e
v_mfma_f32_16x16x32_bf16 v[56:59], v[104:107], v[52:55], v[56:59]
v_bitop3_b32 v108, v108, v109, 1 bitop3:0xa8
v_cmp_ne_u32_e64 vcc, 0, v108
s_cbranch_vccnz L_f1
L_ok1:
s_nop 0
s_nop 3
v_add_f32_dpp v56, v56, v56 row_ror:8 row_mask:0xf bank_mask:0xf
v_add_f32_dpp v57, v57, v57 row_ror:8 row_mask:0xf bank_mask:0xf
s_nop 0
v_add_f32_dpp v56, v56, v56 row_ror:4 row_mask:0xf bank_mask:0xf
v_add_f32_dpp v57, v57, v57 row_ror:4 row_mask:0xf bank_mask:0xf
v_cvt_pk_bf16_f32 v20, v56, v57
buffer_store_dword v20, v4, s[36:39], s63 offen
s_nop 0
s_nop 0
s_nop 5
L_pub1:
ds_read_b128 v[40:43], v9 offset:2048
ds_read_b128 v[44:47], v9 offset:3072
v_mov_b64 v[76:77], 0
v_mov_b64 v[78:79], 0
s_xor_b32 s60, s60, 0x40000
s_xor_b32 s61, s61, 0x40000
s_xor_b32 s62, s62, 0x40000
s_xor_b32 s64, s64, 0x10000
v_readfirstlane_b32 s54, v21
s_nop 0
s_cmp_lg_u32 s54, 0
s_cbranch_scc0 L_fslow
L_fok:
s_mov_b32 s58, s67
s_add_u32 s71, s71, 4
s_add_u32 s67, s67, 1
s_xor_b32 s63, s63, 0x10000
s_bfe_u32 s57, s67, 0x10001
s_lshl_b32 s75, 0x8000, s57
s_lshl_b32 s74, 0xffff0000, s57
v_mov_b32 v18, s74
s_add_u32 s55, s65, 0x80000
s_add_u32 s56, s66, 0x40000
s_nop 0
s_nop 0
s_cmp_lt_u32 s32, 2
s_cbranch_scc0 L_step
s_nop 0
s_nop 0
s_nop 0
s_nop 0
s_nop 0
s_nop 0
s_nop 3
L_stepe:
buffer_load_dwordx4 v[32:35], v0, s[36:39], s64 offen offset:0 sc1
buffer_load_dwordx4 v[36:39], v0, s[36:39], s64 offen offset:1024 sc1
ds_read_b128 v[24:27], v9 offset:16384
ds_read_b128 v[28:31], v9 offset:17408
ds_read_b128 v[80:83], v9 offset:14336
ds_read_b128 v[84:87], v9 offset:15360
ds_read_b128 a[208:211], v5 offset:22528
ds_read_b128 a[212:215], v5 offset:23552
ds_read_b128 v[56:59], v9 offset:10240
ds_read_b128 v[60:63], v9 offset:11264
s_nop 15
s_nop 0
s_nop 12
buffer_load_dwordx4 v[32:35], v0, s[36:39], s64 offen offset:0 sc1
buffer_load_dwordx4 v[36:39], v0, s[36:39], s64 offen offset:1024 sc1
s_waitcnt vmcnt(4) lgkmcnt(0)
ds_read_b128 v[48:51], v9 offset:6144
ds_read_b128 v[52:55], v9 offset:7168
s_waitcnt vmcnt(3)
v_max3_u32 v108, v32, v33, v34
v_max_u32_e64 v108, v108, v35
s_waitcnt vmcnt(2)
v_max3_u32 v108, v108, v36, v37
v_max3_u32 v108, v108, v38, v39
v_cmp_le_u32 vcc, s68, v108
s_cbranch_vccnz L_f2e
L_ok2e:
ds_write_b64 v5, v[32:33] offset:0
v_smfmac_f32_16x16x64_bf16 v[72:75], v[32:35], a[208:215], v2
ds_write_b64 v5, v[34:35] offset:8
v_smfmac_f32_16x16x64_bf16 v[76:79], v[32:35], v[88:95], v2
ds_write_b64 v5, v[36:37] offset:1024
v_smfmac_f32_16x16x64_bf16 v[72:75], v[36:39], v[40:47], v2
ds_write_b64 v5, v[38:39] offset:1032
v_smfmac_f32_16x16x64_bf16 v[76:79], v[36:39], v[96:103], v2
buffer_store_dword v17, v4, s[36:39], s63 offen
buffer_load_dwordx4 v[88:91], v0, s[36:39], s65 offen offset:0 sc1
s_waitcnt lgkmcnt(4)
v_smfmac_f32_16x16x64_bf16 v[64:67], v[32:35], v[48:55], v2
buffer_load_dwordx4 v[92:95], v0, s[36:39], s65 offen offset:1024 sc1
v_smfmac_f32_16x16x64_bf16 v[68:71], v[32:35], v[112:119], v2
buffer_load_dwordx4 v[96:99], v0, s[36:39], s65 offen offset:2048 sc1
v_smfmac_f32_16x16x64_bf16 v[64:67], v[36:39], v[56:63], v2
buffer_load_dwordx4 v[100:103], v0, s[36:39], s65 offen offset:3072 sc1
v_smfmac_f32_16x16x64_bf16 v[68:71], v[36:39], v[120:127], v2
s_waitcnt lgkmcnt(0)
s_barrier
ds_read_b128 v[40:43], v6 offset:0
ds_read_b128 v[44:47], v6 offset:1024
s_branch L_join2
L_fslow:
s_cmp_ge_u32 s67, 62
s_cbranch_scc1 L_fok
L_fs_19:
buffer_load_dword v21, off, s[36:39], s71 offset:0 sc1
s_waitcnt vmcnt(0)
v_cmp_eq_u32 vcc, 0, v21
s_cbranch_vccz L_fsd_20
s_add_u32 s35, s35, 1
s_cmp_gt_u32 s35, 131072
s_cbranch_scc1 L_END
s_sleep 1
s_branch L_fs_19
L_fsd_20:
s_branch L_fok
.p2align 5
s_nop 0
L_f1:
buffer_load_dwordx4 v[48:51], v0, s[36:39], s62 offen offset:0 sc1
buffer_load_dwordx4 v[52:55], v0, s[36:39], s62 offen offset:1024 sc1
s_add_u32 s35, s35, 1
s_cmp_gt_u32 s35, 524288
s_cbranch_scc1 L_END
s_waitcnt vmcnt(3)
v_bitop3_b32 v108, v48, v50, s57 bitop3:0x7e
v_mfma_f32_16x16x32_bf16 v[56:59], v[104:107], v[48:51], 0
s_waitcnt vmcnt(2)
v_bitop3_b32 v109, v52, v54, s57 bitop3:0x7e
v_mfma_f32_16x16x32_bf16 v[56:59], v[104:107], v[52:55], v[56:59]
v_bitop3_b32 v108, v108, v109, 1 bitop3:0xa8
v_cmp_ne_u32 vcc, 0, v108
s_cbranch_vccnz L_f1
s_nop 0
s_nop 3
v_add_f32_dpp v56, v56, v56 row_ror:8 row_mask:0xf bank_mask:0xf
v_add_f32_dpp v57, v57, v57 row_ror:8 row_mask:0xf bank_mask:0xf
s_nop 0
v_add_f32_dpp v56, v56, v56 row_ror:4 row_mask:0xf bank_mask:0xf
v_add_f32_dpp v57, v57, v57 row_ror:4 row_mask:0xf bank_mask:0xf
v_cvt_pk_bf16_f32 v20, v56, v57
buffer_store_dword v20, v4, s[36:39], s63 offen
s_branch L_pub1
.p2align 5
s_nop 0
s_nop 0
s_nop 0
s_nop 0
L_f2:
buffer_load_dwordx4 v[32:35], v0, s[36:39], s64 offen offset:0 sc1
buffer_load_dwordx4 v[36:39], v0, s[36:39], s64 offen offset:1024 sc1
v_cmp_lt_u32_e64 vcc, s68, v108
s_add_u32 s35, s35, 1
s_cmp_gt_u32 s35, 524288
s_cbranch_scc1 L_END
s_cbranch_vccnz L_x2
s_waitcnt vmcnt(3)
v_max3_u32 v108, v32, v33, v34
v_max_u32 v108, v108, v35
s_waitcnt vmcnt(2)
v_max3_u32 v108, v108, v36, v37
v_max3_u32 v108, v108, v38, v39
v_cmp_le_u32 vcc, s68, v108
s_cbranch_vccnz L_f2
ds_write_b64 v5, v[32:33] offset:0
v_smfmac_f32_16x16x64_bf16 v[72:75], v[32:35], a[208:215], v2
ds_write_b64 v5, v[34:35] offset:8
v_smfmac_f32_16x16x64_bf16 v[76:79], v[32:35], v[88:95], v2
ds_write_b64 v5, v[36:37] offset:1024
v_smfmac_f32_16x16x64_bf16 v[72:75], v[36:39], v[40:47], v2
ds_write_b64 v5, v[38:39] offset:1032
buffer_store_dword v17, v4, s[36:39], s63 offen
v_smfmac_f32_16x16x64_bf16 v[76:79], v[36:39], v[96:103], v2
buffer_load_dwordx4 v[88:91], v0, s[36:39], s65 offen offset:0 sc1
s_branch L_hb
.p2align 5
s_nop 0
s_nop 0
s_nop 0
s_nop 0
L_f2e:
buffer_load_dwordx4 v[32:35], v0, s[36:39], s64 offen offset:0 sc1
buffer_load_dwordx4 v[36:39], v0, s[36:39], s64 offen offset:1024 sc1
v_cmp_lt_u32_e64 vcc, s68, v108
s_add_u32 s35, s35, 1
s_cmp_gt_u32 s35, 524288
s_cbranch_scc1 L_END
s_cbranch_vccnz L_x2e
s_waitcnt vmcnt(3)
v_max3_u32 v108, v32, v33, v34
v_max_u32 v108, v108, v35
s_waitcnt vmcnt(2)
v_max3_u32 v108, v108, v36, v37
v_max3_u32 v108, v108, v38, v39
v_cmp_le_u32_e64 vcc, s68, v108
s_cbranch_vccnz L_f2e
ds_write_b64 v5, v[32:33] offset:0
v_smfmac_f32_16x16x64_bf16 v[72:75], v[32:35], a[208:215], v2
ds_write_b64 v5, v[34:35] offset:8
v_smfmac_f32_16x16x64_bf16 v[76:79], v[32:35], v[88:95], v2
ds_write_b64 v5, v[36:37] offset:1024
v_smfmac_f32_16x16x64_bf16 v[72:75], v[36:39], v[40:47], v2
ds_write_b64 v5, v[38:39] offset:1032
v_smfmac_f32_16x16x64_bf16 v[76:79], v[36:39], v[96:103], v2
buffer_store_dword v17, v4, s[36:39], s63 offen
buffer_load_dwordx4 v[88:91], v0, s[36:39], s65 offen offset:0 sc1
s_waitcnt lgkmcnt(4)
v_smfmac_f32_16x16x64_bf16 v[64:67], v[32:35], v[48:55], v2
buffer_load_dwordx4 v[92:95], v0, s[36:39], s65 offen offset:1024 sc1
v_smfmac_f32_16x16x64_bf16 v[68:71], v[32:35], v[112:119], v2
buffer_load_dwordx4 v[96:99], v0, s[36:39], s65 offen offset:2048 sc1
v_smfmac_f32_16x16x64_bf16 v[64:67], v[36:39], v[56:63], v2
buffer_load_dwordx4 v[100:103], v0, s[36:39], s65 offen offset:3072 sc1
v_smfmac_f32_16x16x64_bf16 v[68:71], v[36:39], v[120:127], v2
s_waitcnt lgkmcnt(0)
s_barrier
ds_read_b128 v[40:43], v6 offset:0
ds_read_b128 v[44:47], v6 offset:1024
s_branch L_join2
L_x2:
s_waitcnt vmcnt(0)
v_cmp_eq_u32 s[76:77], s68, v32
v_cmp_eq_u32 vcc, s68, v33
s_nop 0
s_or_b64 s[76:77], s[76:77], vcc
v_cmp_eq_u32 vcc, s68, v34
s_nop 0
s_or_b64 s[76:77], s[76:77], vcc
v_cmp_eq_u32 vcc, s68, v35
s_nop 0
s_or_b64 s[76:77], s[76:77], vcc
v_cmp_eq_u32 vcc, s68, v36
s_nop 0
s_or_b64 s[76:77], s[76:77], vcc
v_cmp_eq_u32 vcc, s68, v37
s_nop 0
s_or_b64 s[76:77], s[76:77], vcc
v_cmp_eq_u32 vcc, s68, v38
s_nop 0
s_or_b64 s[76:77], s[76:77], vcc
v_cmp_eq_u32 vcc, s68, v39
s_nop 0
s_or_b64 s[76:77], s[76:77], vcc
s_cbranch_scc0 L_ok2
s_branch L_f2
L_x2e:
s_waitcnt vmcnt(0)
v_cmp_eq_u32 s[76:77], s68, v32
v_cmp_eq_u32 vcc, s68, v33
s_nop 0
s_or_b64 s[76:77], s[76:77], vcc
v_cmp_eq_u32 vcc, s68, v34
s_nop 0
s_or_b64 s[76:77], s[76:77], vcc
v_cmp_eq_u32 vcc, s68, v35
s_nop 0
s_or_b64 s[76:77], s[76:77], vcc
v_cmp_eq_u32 vcc, s68, v36
s_nop 0
s_or_b64 s[76:77], s[76:77], vcc
v_cmp_eq_u32 vcc, s68, v37
s_nop 0
s_or_b64 s[76:77], s[76:77], vcc
v_cmp_eq_u32 vcc, s68, v38
s_nop 0
s_or_b64 s[76:77], s[76:77], vcc
v_cmp_eq_u32 vcc, s68, v39
s_nop 0
s_or_b64 s[76:77], s[76:77], vcc
s_cbranch_scc0 L_ok2e
s_branch L_f2e
L_CEND:
buffer_store_dword v110, v11, s[36:39], s56 offen offset:0 sc1
buffer_store_dword v111, v11, s[36:39], s56 offen offset:64 sc1
v_smfmac_f32_16x16x64_bf16 v[84:87], v[48:51], a[136:143], v2
v_smfmac_f32_16x16x64_bf16 v[84:87], v[40:43], a[120:127], v2
s_waitcnt lgkmcnt(0)
v_smfmac_f32_16x16x64_bf16 v[84:87], v[44:47], v[112:119], v2
v_smfmac_f32_16x16x64_bf16 v[80:83], v[48:51], a[128:135], v2
v_smfmac_f32_16x16x64_bf16 v[80:83], v[52:55], a[176:183], v2
v_smfmac_f32_16x16x64_bf16 v[84:87], v[52:55], a[184:191], v2
v_smfmac_f32_16x16x64_bf16 v[80:83], v[56:59], a[144:151], v2
v_smfmac_f32_16x16x64_bf16 v[84:87], v[56:59], a[152:159], v2
v_smfmac_f32_16x16x64_bf16 v[80:83], v[44:47], v[120:127], v2
v_smfmac_f32_16x16x64_bf16 v[80:83], v[60:63], a[192:199], v2
v_smfmac_f32_16x16x64_bf16 v[84:87], v[60:63], a[200:207], v2
s_nop 3
v_add_f32 v80, v80, v82
v_add_f32 v81, v81, v83
s_nop 1
v_add_f32 v84, v84, v86
v_add_f32 v85, v85, v87
v_cvt_pk_bf16_f32 v80, v80, v81
v_cvt_pk_bf16_f32 v81, v84, v85
buffer_store_dwordx2 v[80:81], v1, s[36:39], s56 offen offset:1024 sc1
v_mov_b32 v108, 64
s_waitcnt vmcnt(0) lgkmcnt(0)
buffer_store_dword v108, v16, s[36:39], s70 offen sc1
L_END:
s_endpgm
.section .rodata,"a"
.p2align 6
.amdhsa_kernel recurrent_scan__memory_aug_recurrent_mem_tr__glu_gated_reglu__prompt_kernel
  .amdhsa_next_free_vgpr 512
  .amdhsa_next_free_sgpr 102
  .amdhsa_accum_offset 256
  .amdhsa_group_segment_fixed_size 0
  .amdhsa_kernarg_size 112
  .amdhsa_user_sgpr_count 2
  .amdhsa_user_sgpr_kernarg_segment_ptr 1
  .amdhsa_system_sgpr_workgroup_id_x 1
  .amdhsa_float_denorm_mode_32 3
.end_amdhsa_kernel
```
